```python
import torch

def _softmax(x, axis=-1):
    return torch.softmax(x, dim=axis)
def _gelu(x):
    return torch.nn.functional.gelu(x, approximate="tanh")
def _silu(x):
    return torch.nn.functional.silu(x)
def _sigmoid(x):
    return torch.sigmoid(x)
def _layernorm(x, axis=-1, eps=1e-5):
    m = x.mean(dim=axis, keepdim=True)
    v = x.var(dim=axis, keepdim=True, unbiased=False)
    return (x - m) / torch.sqrt(v + eps)
def _scatter_add(tgt, idx, src, axis=0):
    return tgt.clone().index_add_(axis, idx, src)
def _segment_sum(src, seg, n):
    out = torch.zeros((n,) + src.shape[1:], dtype=src.dtype)
    return out.index_add_(0, seg, src)
def _pad(x, pw):
    flat = tuple(v for pair in reversed(pw) for v in pair)
    return torch.nn.functional.pad(x, flat)

kernel_name = 'gated_mix__linear_attn_block__mixer_s_mlp__prompt'

def setup_inputs():

    _w = (lambda a: (lambda t: t.to(torch.bfloat16) if t.is_floating_point() else t)(torch.as_tensor(a)))
    def _A_setup():
        B, S, D = 1, 2048, 640
        return {
            "x": _w((lambda *s: torch.randn(*s, dtype=torch.bfloat16) * 0.05)(B, S, D)),
            "wqkv": _w((lambda *s: torch.randn(*s, dtype=torch.bfloat16) * 3.2)(D, 3 * D)),
            "wo": _w((lambda *s: torch.randn(*s, dtype=torch.bfloat16) * 1.6)(D, D)),
        }
    _A_in = _A_setup()

    def _B_setup():
        B, S, D, F = 1, 2048, 640, 1728
        return {
            "x":  _w((lambda *s: torch.randn(*s, dtype=torch.bfloat16) * 0.05)(B, S, D)),
            "w1": _w((lambda *s: torch.randn(*s, dtype=torch.bfloat16) * 3.2)(D, D) * (D ** -0.5)),
            "w2": _w((lambda *s: torch.randn(*s, dtype=torch.bfloat16) * 3.2)(D, D) * (D ** -0.5)),
            "w3": _w((lambda *s: torch.randn(*s, dtype=torch.bfloat16) * 3.2)(D, F) * (D ** -0.5)),
            "w4": _w((lambda *s: torch.randn(*s, dtype=torch.bfloat16) * 3.2)(F, D) * (F ** -0.5)),
        }
    _B_in = _B_setup()

    return {
        "A_x": _A_in["x"],
        "A_wqkv": _A_in["wqkv"],
        "A_wo": _A_in["wo"],
        "B_x": _B_in["x"],
        "B_w1": _B_in["w1"],
        "B_w2": _B_in["w2"],
        "B_w3": _B_in["w3"],
        "B_w4": _B_in["w4"],
        "gate_w": _w((lambda *s: torch.randn(*s, dtype=torch.bfloat16) * 0.05)(640) * 16.0),
    }

def reference(A_x, A_wqkv, A_wo, B_x, B_w1, B_w2, B_w3, B_w4, gate_w):
    def _A_ref(x, wqkv, wo):
        B, S, D = x.shape
        H = 32; Dh = D // H
        qkv = (lambda x, *d: x.permute(*d))((x @ wqkv).reshape(B, S, 3, H, Dh), 2, 0, 3, 1, 4)
        q, k, v = qkv[0], qkv[1], qkv[2]
        phi = lambda t: torch.where(t > 0, t + 1, torch.exp(t)) + 1e-6
        pq, pk = phi(q), phi(k)
        kv = torch.einsum("bhsd,bhse->bhde", pk, v)
        z = torch.einsum("bhsd->bhd", pk)
        num = torch.einsum("bhqd,bhde->bhqe", pq, kv)
        den = torch.einsum("bhqd,bhd->bhq", pq, z)[..., None] + 1e-6
        o = num / den
        return (lambda x, *d: x.permute(*d))(o, 0, 2, 1, 3).reshape(B, S, D) @ wo

    def _B_ref(x, w1, w2, w3, w4):
        B, S, D = x.shape
        h = _gelu(_layernorm(x, axis=-1) @ w1)
        c = D // 4
        g0 = _pad(h[:, :, 0*c:1*c], ((0, 0), (1, 0), (0, 0)))[:, :S, :]
        g1 = _pad(h[:, :, 1*c:2*c], ((0, 0), (0, 1), (0, 0)))[:, 1:, :]
        g2 = _pad(h[:, :, 2*c:3*c], ((0, 0), (2, 0), (0, 0)))[:, :S, :]
        g3 = _pad(h[:, :, 3*c:   ], ((0, 0), (0, 2), (0, 0)))[:, 2:, :]
        hs = torch.concatenate([g0, g1, g2, g3], axis=-1) @ w2
        x1 = x + hs
        h2 = _gelu(_layernorm(x1, axis=-1) @ w3) @ w4
        return x1 + h2

    x = A_x
    g = _sigmoid((x * gate_w).sum(-1, keepdims=True))
    a = _A_ref(x, A_wqkv, A_wo)
    b = _B_ref(x, B_w1, B_w2, B_w3, B_w4)
    return g * a + (1 - g) * b
```

```asm
; @launch grid=(256,1,1) block=(256,1,1) lds=163840
.amdgcn_target "amdgcn-amd-amdhsa--gfx950"
.text
.globl gated_mix__linear_attn_block__mixer_s_mlp__prompt_kernel
.p2align 8
.type gated_mix__linear_attn_block__mixer_s_mlp__prompt_kernel,@function
gated_mix__linear_attn_block__mixer_s_mlp__prompt_kernel:
s_cmp_ge_u32 s2, 256
s_cbranch_scc1 L_exit
s_load_dwordx4 s[8:11], s[0:1], 0
s_load_dwordx2 s[12:13], s[0:1], 16
s_load_dwordx8 s[16:23], s[0:1], 32
s_load_dwordx2 s[24:25], s[0:1], 64
s_load_dwordx2 s[26:27], s[0:1], 88
s_load_dwordx2 s[34:35], s[0:1], 80
v_lshrrev_b32 v32, 6, v0
v_and_b32 v1, 63, v0
v_readfirstlane_b32 s3, v32
v_lshrrev_b32 v2, 4, v1
v_and_b32 v3, 15, v1
v_lshlrev_b32 v31, 4, v1
s_getpc_b64 s[96:97]
L_pfr_gated_mix__linear_attn_block__mixer_s_mlp__prompt_kernel_1:
s_sub_u32 s96, s96, L_pfr_gated_mix__linear_attn_block__mixer_s_mlp__prompt_kernel_1 - gated_mix__linear_attn_block__mixer_s_mlp__prompt_kernel
s_subb_u32 s97, s97, 0
v_lshrrev_b32 v62, 6, v0
v_and_b32 v61, 1, v0
v_mad_u32_u24 v62, v62, 2, v61
s_lshr_b32 s95, s2, 3
s_mul_i32 s95, s95, 8
v_add_u32 v62, s95, v62
v_min_u32 v62, (L_code_p2 - gated_mix__linear_attn_block__mixer_s_mlp__prompt_kernel) >> 7, v62
v_lshlrev_b32 v62, 7, v62
global_load_dword v55, v62, s[96:97]
s_and_b32 s28, s2, 7
s_lshr_b32 s29, s2, 3
s_lshr_b32 s71, s29, 2
s_and_b32 s72, s29, 3
s_cmp_lt_u32 s28, 4
s_cbranch_scc0 L_k1_dec_b
s_lshr_b32 s73, s28, 1
s_lshl_b32 s73, s73, 3
s_add_u32 s30, s73, s71
s_and_b32 s73, s28, 1
s_lshl_b32 s73, s73, 2
s_add_u32 s31, s73, s72
s_mov_b32 s32, 0
s_mul_i32 s61, s31, 160
s_add_u32 s61, s61, 1280
s_movk_i32 s62, 1120
s_branch L_k1_dec_done
L_k1_dec_b:
s_and_b32 s73, s28, 1
s_lshl_b32 s73, s73, 3
s_add_u32 s30, s73, s71
s_mov_b32 s31, s72
s_cmp_lt_u32 s28, 6
s_cselect_b32 s32, 1, 2
s_mul_i32 s61, s31, 320
s_mov_b32 s62, 0
L_k1_dec_done:
s_cmp_eq_u32 s32, 2
s_movk_i32 s60, 3840
s_cselect_b32 s60, 1280, s60
s_lshl_b32 s66, s60, 6
s_lshl_b32 s69, s3, 12
s_mul_i32 s70, s3, 5120
s_add_u32 s70, s70, 16384
v_lshrrev_b32 v32, 3, v1
s_lshl_b32 s71, s3, 5
v_add_u32 v32, s71, v32
v_mul_u32_u24 v32, 1280, v32
v_and_b32 v33, 7, v1
v_xor_b32 v33, v33, v2
v_lshlrev_b32 v33, 4, v33
v_xor_b32 v34, 64, v33
v_add_u32 v4, v32, v33
v_add_u32 v5, v32, v34
v_add_u32 v5, 9216, v5
v_add_u32 v6, v32, v33
v_add_u32 v6, 18432, v6
v_add_u32 v7, v32, v34
v_add_u32 v7, 27648, v7
s_waitcnt lgkmcnt(0)
s_mul_i32 s71, s30, 163840
s_add_u32 s36, s8, s71
s_addc_u32 s37, s9, 0
s_mov_b32 s38, 163840
s_mov_b32 s39, 0x20000
s_add_u32 m0, s69, 0
s_movk_i32 s64, 0
buffer_load_dwordx4 v4, s[36:39], s64 offen offset:0 lds
buffer_load_dwordx4 v5, s[36:39], s64 offen offset:1024 lds
buffer_load_dwordx4 v6, s[36:39], s64 offen offset:2048 lds
buffer_load_dwordx4 v7, s[36:39], s64 offen offset:3072 lds
s_add_u32 m0, s69, 36864
s_movk_i32 s64, 128
buffer_load_dwordx4 v4, s[36:39], s64 offen offset:0 lds
buffer_load_dwordx4 v5, s[36:39], s64 offen offset:1024 lds
buffer_load_dwordx4 v6, s[36:39], s64 offen offset:2048 lds
buffer_load_dwordx4 v7, s[36:39], s64 offen offset:3072 lds
s_mov_b32 s56, s24
s_mov_b32 s57, s25
s_mov_b32 s58, 1280
s_mov_b32 s59, 0x20000
s_cmp_eq_u32 s32, 2
s_cbranch_scc0 L_k1_nogw
s_mov_b32 m0, 151680
s_nop 0
buffer_load_dwordx4 v31, s[56:59], 0 offen lds
buffer_load_dwordx4 v31, s[56:59], 0 offen offset:1024 lds
L_k1_nogw:
v_add_u32 v32, 0, v1
v_mul_u32_u24 v33, 3277, v32
v_lshrrev_b32 v33, 16, v33
v_mul_u32_u24 v34, 20, v33
v_sub_u32 v32, v32, v34
v_bfe_u32 v34, v33, 3, 1
v_lshlrev_b32 v34, 1, v34
v_sub_u32 v32, v32, v34
v_add_u32 v34, 20, v32
v_cmp_gt_i32 vcc, 0, v32
s_lshl_b32 s71, s3, 4
v_add_u32 v33, s71, v33
v_cndmask_b32 v32, v32, v34, vcc
v_mul_u32_u24 v33, s60, v33
v_cmp_le_u32 vcc, 10, v32
v_lshlrev_b32 v32, 4, v32
v_mov_b32 v34, s62
v_cndmask_b32 v34, 0, v34, vcc
v_add3_u32 v32, v32, v33, v34
v_add_u32 v8, s61, v32
v_add_u32 v32, 64, v1
v_mul_u32_u24 v33, 3277, v32
v_lshrrev_b32 v33, 16, v33
v_mul_u32_u24 v34, 20, v33
v_sub_u32 v32, v32, v34
v_bfe_u32 v34, v33, 3, 1
v_lshlrev_b32 v34, 1, v34
v_sub_u32 v32, v32, v34
v_add_u32 v34, 20, v32
v_cmp_gt_i32 vcc, 0, v32
s_lshl_b32 s71, s3, 4
v_add_u32 v33, s71, v33
v_cndmask_b32 v32, v32, v34, vcc
v_mul_u32_u24 v33, s60, v33
v_cmp_le_u32 vcc, 10, v32
v_lshlrev_b32 v32, 4, v32
v_mov_b32 v34, s62
v_cndmask_b32 v34, 0, v34, vcc
v_add3_u32 v32, v32, v33, v34
v_add_u32 v9, s61, v32
v_subrev_u32 v9, 1024, v9
v_add_u32 v32, 128, v1
v_mul_u32_u24 v33, 3277, v32
v_lshrrev_b32 v33, 16, v33
v_mul_u32_u24 v34, 20, v33
v_sub_u32 v32, v32, v34
v_bfe_u32 v34, v33, 3, 1
v_lshlrev_b32 v34, 1, v34
v_sub_u32 v32, v32, v34
v_add_u32 v34, 20, v32
v_cmp_gt_i32 vcc, 0, v32
s_lshl_b32 s71, s3, 4
v_add_u32 v33, s71, v33
v_cndmask_b32 v32, v32, v34, vcc
v_mul_u32_u24 v33, s60, v33
v_cmp_le_u32 vcc, 10, v32
v_lshlrev_b32 v32, 4, v32
v_mov_b32 v34, s62
v_cndmask_b32 v34, 0, v34, vcc
v_add3_u32 v32, v32, v33, v34
v_add_u32 v10, s61, v32
v_subrev_u32 v10, 2048, v10
v_add_u32 v32, 192, v1
v_mul_u32_u24 v33, 3277, v32
v_lshrrev_b32 v33, 16, v33
v_mul_u32_u24 v34, 20, v33
v_sub_u32 v32, v32, v34
v_bfe_u32 v34, v33, 3, 1
v_lshlrev_b32 v34, 1, v34
v_sub_u32 v32, v32, v34
v_add_u32 v34, 20, v32
v_cmp_gt_i32 vcc, 0, v32
s_lshl_b32 s71, s3, 4
v_add_u32 v33, s71, v33
v_cndmask_b32 v32, v32, v34, vcc
v_mul_u32_u24 v33, s60, v33
v_cmp_le_u32 vcc, 10, v32
v_lshlrev_b32 v32, 4, v32
v_mov_b32 v34, s62
v_cndmask_b32 v34, 0, v34, vcc
v_add3_u32 v32, v32, v33, v34
v_add_u32 v11, s61, v32
v_subrev_u32 v11, 3072, v11
v_add_u32 v32, 256, v1
v_mul_u32_u24 v33, 3277, v32
v_lshrrev_b32 v33, 16, v33
v_mul_u32_u24 v34, 20, v33
v_sub_u32 v32, v32, v34
v_bfe_u32 v34, v33, 3, 1
v_lshlrev_b32 v34, 1, v34
v_sub_u32 v32, v32, v34
v_add_u32 v34, 20, v32
v_cmp_gt_i32 vcc, 0, v32
s_lshl_b32 s71, s3, 4
v_add_u32 v33, s71, v33
v_cndmask_b32 v32, v32, v34, vcc
v_mul_u32_u24 v33, s60, v33
v_cmp_le_u32 vcc, 10, v32
v_lshlrev_b32 v32, 4, v32
v_mov_b32 v34, s62
v_cndmask_b32 v34, 0, v34, vcc
v_add3_u32 v32, v32, v33, v34
v_add_u32 v12, s61, v32
s_cmp_eq_u32 s32, 2
s_cselect_b32 s40, s16, s10
s_cselect_b32 s41, s17, s11
s_mul_i32 s42, s60, 640
s_mov_b32 s43, 0x20000
s_add_u32 s89, s70, 4096
s_add_u32 m0, s70, 0
s_mul_i32 s65, s66, 0
buffer_load_dwordx4 v8, s[40:43], s65 offen offset:0 lds
s_mov_b32 s44, s26
s_mov_b32 s45, s27
s_mov_b32 s46, 28520448
s_mov_b32 s47, 0x20000
s_add_u32 s52, s26, 0
s_addc_u32 s53, s27, 0
buffer_load_dwordx4 v9, s[40:43], s65 offen offset:1024 lds
s_mov_b32 s54, 2621440
s_mov_b32 s55, 0x20000
v_mov_b32 v32, 0x3f803f80
v_lshlrev_b32 v33, 2, v1
v_add_u32 v33, 151552, v33
v_cmp_gt_u32 vcc, 32, v1
s_and_saveexec_b64 s[76:77], vcc
ds_write_b32 v33, v32
s_mov_b64 exec, s[76:77]
v_accvgpr_write_b32 a76, v32
v_accvgpr_write_b32 a77, v32
v_accvgpr_write_b32 a78, v32
buffer_load_dwordx4 v10, s[40:43], s65 offen offset:2048 lds
v_accvgpr_write_b32 a79, v32
v_lshrrev_b32 v32, 1, v3
v_xor_b32 v32, v32, v2
v_lshlrev_b32 v32, 4, v32
v_lshl_add_u32 v32, v3, 7, v32
v_add_u32 v13, s69, v32
v_xor_b32 v14, 64, v13
v_lshrrev_b32 v32, 2, v3
v_lshl_add_u32 v32, v2, 3, v32
v_mul_u32_u24 v32, 320, v32
v_and_b32 v33, 3, v3
v_lshl_add_u32 v32, v33, 3, v32
buffer_load_dwordx4 v11, s[40:43], s65 offen offset:3072 lds
v_add_u32 v32, 16384, v32
v_and_b32 v33, 1, v2
v_lshl_add_u32 v15, v33, 5, v32
v_xor_b32 v33, 1, v33
v_mul_u32_u24 v33, 288, v33
v_add_u32 v16, v32, v33
s_lshl_b32 s71, s3, 5
v_add_u32 v17, s71, v15
v_add_u32 v18, 128, v17
v_add_u32 v19, 256, v15
s_cmp_eq_u32 s3, 1
s_cbranch_scc0 L_k1_nc9
v_mov_b32 v19, v16
L_k1_nc9:
s_add_u32 m0, s89, 0
s_nop 0
buffer_load_dwordx4 v12, s[40:43], s65 offen lds
v_lshlrev_b32 v32, 4, v2
v_add_u32 v32, 151680, v32
v_mov_b32 v33, 151552
v_cmp_gt_u32 vcc, 8, v3
v_mov_b32 v34, 128
v_mov_b32 v35, 0
v_cndmask_b32 v20, v32, v33, vcc
v_cndmask_b32 v21, v34, v35, vcc
v_mov_b32 v22, v13
v_mov_b32 v23, v14
v_mov_b32 v24, v15
v_mov_b32 v25, v16
s_add_u32 m0, s70, 36864
s_mul_i32 s65, s66, 1
buffer_load_dwordx4 v8, s[40:43], s65 offen offset:0 lds
v_mov_b32 v26, v17
v_mov_b32 v27, v18
v_mov_b32 v28, v19
s_mov_b32 s68, 0
v_pk_mov_b32 v[64:65], 0, 0
v_pk_mov_b32 v[66:67], 0, 0
v_pk_mov_b32 v[68:69], 0, 0
v_pk_mov_b32 v[70:71], 0, 0
v_pk_mov_b32 v[72:73], 0, 0
v_pk_mov_b32 v[74:75], 0, 0
v_pk_mov_b32 v[76:77], 0, 0
v_pk_mov_b32 v[78:79], 0, 0
buffer_load_dwordx4 v9, s[40:43], s65 offen offset:1024 lds
v_pk_mov_b32 v[80:81], 0, 0
v_pk_mov_b32 v[82:83], 0, 0
v_pk_mov_b32 v[84:85], 0, 0
v_pk_mov_b32 v[86:87], 0, 0
v_pk_mov_b32 v[88:89], 0, 0
v_pk_mov_b32 v[90:91], 0, 0
v_pk_mov_b32 v[92:93], 0, 0
v_pk_mov_b32 v[94:95], 0, 0
v_pk_mov_b32 v[96:97], 0, 0
v_pk_mov_b32 v[98:99], 0, 0
v_pk_mov_b32 v[100:101], 0, 0
v_pk_mov_b32 v[102:103], 0, 0
buffer_load_dwordx4 v10, s[40:43], s65 offen offset:2048 lds
v_pk_mov_b32 v[104:105], 0, 0
v_pk_mov_b32 v[106:107], 0, 0
v_pk_mov_b32 v[108:109], 0, 0
v_pk_mov_b32 v[110:111], 0, 0
v_pk_mov_b32 v[112:113], 0, 0
v_pk_mov_b32 v[114:115], 0, 0
v_pk_mov_b32 v[116:117], 0, 0
v_pk_mov_b32 v[118:119], 0, 0
v_pk_mov_b32 v[120:121], 0, 0
v_pk_mov_b32 v[122:123], 0, 0
v_pk_mov_b32 v[124:125], 0, 0
v_pk_mov_b32 v[126:127], 0, 0
buffer_load_dwordx4 v11, s[40:43], s65 offen offset:3072 lds
v_pk_mov_b32 v[128:129], 0, 0
v_pk_mov_b32 v[130:131], 0, 0
v_pk_mov_b32 v[132:133], 0, 0
v_pk_mov_b32 v[134:135], 0, 0
v_pk_mov_b32 v[136:137], 0, 0
v_pk_mov_b32 v[138:139], 0, 0
v_pk_mov_b32 v[140:141], 0, 0
v_pk_mov_b32 v[142:143], 0, 0
v_pk_mov_b32 v[144:145], 0, 0
v_pk_mov_b32 v[146:147], 0, 0
v_pk_mov_b32 v[148:149], 0, 0
v_pk_mov_b32 v[150:151], 0, 0
s_add_u32 m0, s89, 36864
s_nop 0
buffer_load_dwordx4 v12, s[40:43], s65 offen lds
v_pk_mov_b32 v[152:153], 0, 0
v_pk_mov_b32 v[154:155], 0, 0
v_pk_mov_b32 v[156:157], 0, 0
v_pk_mov_b32 v[158:159], 0, 0
v_pk_mov_b32 v[160:161], 0, 0
v_pk_mov_b32 v[162:163], 0, 0
v_pk_mov_b32 v[164:165], 0, 0
v_pk_mov_b32 v[166:167], 0, 0
v_pk_mov_b32 v[168:169], 0, 0
v_pk_mov_b32 v[170:171], 0, 0
s_lshl_b32 s71, s2, 2
s_add_u32 s71, s71, s3
s_mul_i32 s72, s71, 20
v_add_u32 v40, s72, v1
v_lshlrev_b32 v40, 7, v40
v_mov_b32 v41, 0x80000000
v_cmp_gt_u32 vcc, 20, v1
s_mov_b32 s48, s8
s_mov_b32 s49, s9
s_mov_b32 s50, 2621440
s_mov_b32 s51, 0x20000
v_cndmask_b32 v40, v41, v40, vcc
buffer_load_dword v52, v40, s[48:51], 0 offen
s_mul_i32 s72, s71, 19
v_add_u32 v40, s72, v1
v_lshlrev_b32 v40, 7, v40
v_mov_b32 v41, 0x80000000
v_cmp_gt_u32 vcc, 19, v1
s_mov_b32 s48, s10
s_mov_b32 s49, s11
s_mov_b32 s50, 2457600
s_mov_b32 s51, 0x20000
v_cndmask_b32 v40, v41, v40, vcc
buffer_load_dword v53, v40, s[48:51], 0 offen
s_mul_i32 s72, s71, 7
v_add_u32 v40, s72, v1
v_lshlrev_b32 v40, 7, v40
v_mov_b32 v41, 0x80000000
v_cmp_gt_u32 vcc, 7, v1
s_mov_b32 s48, s16
s_mov_b32 s49, s17
s_mov_b32 s50, 819200
s_mov_b32 s51, 0x20000
v_cndmask_b32 v40, v41, v40, vcc
buffer_load_dword v54, v40, s[48:51], 0 offen
s_movk_i32 s64, 256
s_lshl_b32 s65, s66, 1
s_mov_b32 s67, 73728
s_mov_b32 s33, s2
s_mov_b32 s82, 0
s_mov_b32 s85, 0
s_mov_b32 s48, s20
s_mov_b32 s49, s21
s_mov_b32 s50, 2211840
s_mov_b32 s51, 0x20000
s_movk_i32 s87, 3456
s_mov_b32 s71, 0
s_mov_b32 s72, 0
s_mov_b32 s83, 0
s_mov_b32 s84, 0
s_mov_b32 s86, 0
s_cmp_lt_u32 s33, 81
s_cbranch_scc0 L_rl_n3_pre
s_mul_i32 s71, s33, 21846
s_lshr_b32 s71, s71, 16
s_mul_i32 s73, s71, 3
s_sub_u32 s73, s33, s73
s_mul_i32 s72, s73, 7
s_cmp_eq_u32 s73, 2
s_cselect_b32 s82, 6, 7
s_mov_b32 s85, 1
s_lshl_b32 s74, s71, 2
s_add_u32 s74, s74, s3
s_mul_i32 s86, s73, 6912
s_lshl_b32 s73, s74, 6
s_add_u32 s86, s86, s73
s_add_u32 s86, s86, 13148160
s_mul_i32 s73, s74, 7282
s_lshr_b32 s73, s73, 16
s_mul_i32 s83, s73, 9
s_sub_u32 s74, s74, s83
s_mul_i32 s73, s73, 20
s_add_u32 s73, s73, s72
s_mul_i32 s73, s73, 9
s_add_u32 s73, s73, s74
s_lshl_b32 s83, s73, 10
s_add_u32 s83, s83, 7905280
s_movk_i32 s84, 9216
s_branch L_rl_done_pre
L_rl_n3_pre:
s_movk_i32 s87, 1280
s_cmp_lt_u32 s33, 161
s_cbranch_scc0 L_rl_n4_pre
s_sub_u32 s74, s33, 81
s_lshr_b32 s71, s74, 3
s_and_b32 s73, s74, 7
s_mul_i32 s72, s73, 7
s_cmp_eq_u32 s73, 7
s_cselect_b32 s82, 5, 7
s_mov_b32 s48, s22
s_mov_b32 s49, s23
s_mov_b32 s50, 2211840
s_lshl_b32 s74, s71, 2
s_add_u32 s74, s74, s3
s_mul_i32 s73, s74, 13108
s_lshr_b32 s73, s73, 16
s_mul_i32 s83, s73, 5
s_sub_u32 s74, s74, s83
s_mul_i32 s73, s73, 54
s_add_u32 s73, s73, s72
s_mul_i32 s73, s73, 5
s_add_u32 s73, s73, s74
s_lshl_b32 s83, s73, 10
s_add_u32 s83, s83, 10117120
s_movk_i32 s84, 5120
s_branch L_rl_done_pre
L_rl_n4_pre:
s_cmp_lt_u32 s33, 191
s_cbranch_scc0 L_rl_done_pre
s_movk_i32 s74, 161
s_mov_b32 s48, s12
s_mov_b32 s49, s13
s_mov_b32 s86, 10
s_movk_i32 s85, 6554
s_mov_b32 s84, 12328960
s_mov_b32 s50, 819200
s_sub_u32 s74, s33, s74
s_mul_i32 s71, s74, 21846
s_lshr_b32 s71, s71, 16
s_mul_i32 s73, s71, 3
s_sub_u32 s73, s74, s73
s_mul_i32 s72, s73, 7
s_cmp_eq_u32 s73, 2
s_cselect_b32 s82, 6, 7
s_lshl_b32 s74, s71, 2
s_add_u32 s74, s74, s3
s_mul_i32 s73, s74, s85
s_lshr_b32 s73, s73, 16
s_mul_i32 s83, s73, s86
s_sub_u32 s74, s74, s83
s_mul_i32 s73, s73, 20
s_add_u32 s73, s73, s72
s_mul_i32 s73, s73, s86
s_add_u32 s73, s73, s74
s_lshl_b32 s83, s73, 10
s_add_u32 s83, s83, s84
s_lshl_b32 s84, s86, 10
s_mov_b32 s85, 0
s_mov_b32 s86, 0
L_rl_done_pre:
s_cmp_eq_u32 s82, 0
s_cselect_b32 s50, 0, s50
s_lshl_b32 s72, s72, 5
s_lshl_b32 s73, s3, 3
s_add_u32 s72, s72, s73
v_lshrrev_b32 v32, 3, v1
v_add_u32 v32, s72, v32
v_mul_lo_u32 v32, v32, s87
v_and_b32 v33, 7, v1
v_lshl_add_u32 v32, v33, 4, v32
s_lshl_b32 s71, s71, 7
v_add_u32 v29, s71, v32
v_lshrrev_b32 v32, 2, v3
v_lshl_add_u32 v32, v2, 2, v32
v_lshlrev_b32 v32, 7, v32
v_and_b32 v33, 3, v3
v_lshl_add_u32 v32, v33, 3, v32
s_lshl_b32 s71, s3, 5
s_add_u32 s71, s71, 73728
v_add_u32 v30, s71, v32
s_mov_b32 s91, 0
s_cmp_eq_u32 s2, 0
s_cbranch_scc0 L_tag_posted
s_memrealtime s[94:95]
s_waitcnt lgkmcnt(0)
s_or_b32 s94, s94, 1
v_mov_b32 v60, s94
v_mov_b32 v61, 0
v_cmp_eq_u32 vcc, 0, v0
s_and_saveexec_b64 s[94:95], vcc
s_cbranch_execz L_tag_skip
global_store_dword v61, v60, s[34:35] sc1
L_tag_skip:
s_mov_b64 exec, s[94:95]
L_tag_posted:
s_waitcnt vmcnt(8) lgkmcnt(0)
s_barrier
s_cmp_eq_u32 s32, 0
s_cbranch_scc1 L_k1_kv
s_cmp_eq_u32 s32, 1
s_cbranch_scc1 L_k1_q
L_k1_w1:
ds_read_b128 a[0:3], v22 offset:0
ds_read_b128 a[4:7], v22 offset:2048
ds_read_b128 a[68:71], v20 offset:0
ds_read_b64_tr_b16 a[16:17], v24 offset:0
ds_read_b64_tr_b16 a[18:19], v24 offset:1280
ds_read_b64_tr_b16 a[56:57], v26 offset:0
ds_read_b64_tr_b16 a[58:59], v26 offset:1280
ds_read_b64_tr_b16 a[20:21], v24 offset:32
ds_read_b64_tr_b16 a[22:23], v24 offset:1312
ds_read_b64_tr_b16 a[24:25], v24 offset:64
ds_read_b64_tr_b16 a[26:27], v24 offset:1344
ds_read_b64_tr_b16 a[60:61], v27 offset:0
ds_read_b64_tr_b16 a[62:63], v27 offset:1280
ds_read_b64_tr_b16 a[28:29], v24 offset:96
ds_read_b64_tr_b16 a[30:31], v24 offset:1376
s_waitcnt lgkmcnt(13)
ds_read_b64_tr_b16 a[32:33], v24 offset:128
ds_read_b64_tr_b16 a[34:35], v24 offset:1408
s_waitcnt lgkmcnt(13)
ds_read_b64_tr_b16 a[64:65], v28 offset:0
ds_read_b64_tr_b16 a[66:67], v28 offset:1280
s_waitcnt lgkmcnt(14)
s_mov_b32 s63, 0
L_loopA_w1:
v_mfma_f32_16x16x32_bf16 v[64:67], a[16:19], a[0:3], v[64:67]
ds_read_b64_tr_b16 a[36:37], v24 offset:160
s_waitcnt lgkmcnt(13)
ds_read_b64_tr_b16 a[38:39], v24 offset:1440
s_add_u32 s68, s68, 36864
v_mfma_f32_16x16x32_bf16 v[104:107], a[16:19], a[4:7], v[104:107]
s_add_u32 m0, s67, s69
s_nop 0
buffer_load_dwordx4 v4, s[36:39], s64 offen offset:0 lds
s_waitcnt lgkmcnt(12)
v_mfma_f32_16x16x32_bf16 v[68:71], a[20:23], a[0:3], v[68:71]
ds_read_b64_tr_b16 a[40:41], v24 offset:192
v_mfma_f32_16x16x32_bf16 v[108:111], a[20:23], a[4:7], v[108:111]
ds_read_b64_tr_b16 a[42:43], v24 offset:1472
v_mfma_f32_16x16x32_bf16 v[144:147], a[68:71], a[0:3], v[144:147]
s_cmp_eq_u32 s68, 147456
s_cselect_b32 s68, 0, s68
v_mfma_f32_16x16x32_bf16 v[148:151], a[68:71], a[4:7], v[148:151]
ds_read_b128 a[8:11], v23 offset:0
s_waitcnt lgkmcnt(13)
v_mfma_f32_16x16x32_bf16 v[72:75], a[24:27], a[0:3], v[72:75]
ds_read_b64_tr_b16 a[44:45], v24 offset:224
ds_read_b64_tr_b16 a[46:47], v24 offset:1504
v_mfma_f32_16x16x32_bf16 v[112:115], a[24:27], a[4:7], v[112:115]
v_add_u32 v22, s68, v13
buffer_load_dwordx4 v5, s[36:39], s64 offen offset:1024 lds
s_waitcnt lgkmcnt(11)
v_mfma_f32_16x16x32_bf16 v[76:79], a[28:31], a[0:3], v[76:79]
ds_read_b64_tr_b16 a[48:49], v24 offset:256
v_mfma_f32_16x16x32_bf16 v[116:119], a[28:31], a[4:7], v[116:119]
ds_read_b64_tr_b16 a[50:51], v24 offset:1536
v_mfma_f32_16x16x32_bf16 v[152:155], a[0:3], a[0:3], v[152:155]
ds_read_b128 a[12:15], v23 offset:2048
v_mfma_f32_16x16x32_bf16 v[156:159], a[4:7], a[4:7], v[156:159]
ds_read_b128 a[72:75], v20 offset:64
s_waitcnt lgkmcnt(13)
v_mfma_f32_16x16x32_bf16 v[80:83], a[32:35], a[0:3], v[80:83]
ds_read_b64_tr_b16 a[52:53], v25 offset:0
ds_read_b64_tr_b16 a[54:55], v25 offset:1280
v_mfma_f32_16x16x32_bf16 v[120:123], a[32:35], a[4:7], v[120:123]
buffer_load_dwordx4 v6, s[36:39], s64 offen offset:2048 lds
s_waitcnt lgkmcnt(11)
v_mfma_f32_16x16x32_bf16 v[84:87], a[36:39], a[0:3], v[84:87]
ds_read_b64_tr_b16 a[16:17], v24 offset:10240
v_mfma_f32_16x16x32_bf16 v[124:127], a[36:39], a[4:7], v[124:127]
ds_read_b64_tr_b16 a[18:19], v24 offset:11520
v_mfma_f32_16x16x32_bf16 v[160:163], a[56:59], a[76:79], v[160:163]
ds_read_b64_tr_b16 a[56:57], v26 offset:10240
ds_read_b64_tr_b16 a[58:59], v26 offset:11520
s_waitcnt lgkmcnt(13)
v_mfma_f32_16x16x32_bf16 v[88:91], a[40:43], a[0:3], v[88:91]
ds_read_b64_tr_b16 a[20:21], v24 offset:10272
ds_read_b64_tr_b16 a[22:23], v24 offset:11552
v_mfma_f32_16x16x32_bf16 v[128:131], a[40:43], a[4:7], v[128:131]
buffer_load_dwordx4 v7, s[36:39], s64 offen offset:3072 lds
s_waitcnt lgkmcnt(12)
v_mfma_f32_16x16x32_bf16 v[92:95], a[44:47], a[0:3], v[92:95]
ds_read_b64_tr_b16 a[24:25], v24 offset:10304
v_mfma_f32_16x16x32_bf16 v[132:135], a[44:47], a[4:7], v[132:135]
ds_read_b64_tr_b16 a[26:27], v24 offset:11584
v_mfma_f32_16x16x32_bf16 v[164:167], a[60:63], a[76:79], v[164:167]
s_add_u32 m0, s67, s70
ds_read_b64_tr_b16 a[60:61], v27 offset:10240
s_waitcnt lgkmcnt(13)
ds_read_b64_tr_b16 a[62:63], v27 offset:11520
v_mfma_f32_16x16x32_bf16 v[96:99], a[48:51], a[0:3], v[96:99]
ds_read_b64_tr_b16 a[28:29], v24 offset:10336
s_waitcnt lgkmcnt(13)
ds_read_b64_tr_b16 a[30:31], v24 offset:11616
v_mfma_f32_16x16x32_bf16 v[136:139], a[48:51], a[4:7], v[136:139]
buffer_load_dwordx4 v8, s[40:43], s65 offen offset:0 lds
s_waitcnt lgkmcnt(12)
v_mfma_f32_16x16x32_bf16 v[100:103], a[52:55], a[0:3], v[100:103]
ds_read_b64_tr_b16 a[32:33], v24 offset:10368
v_mfma_f32_16x16x32_bf16 v[140:143], a[52:55], a[4:7], v[140:143]
ds_read_b64_tr_b16 a[34:35], v24 offset:11648
v_mfma_f32_16x16x32_bf16 v[168:171], a[64:67], a[76:79], v[168:171]
ds_read_b64_tr_b16 a[64:65], v28 offset:10240
s_waitcnt lgkmcnt(13)
ds_read_b64_tr_b16 a[66:67], v28 offset:11520
s_waitcnt vmcnt(6)
s_barrier
v_mfma_f32_16x16x32_bf16 v[64:67], a[16:19], a[8:11], v[64:67]
ds_read_b64_tr_b16 a[36:37], v24 offset:10400
s_waitcnt lgkmcnt(13)
ds_read_b64_tr_b16 a[38:39], v24 offset:11680
v_mfma_f32_16x16x32_bf16 v[104:107], a[16:19], a[12:15], v[104:107]
v_add_u32 v20, v20, v21
s_waitcnt lgkmcnt(12)
v_mfma_f32_16x16x32_bf16 v[68:71], a[20:23], a[8:11], v[68:71]
ds_read_b64_tr_b16 a[40:41], v24 offset:10432
v_mfma_f32_16x16x32_bf16 v[108:111], a[20:23], a[12:15], v[108:111]
ds_read_b64_tr_b16 a[42:43], v24 offset:11712
v_mfma_f32_16x16x32_bf16 v[144:147], a[72:75], a[8:11], v[144:147]
ds_read_b128 a[0:3], v22 offset:0
v_mfma_f32_16x16x32_bf16 v[148:151], a[72:75], a[12:15], v[148:151]
buffer_load_dwordx4 v9, s[40:43], s65 offen offset:1024 lds
s_waitcnt lgkmcnt(13)
v_mfma_f32_16x16x32_bf16 v[72:75], a[24:27], a[8:11], v[72:75]
ds_read_b64_tr_b16 a[44:45], v24 offset:10464
ds_read_b64_tr_b16 a[46:47], v24 offset:11744
v_mfma_f32_16x16x32_bf16 v[112:115], a[24:27], a[12:15], v[112:115]
v_add_u32 v26, s68, v17
s_waitcnt lgkmcnt(11)
v_mfma_f32_16x16x32_bf16 v[76:79], a[28:31], a[8:11], v[76:79]
ds_read_b64_tr_b16 a[48:49], v24 offset:10496
ds_read_b64_tr_b16 a[50:51], v24 offset:11776
v_mfma_f32_16x16x32_bf16 v[116:119], a[28:31], a[12:15], v[116:119]
ds_read_b128 a[4:7], v22 offset:2048
v_add_u32 v27, s68, v18
v_mfma_f32_16x16x32_bf16 v[152:155], a[8:11], a[8:11], v[152:155]
ds_read_b128 a[68:71], v20 offset:0
buffer_load_dwordx4 v10, s[40:43], s65 offen offset:2048 lds
v_mfma_f32_16x16x32_bf16 v[156:159], a[12:15], a[12:15], v[156:159]
s_waitcnt lgkmcnt(13)
v_mfma_f32_16x16x32_bf16 v[80:83], a[32:35], a[8:11], v[80:83]
ds_read_b64_tr_b16 a[52:53], v25 offset:10240
ds_read_b64_tr_b16 a[54:55], v25 offset:11520
v_mfma_f32_16x16x32_bf16 v[120:123], a[32:35], a[12:15], v[120:123]
v_add_u32 v23, s68, v14
v_add_u32 v28, s68, v19
s_waitcnt lgkmcnt(11)
v_mfma_f32_16x16x32_bf16 v[84:87], a[36:39], a[8:11], v[84:87]
v_add_u32 v24, s68, v15
v_mfma_f32_16x16x32_bf16 v[124:127], a[36:39], a[12:15], v[124:127]
ds_read_b64_tr_b16 a[16:17], v24 offset:0
v_mfma_f32_16x16x32_bf16 v[160:163], a[56:59], a[76:79], v[160:163]
ds_read_b64_tr_b16 a[18:19], v24 offset:1280
ds_read_b64_tr_b16 a[56:57], v26 offset:0
ds_read_b64_tr_b16 a[58:59], v26 offset:1280
s_waitcnt lgkmcnt(13)
v_mfma_f32_16x16x32_bf16 v[88:91], a[40:43], a[8:11], v[88:91]
ds_read_b64_tr_b16 a[20:21], v24 offset:32
ds_read_b64_tr_b16 a[22:23], v24 offset:1312
v_mfma_f32_16x16x32_bf16 v[128:131], a[40:43], a[12:15], v[128:131]
v_add_u32 v25, s68, v16
buffer_load_dwordx4 v11, s[40:43], s65 offen offset:3072 lds
s_waitcnt lgkmcnt(12)
v_mfma_f32_16x16x32_bf16 v[92:95], a[44:47], a[8:11], v[92:95]
ds_read_b64_tr_b16 a[24:25], v24 offset:64
v_mfma_f32_16x16x32_bf16 v[132:135], a[44:47], a[12:15], v[132:135]
ds_read_b64_tr_b16 a[26:27], v24 offset:1344
v_mfma_f32_16x16x32_bf16 v[164:167], a[60:63], a[76:79], v[164:167]
s_add_u32 m0, s67, s89
ds_read_b64_tr_b16 a[60:61], v27 offset:0
s_waitcnt lgkmcnt(13)
ds_read_b64_tr_b16 a[62:63], v27 offset:1280
v_mfma_f32_16x16x32_bf16 v[96:99], a[48:51], a[8:11], v[96:99]
ds_read_b64_tr_b16 a[28:29], v24 offset:96
s_waitcnt lgkmcnt(13)
ds_read_b64_tr_b16 a[30:31], v24 offset:1376
v_mfma_f32_16x16x32_bf16 v[136:139], a[48:51], a[12:15], v[136:139]
buffer_load_dwordx4 v12, s[40:43], s65 offen lds
s_waitcnt lgkmcnt(12)
v_mfma_f32_16x16x32_bf16 v[100:103], a[52:55], a[8:11], v[100:103]
ds_read_b64_tr_b16 a[32:33], v24 offset:128
ds_read_b64_tr_b16 a[34:35], v24 offset:1408
v_mfma_f32_16x16x32_bf16 v[140:143], a[52:55], a[12:15], v[140:143]
buffer_load_dword v51, v29, s[48:51], s91 offen
s_lshl_b32 s74, s87, 5
s_add_u32 s91, s91, s74
s_add_u32 s64, s64, 128
s_add_u32 s65, s65, s66
s_add_u32 s67, s67, 36864
s_cmp_eq_u32 s67, 147456
s_cselect_b32 s67, 0, s67
v_mfma_f32_16x16x32_bf16 v[168:171], a[64:67], a[76:79], v[168:171]
ds_read_b64_tr_b16 a[64:65], v28 offset:0
s_waitcnt lgkmcnt(13)
ds_read_b64_tr_b16 a[66:67], v28 offset:1280
s_add_u32 s63, s63, 1
s_cmp_lt_u32 s63, 8
s_cbranch_scc1 L_loopA_w1
v_mov_b32 v63, 0
global_load_dword v59, v63, s[34:35] sc1
s_getpc_b64 s[96:97]
L_pfr_L_code_p2_1:
s_add_u32 s96, s96, L_code_p2 - L_pfr_L_code_p2_1
s_addc_u32 s97, s97, 0
v_lshrrev_b32 v62, 6, v0
v_and_b32 v61, 0, v0
v_mad_u32_u24 v62, v62, 1, v61
s_lshr_b32 s95, s2, 3
s_mul_i32 s95, s95, 4
v_add_u32 v62, s95, v62
v_min_u32 v62, (L_code_p3 - L_code_p2) >> 7, v62
v_lshlrev_b32 v62, 7, v62
global_load_dword v55, v62, s[96:97]
s_lshl_b32 s73, s3, 10
s_add_u32 s73, s73, 73728
s_lshl_b32 s74, s87, 5
s_mov_b32 s88, 0
s_add_u32 m0, s73, 0
s_nop 0
buffer_load_dwordx4 v29, s[48:51], s88 offen lds
s_add_u32 m0, s73, 4096
s_add_u32 s88, s88, s74
buffer_load_dwordx4 v29, s[48:51], s88 offen lds
s_add_u32 m0, s73, 8192
s_add_u32 s88, s88, s74
buffer_load_dwordx4 v29, s[48:51], s88 offen lds
s_add_u32 m0, s73, 12288
s_add_u32 s88, s88, s74
buffer_load_dwordx4 v29, s[48:51], s88 offen lds
s_add_u32 m0, s73, 16384
s_add_u32 s88, s88, s74
buffer_load_dwordx4 v29, s[48:51], s88 offen lds
s_add_u32 m0, s73, 20480
s_add_u32 s88, s88, s74
buffer_load_dwordx4 v29, s[48:51], s88 offen lds
s_add_u32 m0, s73, 24576
s_add_u32 s88, s88, s74
buffer_load_dwordx4 v29, s[48:51], s88 offen lds
L_loopB_w1:
v_mfma_f32_16x16x32_bf16 v[64:67], a[16:19], a[0:3], v[64:67]
ds_read_b64_tr_b16 a[36:37], v24 offset:160
s_waitcnt lgkmcnt(13)
ds_read_b64_tr_b16 a[38:39], v24 offset:1440
v_mfma_f32_16x16x32_bf16 v[104:107], a[16:19], a[4:7], v[104:107]
s_add_u32 s68, s68, 36864
s_waitcnt lgkmcnt(12)
v_mfma_f32_16x16x32_bf16 v[68:71], a[20:23], a[0:3], v[68:71]
ds_read_b64_tr_b16 a[40:41], v24 offset:192
v_mfma_f32_16x16x32_bf16 v[108:111], a[20:23], a[4:7], v[108:111]
ds_read_b64_tr_b16 a[42:43], v24 offset:1472
v_mfma_f32_16x16x32_bf16 v[144:147], a[68:71], a[0:3], v[144:147]
s_cmp_eq_u32 s68, 147456
s_cselect_b32 s68, 0, s68
v_mfma_f32_16x16x32_bf16 v[148:151], a[68:71], a[4:7], v[148:151]
ds_read_b128 a[8:11], v23 offset:0
s_waitcnt lgkmcnt(13)
v_mfma_f32_16x16x32_bf16 v[72:75], a[24:27], a[0:3], v[72:75]
ds_read_b64_tr_b16 a[44:45], v24 offset:224
ds_read_b64_tr_b16 a[46:47], v24 offset:1504
v_mfma_f32_16x16x32_bf16 v[112:115], a[24:27], a[4:7], v[112:115]
v_add_u32 v22, s68, v13
s_waitcnt lgkmcnt(11)
v_mfma_f32_16x16x32_bf16 v[76:79], a[28:31], a[0:3], v[76:79]
ds_read_b64_tr_b16 a[48:49], v24 offset:256
v_mfma_f32_16x16x32_bf16 v[116:119], a[28:31], a[4:7], v[116:119]
ds_read_b64_tr_b16 a[50:51], v24 offset:1536
v_mfma_f32_16x16x32_bf16 v[152:155], a[0:3], a[0:3], v[152:155]
ds_read_b128 a[12:15], v23 offset:2048
v_mfma_f32_16x16x32_bf16 v[156:159], a[4:7], a[4:7], v[156:159]
ds_read_b128 a[72:75], v20 offset:64
s_waitcnt lgkmcnt(13)
v_mfma_f32_16x16x32_bf16 v[80:83], a[32:35], a[0:3], v[80:83]
ds_read_b64_tr_b16 a[52:53], v25 offset:0
v_mfma_f32_16x16x32_bf16 v[120:123], a[32:35], a[4:7], v[120:123]
ds_read_b64_tr_b16 a[54:55], v25 offset:1280
s_waitcnt lgkmcnt(11)
v_mfma_f32_16x16x32_bf16 v[84:87], a[36:39], a[0:3], v[84:87]
ds_read_b64_tr_b16 a[16:17], v24 offset:10240
v_mfma_f32_16x16x32_bf16 v[124:127], a[36:39], a[4:7], v[124:127]
ds_read_b64_tr_b16 a[18:19], v24 offset:11520
v_mfma_f32_16x16x32_bf16 v[160:163], a[56:59], a[76:79], v[160:163]
ds_read_b64_tr_b16 a[56:57], v26 offset:10240
ds_read_b64_tr_b16 a[58:59], v26 offset:11520
s_waitcnt lgkmcnt(13)
v_mfma_f32_16x16x32_bf16 v[88:91], a[40:43], a[0:3], v[88:91]
ds_read_b64_tr_b16 a[20:21], v24 offset:10272
v_mfma_f32_16x16x32_bf16 v[128:131], a[40:43], a[4:7], v[128:131]
ds_read_b64_tr_b16 a[22:23], v24 offset:11552
s_waitcnt lgkmcnt(12)
v_mfma_f32_16x16x32_bf16 v[92:95], a[44:47], a[0:3], v[92:95]
ds_read_b64_tr_b16 a[24:25], v24 offset:10304
v_mfma_f32_16x16x32_bf16 v[132:135], a[44:47], a[4:7], v[132:135]
ds_read_b64_tr_b16 a[26:27], v24 offset:11584
v_mfma_f32_16x16x32_bf16 v[164:167], a[60:63], a[76:79], v[164:167]
ds_read_b64_tr_b16 a[60:61], v27 offset:10240
s_waitcnt lgkmcnt(13)
ds_read_b64_tr_b16 a[62:63], v27 offset:11520
v_mfma_f32_16x16x32_bf16 v[96:99], a[48:51], a[0:3], v[96:99]
ds_read_b64_tr_b16 a[28:29], v24 offset:10336
v_mfma_f32_16x16x32_bf16 v[136:139], a[48:51], a[4:7], v[136:139]
s_waitcnt lgkmcnt(13)
ds_read_b64_tr_b16 a[30:31], v24 offset:11616
s_waitcnt lgkmcnt(12)
v_mfma_f32_16x16x32_bf16 v[100:103], a[52:55], a[0:3], v[100:103]
ds_read_b64_tr_b16 a[32:33], v24 offset:10368
v_mfma_f32_16x16x32_bf16 v[140:143], a[52:55], a[4:7], v[140:143]
ds_read_b64_tr_b16 a[34:35], v24 offset:11648
v_mfma_f32_16x16x32_bf16 v[168:171], a[64:67], a[76:79], v[168:171]
ds_read_b64_tr_b16 a[64:65], v28 offset:10240
s_waitcnt lgkmcnt(13)
ds_read_b64_tr_b16 a[66:67], v28 offset:11520
s_cmp_eq_u32 s63, 8
s_cbranch_scc0 L_wd_w1_b
s_waitcnt vmcnt(7)
L_wd_w1_b:
s_barrier
v_mfma_f32_16x16x32_bf16 v[64:67], a[16:19], a[8:11], v[64:67]
ds_read_b64_tr_b16 a[36:37], v24 offset:10400
s_waitcnt lgkmcnt(13)
ds_read_b64_tr_b16 a[38:39], v24 offset:11680
v_mfma_f32_16x16x32_bf16 v[104:107], a[16:19], a[12:15], v[104:107]
v_add_u32 v20, v20, v21
s_waitcnt lgkmcnt(12)
v_mfma_f32_16x16x32_bf16 v[68:71], a[20:23], a[8:11], v[68:71]
ds_read_b64_tr_b16 a[40:41], v24 offset:10432
v_mfma_f32_16x16x32_bf16 v[108:111], a[20:23], a[12:15], v[108:111]
ds_read_b64_tr_b16 a[42:43], v24 offset:11712
v_mfma_f32_16x16x32_bf16 v[144:147], a[72:75], a[8:11], v[144:147]
ds_read_b128 a[0:3], v22 offset:0
v_mfma_f32_16x16x32_bf16 v[148:151], a[72:75], a[12:15], v[148:151]
s_waitcnt lgkmcnt(13)
v_mfma_f32_16x16x32_bf16 v[72:75], a[24:27], a[8:11], v[72:75]
ds_read_b64_tr_b16 a[44:45], v24 offset:10464
ds_read_b64_tr_b16 a[46:47], v24 offset:11744
v_mfma_f32_16x16x32_bf16 v[112:115], a[24:27], a[12:15], v[112:115]
v_add_u32 v26, s68, v17
s_waitcnt lgkmcnt(11)
v_mfma_f32_16x16x32_bf16 v[76:79], a[28:31], a[8:11], v[76:79]
ds_read_b64_tr_b16 a[48:49], v24 offset:10496
ds_read_b64_tr_b16 a[50:51], v24 offset:11776
v_mfma_f32_16x16x32_bf16 v[116:119], a[28:31], a[12:15], v[116:119]
ds_read_b128 a[4:7], v22 offset:2048
v_add_u32 v27, s68, v18
v_mfma_f32_16x16x32_bf16 v[152:155], a[8:11], a[8:11], v[152:155]
ds_read_b128 a[68:71], v20 offset:0
v_mfma_f32_16x16x32_bf16 v[156:159], a[12:15], a[12:15], v[156:159]
s_waitcnt lgkmcnt(13)
v_mfma_f32_16x16x32_bf16 v[80:83], a[32:35], a[8:11], v[80:83]
ds_read_b64_tr_b16 a[52:53], v25 offset:10240
ds_read_b64_tr_b16 a[54:55], v25 offset:11520
v_mfma_f32_16x16x32_bf16 v[120:123], a[32:35], a[12:15], v[120:123]
v_add_u32 v23, s68, v14
v_add_u32 v28, s68, v19
s_waitcnt lgkmcnt(11)
v_mfma_f32_16x16x32_bf16 v[84:87], a[36:39], a[8:11], v[84:87]
v_add_u32 v24, s68, v15
v_mfma_f32_16x16x32_bf16 v[124:127], a[36:39], a[12:15], v[124:127]
ds_read_b64_tr_b16 a[16:17], v24 offset:0
v_mfma_f32_16x16x32_bf16 v[160:163], a[56:59], a[76:79], v[160:163]
ds_read_b64_tr_b16 a[18:19], v24 offset:1280
ds_read_b64_tr_b16 a[56:57], v26 offset:0
ds_read_b64_tr_b16 a[58:59], v26 offset:1280
s_waitcnt lgkmcnt(13)
v_mfma_f32_16x16x32_bf16 v[88:91], a[40:43], a[8:11], v[88:91]
ds_read_b64_tr_b16 a[20:21], v24 offset:32
ds_read_b64_tr_b16 a[22:23], v24 offset:1312
v_mfma_f32_16x16x32_bf16 v[128:131], a[40:43], a[12:15], v[128:131]
v_add_u32 v25, s68, v16
s_waitcnt lgkmcnt(12)
v_mfma_f32_16x16x32_bf16 v[92:95], a[44:47], a[8:11], v[92:95]
ds_read_b64_tr_b16 a[24:25], v24 offset:64
v_mfma_f32_16x16x32_bf16 v[132:135], a[44:47], a[12:15], v[132:135]
ds_read_b64_tr_b16 a[26:27], v24 offset:1344
v_mfma_f32_16x16x32_bf16 v[164:167], a[60:63], a[76:79], v[164:167]
ds_read_b64_tr_b16 a[60:61], v27 offset:0
s_waitcnt lgkmcnt(13)
ds_read_b64_tr_b16 a[62:63], v27 offset:1280
v_mfma_f32_16x16x32_bf16 v[96:99], a[48:51], a[8:11], v[96:99]
ds_read_b64_tr_b16 a[28:29], v24 offset:96
v_mfma_f32_16x16x32_bf16 v[136:139], a[48:51], a[12:15], v[136:139]
s_waitcnt lgkmcnt(13)
ds_read_b64_tr_b16 a[30:31], v24 offset:1376
s_waitcnt lgkmcnt(12)
v_mfma_f32_16x16x32_bf16 v[100:103], a[52:55], a[8:11], v[100:103]
ds_read_b64_tr_b16 a[32:33], v24 offset:128
v_mfma_f32_16x16x32_bf16 v[140:143], a[52:55], a[12:15], v[140:143]
ds_read_b64_tr_b16 a[34:35], v24 offset:1408
v_mfma_f32_16x16x32_bf16 v[168:171], a[64:67], a[76:79], v[168:171]
ds_read_b64_tr_b16 a[64:65], v28 offset:0
s_waitcnt lgkmcnt(13)
ds_read_b64_tr_b16 a[66:67], v28 offset:1280
s_add_u32 s63, s63, 1
s_cmp_lt_u32 s63, 10
s_cbranch_scc1 L_loopB_w1
s_waitcnt vmcnt(0) lgkmcnt(0)
s_barrier
s_cmp_eq_u32 s82, 0
s_cbranch_scc1 L_rls_done_w1
ds_read_b64_tr_b16 v[172:173], v30 offset:0
ds_read_b64_tr_b16 v[174:175], v30 offset:2048
ds_read_b64_tr_b16 v[176:177], v30 offset:4096
ds_read_b64_tr_b16 v[178:179], v30 offset:6144
ds_read_b64_tr_b16 v[180:181], v30 offset:8192
ds_read_b64_tr_b16 v[182:183], v30 offset:10240
ds_read_b64_tr_b16 v[184:185], v30 offset:12288
ds_read_b64_tr_b16 v[186:187], v30 offset:14336
ds_read_b64_tr_b16 v[188:189], v30 offset:16384
ds_read_b64_tr_b16 v[190:191], v30 offset:18432
ds_read_b64_tr_b16 v[192:193], v30 offset:20480
ds_read_b64_tr_b16 v[194:195], v30 offset:22528
ds_read_b64_tr_b16 v[196:197], v30 offset:24576
ds_read_b64_tr_b16 v[198:199], v30 offset:26624
v_mov_b32 v36, 0
v_mov_b32 v37, 0x3f803f80
s_waitcnt lgkmcnt(12)
buffer_store_dwordx4 v[172:175], v31, s[44:47], s83 offen sc1
s_add_u32 s83, s83, s84
s_waitcnt lgkmcnt(10)
buffer_store_dwordx4 v[176:179], v31, s[44:47], s83 offen sc1
s_add_u32 s83, s83, s84
s_waitcnt lgkmcnt(8)
buffer_store_dwordx4 v[180:183], v31, s[44:47], s83 offen sc1
s_add_u32 s83, s83, s84
s_waitcnt lgkmcnt(6)
buffer_store_dwordx4 v[184:187], v31, s[44:47], s83 offen sc1
s_add_u32 s83, s83, s84
s_waitcnt lgkmcnt(4)
buffer_store_dwordx4 v[188:191], v31, s[44:47], s83 offen sc1
s_add_u32 s83, s83, s84
s_cmp_le_u32 s82, 5
s_cbranch_scc1 L_rls_st_done_w1
s_waitcnt lgkmcnt(2)
buffer_store_dwordx4 v[192:195], v31, s[44:47], s83 offen sc1
s_add_u32 s83, s83, s84
s_cmp_le_u32 s82, 6
s_cbranch_scc1 L_rls_st_done_w1
s_waitcnt lgkmcnt(0)
buffer_store_dwordx4 v[196:199], v31, s[44:47], s83 offen sc1
s_add_u32 s83, s83, s84
L_rls_st_done_w1:
s_waitcnt lgkmcnt(0)
s_cmp_eq_u32 s85, 0
s_cbranch_scc1 L_rls_done_w1
v_mov_b32 v40, 0
v_mov_b32 v41, 0
v_mov_b32 v42, 0
v_dot2_f32_bf16 v36, v172, v37, v36
v_dot2_f32_bf16 v40, v173, v37, v40
v_dot2_f32_bf16 v41, v174, v37, v41
v_dot2_f32_bf16 v42, v175, v37, v42
v_dot2_f32_bf16 v36, v176, v37, v36
v_dot2_f32_bf16 v40, v177, v37, v40
v_dot2_f32_bf16 v41, v178, v37, v41
v_dot2_f32_bf16 v42, v179, v37, v42
v_dot2_f32_bf16 v36, v180, v37, v36
v_dot2_f32_bf16 v40, v181, v37, v40
v_dot2_f32_bf16 v41, v182, v37, v41
v_dot2_f32_bf16 v42, v183, v37, v42
v_dot2_f32_bf16 v36, v184, v37, v36
v_dot2_f32_bf16 v40, v185, v37, v40
v_dot2_f32_bf16 v41, v186, v37, v41
v_dot2_f32_bf16 v42, v187, v37, v42
v_dot2_f32_bf16 v36, v188, v37, v36
v_dot2_f32_bf16 v40, v189, v37, v40
v_dot2_f32_bf16 v41, v190, v37, v41
v_dot2_f32_bf16 v42, v191, v37, v42
v_dot2_f32_bf16 v36, v192, v37, v36
v_dot2_f32_bf16 v40, v193, v37, v40
v_dot2_f32_bf16 v41, v194, v37, v41
v_dot2_f32_bf16 v42, v195, v37, v42
v_dot2_f32_bf16 v36, v196, v37, v36
v_dot2_f32_bf16 v40, v197, v37, v40
v_dot2_f32_bf16 v41, v198, v37, v41
v_dot2_f32_bf16 v42, v199, v37, v42
s_nop 2
v_add_f32 v36, v36, v40
v_add_f32 v41, v41, v42
v_add_f32 v36, v36, v41
v_mov_b32 v39, v36
s_nop 1
v_permlane32_swap_b32 v36, v39
s_nop 1
v_add_f32 v36, v36, v39
v_mov_b32 v39, v36
s_nop 1
v_permlane16_swap_b32 v36, v39
s_nop 1
v_add_f32 v36, v36, v39
v_lshlrev_b32 v39, 2, v1
v_cmp_gt_u32 vcc, 16, v1
s_and_saveexec_b64 s[76:77], vcc
buffer_store_dword v36, v39, s[44:47], s86 offen sc1
s_mov_b64 exec, s[76:77]
L_rls_done_w1:
s_nop 1
v_lshlrev_b32 v32, 4, v2
s_lshl_b32 s71, s3, 6
s_add_u32 s71, s71, 154112
v_add_u32 v32, s71, v32
v_cmp_eq_u32 vcc, 0, v3
s_and_saveexec_b64 s[76:77], vcc
ds_write_b128 v32, v[160:163]
ds_write_b128 v32, v[164:167] offset:256
ds_write_b128 v32, v[168:171] offset:512
s_mov_b64 exec, s[76:77]
v_and_b32 v33, 3, v3
v_cmp_eq_u32 s[76:77], 1, v33
v_cmp_eq_u32 s[78:79], 2, v33
v_cmp_eq_u32 s[80:81], 3, v33
v_lshrrev_b32 v34, 2, v3
v_lshlrev_b32 v34, 4, v34
v_add_u32 v34, v34, v3
v_lshlrev_b32 v34, 2, v34
v_lshlrev_b32 v35, 2, v3
v_cndmask_b32 v36, v152, v153, s[76:77]
v_cndmask_b32 v36, v36, v154, s[78:79]
v_cndmask_b32 v36, v36, v155, s[80:81]
ds_bpermute_b32 v37, v34, v36
ds_bpermute_b32 v38, v35, v144
s_nop 0
v_cndmask_b32 v36, v156, v157, s[76:77]
v_cndmask_b32 v36, v36, v158, s[78:79]
v_cndmask_b32 v36, v36, v159, s[80:81]
ds_bpermute_b32 v39, v34, v36
ds_bpermute_b32 v40, v35, v148
s_nop 0
s_waitcnt lgkmcnt(0)
s_barrier
v_lshlrev_b32 v32, 4, v2
v_add_u32 v32, 154112, v32
ds_read_b128 v[184:187], v32 offset:0
ds_read_b128 v[188:191], v32 offset:64
ds_read_b128 v[192:195], v32 offset:128
ds_read_b128 v[196:199], v32 offset:192
ds_read_b128 v[200:203], v32 offset:256
ds_read_b128 v[204:207], v32 offset:320
ds_read_b128 v[208:211], v32 offset:384
ds_read_b128 v[212:215], v32 offset:448
ds_read_b128 v[216:219], v32 offset:512
ds_read_b128 v[220:223], v32 offset:576
v_mul_f32 v172, 0xbacccccd, v38
v_mul_f32 v42, 0x3acccccd, v37
v_fma_f32 v42, -v172, v172, v42
v_max_f32 v42, 0, v42
v_add_f32 v42, 0x3727c5ac, v42
v_rsq_f32 v174, v42
v_mov_b32 v173, v172
v_mov_b32 v175, v174
v_mul_f32 v176, 0xbacccccd, v40
v_mul_f32 v42, 0x3acccccd, v39
v_fma_f32 v42, -v176, v176, v42
v_max_f32 v42, 0, v42
v_add_f32 v42, 0x3727c5ac, v42
v_rsq_f32 v178, v42
v_mov_b32 v177, v176
v_mov_b32 v179, v178
s_cmp_lg_u32 s31, 0
s_cbranch_scc1 L_w1_nogate
s_lshl_b32 s71, s30, 7
s_lshl_b32 s72, s3, 5
s_add_u32 s71, s71, s72
s_lshl_b32 s71, s71, 2
s_add_u32 s71, s71, 7077888
v_mul_f32 v44, 0xbfb8aa3b, v144
v_mul_f32 v45, 0xbfb8aa3b, v148
v_exp_f32 v44, v44
v_exp_f32 v45, v45
s_nop 0
v_add_f32 v44, 1.0, v44
v_add_f32 v45, 1.0, v45
v_rcp_f32 v44, v44
v_rcp_f32 v45, v45
v_lshlrev_b32 v46, 2, v3
v_cmp_eq_u32 vcc, 2, v2
s_and_saveexec_b64 s[76:77], vcc
buffer_store_dword v44, v46, s[44:47], s71 offen offset:0 sc1
buffer_store_dword v45, v46, s[44:47], s71 offen offset:64 sc1
s_mov_b64 exec, s[76:77]
L_w1_nogate:
v_mov_b32 v180, 0xc0135761
v_mov_b32 v181, 0xc0135761
v_mov_b32 v182, 0xbdd2d3e8
v_mov_b32 v183, 0xbdd2d3e8
s_waitcnt lgkmcnt(0)
s_lshr_b32 s71, s31, 1
s_add_u32 s71, s71, 1
s_and_b32 s72, s31, 1
s_sub_u32 s73, 0, s71
s_cmp_eq_u32 s72, 0
s_cselect_b32 s74, s71, s73
v_add_u32 v32, s74, v3
v_ashrrev_i32 v33, 4, v32
v_and_b32 v32, 15, v32
v_lshlrev_b32 v32, 4, v32
v_lshl_add_u32 v32, v2, 8, v32
s_lshl_b32 s71, s30, 3
s_lshl_b32 s72, s3, 1
s_add_u32 s71, s71, s72
v_add_u32 v33, s71, v33
s_movk_i32 s73, 20480
v_add_u32 v34, 0, v33
v_cmp_gt_i32 vcc, 0, v34
v_mul_lo_u32 v34, v34, s73
v_add_u32 v34, v34, v32
v_mov_b32 v35, 0x80000000
v_cndmask_b32 v36, v34, v35, vcc
v_add_u32 v34, 1, v33
v_cmp_gt_i32 vcc, 0, v34
v_mul_lo_u32 v34, v34, s73
v_add_u32 v34, v34, v32
v_mov_b32 v35, 0x80000000
v_cndmask_b32 v37, v34, v35, vcc
s_mul_i32 s72, s31, 5120
v_pk_fma_f32 v[64:65], v[184:185], v[172:173], v[64:65]
v_pk_fma_f32 v[66:67], v[186:187], v[172:173], v[66:67]
v_pk_fma_f32 v[68:69], v[188:189], v[172:173], v[68:69]
v_pk_fma_f32 v[70:71], v[190:191], v[172:173], v[70:71]
v_pk_mul_f32 v[64:65], v[64:65], v[174:175]
v_pk_mul_f32 v[66:67], v[66:67], v[174:175]
v_pk_mul_f32 v[68:69], v[68:69], v[174:175]
v_pk_mul_f32 v[70:71], v[70:71], v[174:175]
v_pk_mul_f32 v[244:245], v[64:65], v[64:65]
v_pk_mul_f32 v[246:247], v[66:67], v[66:67]
v_pk_mul_f32 v[248:249], v[68:69], v[68:69]
v_pk_mul_f32 v[250:251], v[70:71], v[70:71]
v_pk_fma_f32 v[244:245], v[244:245], v[182:183], v[180:181]
v_pk_fma_f32 v[246:247], v[246:247], v[182:183], v[180:181]
v_pk_fma_f32 v[248:249], v[248:249], v[182:183], v[180:181]
v_pk_fma_f32 v[250:251], v[250:251], v[182:183], v[180:181]
v_pk_mul_f32 v[244:245], v[244:245], v[64:65]
v_pk_mul_f32 v[246:247], v[246:247], v[66:67]
v_pk_mul_f32 v[248:249], v[248:249], v[68:69]
v_pk_mul_f32 v[250:251], v[250:251], v[70:71]
v_exp_f32 v244, v244
v_exp_f32 v245, v245
v_exp_f32 v246, v246
v_exp_f32 v247, v247
v_exp_f32 v248, v248
v_exp_f32 v249, v249
v_exp_f32 v250, v250
v_exp_f32 v251, v251
v_pk_add_f32 v[244:245], v[244:245], 1.0 op_sel_hi:[1,0]
v_pk_add_f32 v[246:247], v[246:247], 1.0 op_sel_hi:[1,0]
v_pk_add_f32 v[248:249], v[248:249], 1.0 op_sel_hi:[1,0]
v_pk_add_f32 v[250:251], v[250:251], 1.0 op_sel_hi:[1,0]
v_rcp_f32 v244, v244
v_rcp_f32 v245, v245
v_rcp_f32 v246, v246
v_rcp_f32 v247, v247
v_rcp_f32 v248, v248
v_rcp_f32 v249, v249
v_rcp_f32 v250, v250
v_rcp_f32 v251, v251
v_pk_mul_f32 v[64:65], v[64:65], v[244:245]
v_pk_mul_f32 v[66:67], v[66:67], v[246:247]
v_pk_mul_f32 v[68:69], v[68:69], v[248:249]
v_pk_mul_f32 v[70:71], v[70:71], v[250:251]
v_cvt_pk_bf16_f32 v224, v64, v65
v_cvt_pk_bf16_f32 v225, v66, v67
v_cvt_pk_bf16_f32 v226, v68, v69
v_cvt_pk_bf16_f32 v227, v70, v71
s_add_u32 s73, s72, 0
buffer_store_dwordx4 v[224:227], v36, s[52:55], s73 offen sc1
v_pk_fma_f32 v[72:73], v[192:193], v[172:173], v[72:73]
v_pk_fma_f32 v[74:75], v[194:195], v[172:173], v[74:75]
v_pk_fma_f32 v[76:77], v[196:197], v[172:173], v[76:77]
v_pk_fma_f32 v[78:79], v[198:199], v[172:173], v[78:79]
v_pk_mul_f32 v[72:73], v[72:73], v[174:175]
v_pk_mul_f32 v[74:75], v[74:75], v[174:175]
v_pk_mul_f32 v[76:77], v[76:77], v[174:175]
v_pk_mul_f32 v[78:79], v[78:79], v[174:175]
v_pk_mul_f32 v[244:245], v[72:73], v[72:73]
v_pk_mul_f32 v[246:247], v[74:75], v[74:75]
v_pk_mul_f32 v[248:249], v[76:77], v[76:77]
v_pk_mul_f32 v[250:251], v[78:79], v[78:79]
v_pk_fma_f32 v[244:245], v[244:245], v[182:183], v[180:181]
v_pk_fma_f32 v[246:247], v[246:247], v[182:183], v[180:181]
v_pk_fma_f32 v[248:249], v[248:249], v[182:183], v[180:181]
v_pk_fma_f32 v[250:251], v[250:251], v[182:183], v[180:181]
v_pk_mul_f32 v[244:245], v[244:245], v[72:73]
v_pk_mul_f32 v[246:247], v[246:247], v[74:75]
v_pk_mul_f32 v[248:249], v[248:249], v[76:77]
v_pk_mul_f32 v[250:251], v[250:251], v[78:79]
v_exp_f32 v244, v244
v_exp_f32 v245, v245
v_exp_f32 v246, v246
v_exp_f32 v247, v247
v_exp_f32 v248, v248
v_exp_f32 v249, v249
v_exp_f32 v250, v250
v_exp_f32 v251, v251
v_pk_add_f32 v[244:245], v[244:245], 1.0 op_sel_hi:[1,0]
v_pk_add_f32 v[246:247], v[246:247], 1.0 op_sel_hi:[1,0]
v_pk_add_f32 v[248:249], v[248:249], 1.0 op_sel_hi:[1,0]
v_pk_add_f32 v[250:251], v[250:251], 1.0 op_sel_hi:[1,0]
v_rcp_f32 v244, v244
v_rcp_f32 v245, v245
v_rcp_f32 v246, v246
v_rcp_f32 v247, v247
v_rcp_f32 v248, v248
v_rcp_f32 v249, v249
v_rcp_f32 v250, v250
v_rcp_f32 v251, v251
v_pk_mul_f32 v[72:73], v[72:73], v[244:245]
v_pk_mul_f32 v[74:75], v[74:75], v[246:247]
v_pk_mul_f32 v[76:77], v[76:77], v[248:249]
v_pk_mul_f32 v[78:79], v[78:79], v[250:251]
v_cvt_pk_bf16_f32 v228, v72, v73
v_cvt_pk_bf16_f32 v229, v74, v75
v_cvt_pk_bf16_f32 v230, v76, v77
v_cvt_pk_bf16_f32 v231, v78, v79
s_add_u32 s73, s72, 1024
buffer_store_dwordx4 v[228:231], v36, s[52:55], s73 offen sc1
v_pk_fma_f32 v[80:81], v[200:201], v[172:173], v[80:81]
v_pk_fma_f32 v[82:83], v[202:203], v[172:173], v[82:83]
v_pk_fma_f32 v[84:85], v[204:205], v[172:173], v[84:85]
v_pk_fma_f32 v[86:87], v[206:207], v[172:173], v[86:87]
v_pk_mul_f32 v[80:81], v[80:81], v[174:175]
v_pk_mul_f32 v[82:83], v[82:83], v[174:175]
v_pk_mul_f32 v[84:85], v[84:85], v[174:175]
v_pk_mul_f32 v[86:87], v[86:87], v[174:175]
v_pk_mul_f32 v[244:245], v[80:81], v[80:81]
v_pk_mul_f32 v[246:247], v[82:83], v[82:83]
v_pk_mul_f32 v[248:249], v[84:85], v[84:85]
v_pk_mul_f32 v[250:251], v[86:87], v[86:87]
v_pk_fma_f32 v[244:245], v[244:245], v[182:183], v[180:181]
v_pk_fma_f32 v[246:247], v[246:247], v[182:183], v[180:181]
v_pk_fma_f32 v[248:249], v[248:249], v[182:183], v[180:181]
v_pk_fma_f32 v[250:251], v[250:251], v[182:183], v[180:181]
v_pk_mul_f32 v[244:245], v[244:245], v[80:81]
v_pk_mul_f32 v[246:247], v[246:247], v[82:83]
v_pk_mul_f32 v[248:249], v[248:249], v[84:85]
v_pk_mul_f32 v[250:251], v[250:251], v[86:87]
v_exp_f32 v244, v244
v_exp_f32 v245, v245
v_exp_f32 v246, v246
v_exp_f32 v247, v247
v_exp_f32 v248, v248
v_exp_f32 v249, v249
v_exp_f32 v250, v250
v_exp_f32 v251, v251
v_pk_add_f32 v[244:245], v[244:245], 1.0 op_sel_hi:[1,0]
v_pk_add_f32 v[246:247], v[246:247], 1.0 op_sel_hi:[1,0]
v_pk_add_f32 v[248:249], v[248:249], 1.0 op_sel_hi:[1,0]
v_pk_add_f32 v[250:251], v[250:251], 1.0 op_sel_hi:[1,0]
v_rcp_f32 v244, v244
v_rcp_f32 v245, v245
v_rcp_f32 v246, v246
v_rcp_f32 v247, v247
v_rcp_f32 v248, v248
v_rcp_f32 v249, v249
v_rcp_f32 v250, v250
v_rcp_f32 v251, v251
v_pk_mul_f32 v[80:81], v[80:81], v[244:245]
v_pk_mul_f32 v[82:83], v[82:83], v[246:247]
v_pk_mul_f32 v[84:85], v[84:85], v[248:249]
v_pk_mul_f32 v[86:87], v[86:87], v[250:251]
v_cvt_pk_bf16_f32 v232, v80, v81
v_cvt_pk_bf16_f32 v233, v82, v83
v_cvt_pk_bf16_f32 v234, v84, v85
v_cvt_pk_bf16_f32 v235, v86, v87
s_add_u32 s73, s72, 2048
buffer_store_dwordx4 v[232:235], v36, s[52:55], s73 offen sc1
v_pk_fma_f32 v[88:89], v[208:209], v[172:173], v[88:89]
v_pk_fma_f32 v[90:91], v[210:211], v[172:173], v[90:91]
v_pk_fma_f32 v[92:93], v[212:213], v[172:173], v[92:93]
v_pk_fma_f32 v[94:95], v[214:215], v[172:173], v[94:95]
v_pk_mul_f32 v[88:89], v[88:89], v[174:175]
v_pk_mul_f32 v[90:91], v[90:91], v[174:175]
v_pk_mul_f32 v[92:93], v[92:93], v[174:175]
v_pk_mul_f32 v[94:95], v[94:95], v[174:175]
v_pk_mul_f32 v[244:245], v[88:89], v[88:89]
v_pk_mul_f32 v[246:247], v[90:91], v[90:91]
v_pk_mul_f32 v[248:249], v[92:93], v[92:93]
v_pk_mul_f32 v[250:251], v[94:95], v[94:95]
v_pk_fma_f32 v[244:245], v[244:245], v[182:183], v[180:181]
v_pk_fma_f32 v[246:247], v[246:247], v[182:183], v[180:181]
v_pk_fma_f32 v[248:249], v[248:249], v[182:183], v[180:181]
v_pk_fma_f32 v[250:251], v[250:251], v[182:183], v[180:181]
v_pk_mul_f32 v[244:245], v[244:245], v[88:89]
v_pk_mul_f32 v[246:247], v[246:247], v[90:91]
v_pk_mul_f32 v[248:249], v[248:249], v[92:93]
v_pk_mul_f32 v[250:251], v[250:251], v[94:95]
v_exp_f32 v244, v244
v_exp_f32 v245, v245
v_exp_f32 v246, v246
v_exp_f32 v247, v247
v_exp_f32 v248, v248
v_exp_f32 v249, v249
v_exp_f32 v250, v250
v_exp_f32 v251, v251
v_pk_add_f32 v[244:245], v[244:245], 1.0 op_sel_hi:[1,0]
v_pk_add_f32 v[246:247], v[246:247], 1.0 op_sel_hi:[1,0]
v_pk_add_f32 v[248:249], v[248:249], 1.0 op_sel_hi:[1,0]
v_pk_add_f32 v[250:251], v[250:251], 1.0 op_sel_hi:[1,0]
v_rcp_f32 v244, v244
v_rcp_f32 v245, v245
v_rcp_f32 v246, v246
v_rcp_f32 v247, v247
v_rcp_f32 v248, v248
v_rcp_f32 v249, v249
v_rcp_f32 v250, v250
v_rcp_f32 v251, v251
v_pk_mul_f32 v[88:89], v[88:89], v[244:245]
v_pk_mul_f32 v[90:91], v[90:91], v[246:247]
v_pk_mul_f32 v[92:93], v[92:93], v[248:249]
v_pk_mul_f32 v[94:95], v[94:95], v[250:251]
v_cvt_pk_bf16_f32 v236, v88, v89
v_cvt_pk_bf16_f32 v237, v90, v91
v_cvt_pk_bf16_f32 v238, v92, v93
v_cvt_pk_bf16_f32 v239, v94, v95
s_add_u32 s73, s72, 3072
buffer_store_dwordx4 v[236:239], v36, s[52:55], s73 offen sc1
v_pk_fma_f32 v[96:97], v[216:217], v[172:173], v[96:97]
v_pk_fma_f32 v[98:99], v[218:219], v[172:173], v[98:99]
v_pk_fma_f32 v[100:101], v[220:221], v[172:173], v[100:101]
v_pk_fma_f32 v[102:103], v[222:223], v[172:173], v[102:103]
v_pk_mul_f32 v[96:97], v[96:97], v[174:175]
v_pk_mul_f32 v[98:99], v[98:99], v[174:175]
v_pk_mul_f32 v[100:101], v[100:101], v[174:175]
v_pk_mul_f32 v[102:103], v[102:103], v[174:175]
v_pk_mul_f32 v[244:245], v[96:97], v[96:97]
v_pk_mul_f32 v[246:247], v[98:99], v[98:99]
v_pk_mul_f32 v[248:249], v[100:101], v[100:101]
v_pk_mul_f32 v[250:251], v[102:103], v[102:103]
v_pk_fma_f32 v[244:245], v[244:245], v[182:183], v[180:181]
v_pk_fma_f32 v[246:247], v[246:247], v[182:183], v[180:181]
v_pk_fma_f32 v[248:249], v[248:249], v[182:183], v[180:181]
v_pk_fma_f32 v[250:251], v[250:251], v[182:183], v[180:181]
v_pk_mul_f32 v[244:245], v[244:245], v[96:97]
v_pk_mul_f32 v[246:247], v[246:247], v[98:99]
v_pk_mul_f32 v[248:249], v[248:249], v[100:101]
v_pk_mul_f32 v[250:251], v[250:251], v[102:103]
v_exp_f32 v244, v244
v_exp_f32 v245, v245
v_exp_f32 v246, v246
v_exp_f32 v247, v247
v_exp_f32 v248, v248
v_exp_f32 v249, v249
v_exp_f32 v250, v250
v_exp_f32 v251, v251
v_pk_add_f32 v[244:245], v[244:245], 1.0 op_sel_hi:[1,0]
v_pk_add_f32 v[246:247], v[246:247], 1.0 op_sel_hi:[1,0]
v_pk_add_f32 v[248:249], v[248:249], 1.0 op_sel_hi:[1,0]
v_pk_add_f32 v[250:251], v[250:251], 1.0 op_sel_hi:[1,0]
v_rcp_f32 v244, v244
v_rcp_f32 v245, v245
v_rcp_f32 v246, v246
v_rcp_f32 v247, v247
v_rcp_f32 v248, v248
v_rcp_f32 v249, v249
v_rcp_f32 v250, v250
v_rcp_f32 v251, v251
v_pk_mul_f32 v[96:97], v[96:97], v[244:245]
v_pk_mul_f32 v[98:99], v[98:99], v[246:247]
v_pk_mul_f32 v[100:101], v[100:101], v[248:249]
v_pk_mul_f32 v[102:103], v[102:103], v[250:251]
v_cvt_pk_bf16_f32 v240, v96, v97
v_cvt_pk_bf16_f32 v241, v98, v99
v_cvt_pk_bf16_f32 v242, v100, v101
v_cvt_pk_bf16_f32 v243, v102, v103
s_add_u32 s73, s72, 4096
buffer_store_dwordx4 v[240:243], v36, s[52:55], s73 offen sc1
v_pk_fma_f32 v[104:105], v[184:185], v[176:177], v[104:105]
v_pk_fma_f32 v[106:107], v[186:187], v[176:177], v[106:107]
v_pk_fma_f32 v[108:109], v[188:189], v[176:177], v[108:109]
v_pk_fma_f32 v[110:111], v[190:191], v[176:177], v[110:111]
v_pk_mul_f32 v[104:105], v[104:105], v[178:179]
v_pk_mul_f32 v[106:107], v[106:107], v[178:179]
v_pk_mul_f32 v[108:109], v[108:109], v[178:179]
v_pk_mul_f32 v[110:111], v[110:111], v[178:179]
v_pk_mul_f32 v[244:245], v[104:105], v[104:105]
v_pk_mul_f32 v[246:247], v[106:107], v[106:107]
v_pk_mul_f32 v[248:249], v[108:109], v[108:109]
v_pk_mul_f32 v[250:251], v[110:111], v[110:111]
v_pk_fma_f32 v[244:245], v[244:245], v[182:183], v[180:181]
v_pk_fma_f32 v[246:247], v[246:247], v[182:183], v[180:181]
v_pk_fma_f32 v[248:249], v[248:249], v[182:183], v[180:181]
v_pk_fma_f32 v[250:251], v[250:251], v[182:183], v[180:181]
v_pk_mul_f32 v[244:245], v[244:245], v[104:105]
v_pk_mul_f32 v[246:247], v[246:247], v[106:107]
v_pk_mul_f32 v[248:249], v[248:249], v[108:109]
v_pk_mul_f32 v[250:251], v[250:251], v[110:111]
v_exp_f32 v244, v244
v_exp_f32 v245, v245
v_exp_f32 v246, v246
v_exp_f32 v247, v247
v_exp_f32 v248, v248
v_exp_f32 v249, v249
v_exp_f32 v250, v250
v_exp_f32 v251, v251
v_pk_add_f32 v[244:245], v[244:245], 1.0 op_sel_hi:[1,0]
v_pk_add_f32 v[246:247], v[246:247], 1.0 op_sel_hi:[1,0]
v_pk_add_f32 v[248:249], v[248:249], 1.0 op_sel_hi:[1,0]
v_pk_add_f32 v[250:251], v[250:251], 1.0 op_sel_hi:[1,0]
v_rcp_f32 v244, v244
v_rcp_f32 v245, v245
v_rcp_f32 v246, v246
v_rcp_f32 v247, v247
v_rcp_f32 v248, v248
v_rcp_f32 v249, v249
v_rcp_f32 v250, v250
v_rcp_f32 v251, v251
v_pk_mul_f32 v[104:105], v[104:105], v[244:245]
v_pk_mul_f32 v[106:107], v[106:107], v[246:247]
v_pk_mul_f32 v[108:109], v[108:109], v[248:249]
v_pk_mul_f32 v[110:111], v[110:111], v[250:251]
v_cvt_pk_bf16_f32 v224, v104, v105
v_cvt_pk_bf16_f32 v225, v106, v107
v_cvt_pk_bf16_f32 v226, v108, v109
v_cvt_pk_bf16_f32 v227, v110, v111
s_add_u32 s73, s72, 0
buffer_store_dwordx4 v[224:227], v37, s[52:55], s73 offen sc1
v_pk_fma_f32 v[112:113], v[192:193], v[176:177], v[112:113]
v_pk_fma_f32 v[114:115], v[194:195], v[176:177], v[114:115]
v_pk_fma_f32 v[116:117], v[196:197], v[176:177], v[116:117]
v_pk_fma_f32 v[118:119], v[198:199], v[176:177], v[118:119]
v_pk_mul_f32 v[112:113], v[112:113], v[178:179]
v_pk_mul_f32 v[114:115], v[114:115], v[178:179]
v_pk_mul_f32 v[116:117], v[116:117], v[178:179]
v_pk_mul_f32 v[118:119], v[118:119], v[178:179]
v_pk_mul_f32 v[244:245], v[112:113], v[112:113]
v_pk_mul_f32 v[246:247], v[114:115], v[114:115]
v_pk_mul_f32 v[248:249], v[116:117], v[116:117]
v_pk_mul_f32 v[250:251], v[118:119], v[118:119]
v_pk_fma_f32 v[244:245], v[244:245], v[182:183], v[180:181]
v_pk_fma_f32 v[246:247], v[246:247], v[182:183], v[180:181]
v_pk_fma_f32 v[248:249], v[248:249], v[182:183], v[180:181]
v_pk_fma_f32 v[250:251], v[250:251], v[182:183], v[180:181]
v_pk_mul_f32 v[244:245], v[244:245], v[112:113]
v_pk_mul_f32 v[246:247], v[246:247], v[114:115]
v_pk_mul_f32 v[248:249], v[248:249], v[116:117]
v_pk_mul_f32 v[250:251], v[250:251], v[118:119]
v_exp_f32 v244, v244
v_exp_f32 v245, v245
v_exp_f32 v246, v246
v_exp_f32 v247, v247
v_exp_f32 v248, v248
v_exp_f32 v249, v249
v_exp_f32 v250, v250
v_exp_f32 v251, v251
v_pk_add_f32 v[244:245], v[244:245], 1.0 op_sel_hi:[1,0]
v_pk_add_f32 v[246:247], v[246:247], 1.0 op_sel_hi:[1,0]
v_pk_add_f32 v[248:249], v[248:249], 1.0 op_sel_hi:[1,0]
v_pk_add_f32 v[250:251], v[250:251], 1.0 op_sel_hi:[1,0]
v_rcp_f32 v244, v244
v_rcp_f32 v245, v245
v_rcp_f32 v246, v246
v_rcp_f32 v247, v247
v_rcp_f32 v248, v248
v_rcp_f32 v249, v249
v_rcp_f32 v250, v250
v_rcp_f32 v251, v251
v_pk_mul_f32 v[112:113], v[112:113], v[244:245]
v_pk_mul_f32 v[114:115], v[114:115], v[246:247]
v_pk_mul_f32 v[116:117], v[116:117], v[248:249]
v_pk_mul_f32 v[118:119], v[118:119], v[250:251]
v_cvt_pk_bf16_f32 v228, v112, v113
v_cvt_pk_bf16_f32 v229, v114, v115
v_cvt_pk_bf16_f32 v230, v116, v117
v_cvt_pk_bf16_f32 v231, v118, v119
s_add_u32 s73, s72, 1024
buffer_store_dwordx4 v[228:231], v37, s[52:55], s73 offen sc1
v_pk_fma_f32 v[120:121], v[200:201], v[176:177], v[120:121]
v_pk_fma_f32 v[122:123], v[202:203], v[176:177], v[122:123]
v_pk_fma_f32 v[124:125], v[204:205], v[176:177], v[124:125]
v_pk_fma_f32 v[126:127], v[206:207], v[176:177], v[126:127]
v_pk_mul_f32 v[120:121], v[120:121], v[178:179]
v_pk_mul_f32 v[122:123], v[122:123], v[178:179]
v_pk_mul_f32 v[124:125], v[124:125], v[178:179]
v_pk_mul_f32 v[126:127], v[126:127], v[178:179]
v_pk_mul_f32 v[244:245], v[120:121], v[120:121]
v_pk_mul_f32 v[246:247], v[122:123], v[122:123]
v_pk_mul_f32 v[248:249], v[124:125], v[124:125]
v_pk_mul_f32 v[250:251], v[126:127], v[126:127]
v_pk_fma_f32 v[244:245], v[244:245], v[182:183], v[180:181]
v_pk_fma_f32 v[246:247], v[246:247], v[182:183], v[180:181]
v_pk_fma_f32 v[248:249], v[248:249], v[182:183], v[180:181]
v_pk_fma_f32 v[250:251], v[250:251], v[182:183], v[180:181]
v_pk_mul_f32 v[244:245], v[244:245], v[120:121]
v_pk_mul_f32 v[246:247], v[246:247], v[122:123]
v_pk_mul_f32 v[248:249], v[248:249], v[124:125]
v_pk_mul_f32 v[250:251], v[250:251], v[126:127]
v_exp_f32 v244, v244
v_exp_f32 v245, v245
v_exp_f32 v246, v246
v_exp_f32 v247, v247
v_exp_f32 v248, v248
v_exp_f32 v249, v249
v_exp_f32 v250, v250
v_exp_f32 v251, v251
v_pk_add_f32 v[244:245], v[244:245], 1.0 op_sel_hi:[1,0]
v_pk_add_f32 v[246:247], v[246:247], 1.0 op_sel_hi:[1,0]
v_pk_add_f32 v[248:249], v[248:249], 1.0 op_sel_hi:[1,0]
v_pk_add_f32 v[250:251], v[250:251], 1.0 op_sel_hi:[1,0]
v_rcp_f32 v244, v244
v_rcp_f32 v245, v245
v_rcp_f32 v246, v246
v_rcp_f32 v247, v247
v_rcp_f32 v248, v248
v_rcp_f32 v249, v249
v_rcp_f32 v250, v250
v_rcp_f32 v251, v251
v_pk_mul_f32 v[120:121], v[120:121], v[244:245]
v_pk_mul_f32 v[122:123], v[122:123], v[246:247]
v_pk_mul_f32 v[124:125], v[124:125], v[248:249]
v_pk_mul_f32 v[126:127], v[126:127], v[250:251]
v_cvt_pk_bf16_f32 v232, v120, v121
v_cvt_pk_bf16_f32 v233, v122, v123
v_cvt_pk_bf16_f32 v234, v124, v125
v_cvt_pk_bf16_f32 v235, v126, v127
s_add_u32 s73, s72, 2048
buffer_store_dwordx4 v[232:235], v37, s[52:55], s73 offen sc1
v_pk_fma_f32 v[128:129], v[208:209], v[176:177], v[128:129]
v_pk_fma_f32 v[130:131], v[210:211], v[176:177], v[130:131]
v_pk_fma_f32 v[132:133], v[212:213], v[176:177], v[132:133]
v_pk_fma_f32 v[134:135], v[214:215], v[176:177], v[134:135]
v_pk_mul_f32 v[128:129], v[128:129], v[178:179]
v_pk_mul_f32 v[130:131], v[130:131], v[178:179]
v_pk_mul_f32 v[132:133], v[132:133], v[178:179]
v_pk_mul_f32 v[134:135], v[134:135], v[178:179]
v_pk_mul_f32 v[244:245], v[128:129], v[128:129]
v_pk_mul_f32 v[246:247], v[130:131], v[130:131]
v_pk_mul_f32 v[248:249], v[132:133], v[132:133]
v_pk_mul_f32 v[250:251], v[134:135], v[134:135]
v_pk_fma_f32 v[244:245], v[244:245], v[182:183], v[180:181]
v_pk_fma_f32 v[246:247], v[246:247], v[182:183], v[180:181]
v_pk_fma_f32 v[248:249], v[248:249], v[182:183], v[180:181]
v_pk_fma_f32 v[250:251], v[250:251], v[182:183], v[180:181]
v_pk_mul_f32 v[244:245], v[244:245], v[128:129]
v_pk_mul_f32 v[246:247], v[246:247], v[130:131]
v_pk_mul_f32 v[248:249], v[248:249], v[132:133]
v_pk_mul_f32 v[250:251], v[250:251], v[134:135]
v_exp_f32 v244, v244
v_exp_f32 v245, v245
v_exp_f32 v246, v246
v_exp_f32 v247, v247
v_exp_f32 v248, v248
v_exp_f32 v249, v249
v_exp_f32 v250, v250
v_exp_f32 v251, v251
v_pk_add_f32 v[244:245], v[244:245], 1.0 op_sel_hi:[1,0]
v_pk_add_f32 v[246:247], v[246:247], 1.0 op_sel_hi:[1,0]
v_pk_add_f32 v[248:249], v[248:249], 1.0 op_sel_hi:[1,0]
v_pk_add_f32 v[250:251], v[250:251], 1.0 op_sel_hi:[1,0]
v_rcp_f32 v244, v244
v_rcp_f32 v245, v245
v_rcp_f32 v246, v246
v_rcp_f32 v247, v247
v_rcp_f32 v248, v248
v_rcp_f32 v249, v249
v_rcp_f32 v250, v250
v_rcp_f32 v251, v251
v_pk_mul_f32 v[128:129], v[128:129], v[244:245]
v_pk_mul_f32 v[130:131], v[130:131], v[246:247]
v_pk_mul_f32 v[132:133], v[132:133], v[248:249]
v_pk_mul_f32 v[134:135], v[134:135], v[250:251]
v_cvt_pk_bf16_f32 v236, v128, v129
v_cvt_pk_bf16_f32 v237, v130, v131
v_cvt_pk_bf16_f32 v238, v132, v133
v_cvt_pk_bf16_f32 v239, v134, v135
s_add_u32 s73, s72, 3072
buffer_store_dwordx4 v[236:239], v37, s[52:55], s73 offen sc1
v_pk_fma_f32 v[136:137], v[216:217], v[176:177], v[136:137]
v_pk_fma_f32 v[138:139], v[218:219], v[176:177], v[138:139]
v_pk_fma_f32 v[140:141], v[220:221], v[176:177], v[140:141]
v_pk_fma_f32 v[142:143], v[222:223], v[176:177], v[142:143]
v_pk_mul_f32 v[136:137], v[136:137], v[178:179]
v_pk_mul_f32 v[138:139], v[138:139], v[178:179]
v_pk_mul_f32 v[140:141], v[140:141], v[178:179]
v_pk_mul_f32 v[142:143], v[142:143], v[178:179]
v_pk_mul_f32 v[244:245], v[136:137], v[136:137]
v_pk_mul_f32 v[246:247], v[138:139], v[138:139]
v_pk_mul_f32 v[248:249], v[140:141], v[140:141]
v_pk_mul_f32 v[250:251], v[142:143], v[142:143]
v_pk_fma_f32 v[244:245], v[244:245], v[182:183], v[180:181]
v_pk_fma_f32 v[246:247], v[246:247], v[182:183], v[180:181]
v_pk_fma_f32 v[248:249], v[248:249], v[182:183], v[180:181]
v_pk_fma_f32 v[250:251], v[250:251], v[182:183], v[180:181]
v_pk_mul_f32 v[244:245], v[244:245], v[136:137]
v_pk_mul_f32 v[246:247], v[246:247], v[138:139]
v_pk_mul_f32 v[248:249], v[248:249], v[140:141]
v_pk_mul_f32 v[250:251], v[250:251], v[142:143]
v_exp_f32 v244, v244
v_exp_f32 v245, v245
v_exp_f32 v246, v246
v_exp_f32 v247, v247
v_exp_f32 v248, v248
v_exp_f32 v249, v249
v_exp_f32 v250, v250
v_exp_f32 v251, v251
v_pk_add_f32 v[244:245], v[244:245], 1.0 op_sel_hi:[1,0]
v_pk_add_f32 v[246:247], v[246:247], 1.0 op_sel_hi:[1,0]
v_pk_add_f32 v[248:249], v[248:249], 1.0 op_sel_hi:[1,0]
v_pk_add_f32 v[250:251], v[250:251], 1.0 op_sel_hi:[1,0]
v_rcp_f32 v244, v244
v_rcp_f32 v245, v245
v_rcp_f32 v246, v246
v_rcp_f32 v247, v247
v_rcp_f32 v248, v248
v_rcp_f32 v249, v249
v_rcp_f32 v250, v250
v_rcp_f32 v251, v251
v_pk_mul_f32 v[136:137], v[136:137], v[244:245]
v_pk_mul_f32 v[138:139], v[138:139], v[246:247]
v_pk_mul_f32 v[140:141], v[140:141], v[248:249]
v_pk_mul_f32 v[142:143], v[142:143], v[250:251]
v_cvt_pk_bf16_f32 v240, v136, v137
v_cvt_pk_bf16_f32 v241, v138, v139
v_cvt_pk_bf16_f32 v242, v140, v141
v_cvt_pk_bf16_f32 v243, v142, v143
s_add_u32 s73, s72, 4096
buffer_store_dwordx4 v[240:243], v37, s[52:55], s73 offen sc1
s_cmp_gt_i32 s74, 0
s_cbranch_scc0 L_w1_zneg
s_or_b32 s71, s30, s3
s_cmp_eq_u32 s71, 0
s_cbranch_scc0 L_w1_zdone
v_cmp_gt_i32 vcc, s74, v3
s_mov_b32 s71, 0
s_branch L_w1_zst
L_w1_zneg:
s_cmp_eq_u32 s30, 15
s_cbranch_scc0 L_w1_zdone
s_cmp_eq_u32 s3, 3
s_cbranch_scc0 L_w1_zdone
s_add_u32 s71, s74, 16
v_cmp_le_i32 vcc, s71, v3
s_mov_b32 s71, 2600960
L_w1_zst:
v_lshlrev_b32 v32, 4, v3
v_lshl_add_u32 v32, v2, 8, v32
v_add_u32 v32, s71, v32
v_mov_b32 v244, 0
v_mov_b32 v245, 0
v_mov_b32 v246, 0
v_mov_b32 v247, 0
s_and_saveexec_b64 s[76:77], vcc
s_add_u32 s73, s72, 0
buffer_store_dwordx4 v[244:247], v32, s[52:55], s73 offen sc1
s_add_u32 s73, s72, 1024
buffer_store_dwordx4 v[244:247], v32, s[52:55], s73 offen sc1
s_add_u32 s73, s72, 2048
buffer_store_dwordx4 v[244:247], v32, s[52:55], s73 offen sc1
s_add_u32 s73, s72, 3072
buffer_store_dwordx4 v[244:247], v32, s[52:55], s73 offen sc1
s_add_u32 s73, s72, 4096
buffer_store_dwordx4 v[244:247], v32, s[52:55], s73 offen sc1
s_mov_b64 exec, s[76:77]
L_w1_zdone:
v_readfirstlane_b32 s90, v59
s_mov_b32 s91, 0x40000
s_nop 2
L_tag_get_w1:
s_cmp_lg_u32 s90, 0
s_cbranch_scc1 L_tag_got_w1
s_sub_u32 s91, s91, 1
s_cmp_eq_u32 s91, 0
s_cbranch_scc1 L_tag_got_w1
global_load_dword v59, v63, s[34:35] sc1
s_waitcnt vmcnt(0)
v_readfirstlane_b32 s90, v59
s_nop 2
s_branch L_tag_get_w1
L_tag_got_w1:
s_lshl_b32 s72, s30, 7
s_lshl_b32 s73, s31, 2
s_add_u32 s72, s72, s73
s_add_u32 s72, s72, 28511232
s_waitcnt vmcnt(0) lgkmcnt(0)
s_barrier
s_cmp_eq_u32 s3, 0
s_cbranch_scc0 L_pub_p1w1
v_mov_b32 v60, s90
v_mov_b32 v61, 0
s_mov_b64 s[94:95], exec
s_mov_b64 exec, 1
buffer_store_dword v60, v61, s[44:47], s72 offen sc1
s_mov_b64 exec, s[94:95]
L_pub_p1w1:
s_branch L_k1_fin
L_k1_kv:
ds_read_b128 a[0:3], v22 offset:0
ds_read_b128 a[4:7], v22 offset:2048
ds_read_b64_tr_b16 a[16:17], v24 offset:0
ds_read_b64_tr_b16 a[18:19], v24 offset:1280
ds_read_b64_tr_b16 a[20:21], v24 offset:32
ds_read_b64_tr_b16 a[22:23], v24 offset:1312
ds_read_b64_tr_b16 a[24:25], v24 offset:64
ds_read_b64_tr_b16 a[26:27], v24 offset:1344
ds_read_b64_tr_b16 a[28:29], v24 offset:96
ds_read_b64_tr_b16 a[30:31], v24 offset:1376
ds_read_b64_tr_b16 a[32:33], v24 offset:128
ds_read_b64_tr_b16 a[34:35], v24 offset:1408
s_waitcnt lgkmcnt(10)
s_mov_b32 s63, 0
L_loopA_kv:
s_waitcnt lgkmcnt(8)
v_mfma_f32_16x16x32_bf16 v[64:67], a[0:3], a[16:19], v[64:67]
ds_read_b64_tr_b16 a[36:37], v24 offset:160
ds_read_b64_tr_b16 a[38:39], v24 offset:1440
v_mfma_f32_16x16x32_bf16 v[104:107], a[4:7], a[16:19], v[104:107]
s_add_u32 s68, s68, 36864
s_add_u32 m0, s67, s69
s_waitcnt lgkmcnt(8)
v_mfma_f32_16x16x32_bf16 v[68:71], a[0:3], a[20:23], v[68:71]
ds_read_b64_tr_b16 a[40:41], v24 offset:192
ds_read_b64_tr_b16 a[42:43], v24 offset:1472
s_cmp_eq_u32 s68, 147456
s_cselect_b32 s68, 0, s68
v_mfma_f32_16x16x32_bf16 v[108:111], a[4:7], a[20:23], v[108:111]
ds_read_b128 a[8:11], v23 offset:0
buffer_load_dwordx4 v4, s[36:39], s64 offen offset:0 lds
s_waitcnt lgkmcnt(9)
v_mfma_f32_16x16x32_bf16 v[72:75], a[0:3], a[24:27], v[72:75]
ds_read_b64_tr_b16 a[44:45], v24 offset:224
ds_read_b64_tr_b16 a[46:47], v24 offset:1504
v_mfma_f32_16x16x32_bf16 v[112:115], a[4:7], a[24:27], v[112:115]
v_add_u32 v22, s68, v13
ds_read_b128 a[12:15], v23 offset:2048
s_waitcnt lgkmcnt(10)
v_mfma_f32_16x16x32_bf16 v[76:79], a[0:3], a[28:31], v[76:79]
ds_read_b64_tr_b16 a[48:49], v24 offset:256
ds_read_b64_tr_b16 a[50:51], v24 offset:1536
v_mfma_f32_16x16x32_bf16 v[116:119], a[4:7], a[28:31], v[116:119]
buffer_load_dwordx4 v5, s[36:39], s64 offen offset:1024 lds
s_waitcnt lgkmcnt(10)
v_mfma_f32_16x16x32_bf16 v[80:83], a[0:3], a[32:35], v[80:83]
ds_read_b64_tr_b16 a[52:53], v25 offset:0
v_mfma_f32_16x16x32_bf16 v[120:123], a[4:7], a[32:35], v[120:123]
ds_read_b64_tr_b16 a[54:55], v25 offset:1280
s_waitcnt lgkmcnt(10)
v_mfma_f32_16x16x32_bf16 v[84:87], a[0:3], a[36:39], v[84:87]
ds_read_b64_tr_b16 a[16:17], v24 offset:10240
ds_read_b64_tr_b16 a[18:19], v24 offset:11520
v_mfma_f32_16x16x32_bf16 v[124:127], a[4:7], a[36:39], v[124:127]
buffer_load_dwordx4 v6, s[36:39], s64 offen offset:2048 lds
s_waitcnt lgkmcnt(10)
v_mfma_f32_16x16x32_bf16 v[88:91], a[0:3], a[40:43], v[88:91]
ds_read_b64_tr_b16 a[20:21], v24 offset:10272
v_mfma_f32_16x16x32_bf16 v[128:131], a[4:7], a[40:43], v[128:131]
ds_read_b64_tr_b16 a[22:23], v24 offset:11552
s_waitcnt lgkmcnt(9)
v_mfma_f32_16x16x32_bf16 v[92:95], a[0:3], a[44:47], v[92:95]
ds_read_b64_tr_b16 a[24:25], v24 offset:10304
ds_read_b64_tr_b16 a[26:27], v24 offset:11584
v_mfma_f32_16x16x32_bf16 v[132:135], a[4:7], a[44:47], v[132:135]
buffer_load_dwordx4 v7, s[36:39], s64 offen offset:3072 lds
s_waitcnt lgkmcnt(8)
v_mfma_f32_16x16x32_bf16 v[96:99], a[0:3], a[48:51], v[96:99]
ds_read_b64_tr_b16 a[28:29], v24 offset:10336
ds_read_b64_tr_b16 a[30:31], v24 offset:11616
v_mfma_f32_16x16x32_bf16 v[136:139], a[4:7], a[48:51], v[136:139]
s_add_u32 m0, s67, s70
s_waitcnt lgkmcnt(8)
v_mfma_f32_16x16x32_bf16 v[100:103], a[0:3], a[52:55], v[100:103]
ds_read_b64_tr_b16 a[32:33], v24 offset:10368
ds_read_b64_tr_b16 a[34:35], v24 offset:11648
v_mfma_f32_16x16x32_bf16 v[140:143], a[4:7], a[52:55], v[140:143]
buffer_load_dwordx4 v8, s[40:43], s65 offen offset:0 lds
s_waitcnt vmcnt(6)
s_barrier
s_waitcnt lgkmcnt(8)
v_mfma_f32_16x16x32_bf16 v[64:67], a[8:11], a[16:19], v[64:67]
ds_read_b64_tr_b16 a[36:37], v24 offset:10400
v_mfma_f32_16x16x32_bf16 v[104:107], a[12:15], a[16:19], v[104:107]
ds_read_b64_tr_b16 a[38:39], v24 offset:11680
s_waitcnt lgkmcnt(8)
v_mfma_f32_16x16x32_bf16 v[68:71], a[8:11], a[20:23], v[68:71]
ds_read_b64_tr_b16 a[40:41], v24 offset:10432
ds_read_b64_tr_b16 a[42:43], v24 offset:11712
v_mfma_f32_16x16x32_bf16 v[108:111], a[12:15], a[20:23], v[108:111]
ds_read_b128 a[0:3], v22 offset:0
buffer_load_dwordx4 v9, s[40:43], s65 offen offset:1024 lds
s_waitcnt lgkmcnt(9)
v_mfma_f32_16x16x32_bf16 v[72:75], a[8:11], a[24:27], v[72:75]
ds_read_b64_tr_b16 a[44:45], v24 offset:10464
ds_read_b64_tr_b16 a[46:47], v24 offset:11744
v_mfma_f32_16x16x32_bf16 v[112:115], a[12:15], a[24:27], v[112:115]
ds_read_b128 a[4:7], v22 offset:2048
s_waitcnt lgkmcnt(10)
v_mfma_f32_16x16x32_bf16 v[76:79], a[8:11], a[28:31], v[76:79]
ds_read_b64_tr_b16 a[48:49], v24 offset:10496
ds_read_b64_tr_b16 a[50:51], v24 offset:11776
v_mfma_f32_16x16x32_bf16 v[116:119], a[12:15], a[28:31], v[116:119]
buffer_load_dwordx4 v10, s[40:43], s65 offen offset:2048 lds
s_waitcnt lgkmcnt(10)
v_mfma_f32_16x16x32_bf16 v[80:83], a[8:11], a[32:35], v[80:83]
ds_read_b64_tr_b16 a[52:53], v25 offset:10240
ds_read_b64_tr_b16 a[54:55], v25 offset:11520
v_mfma_f32_16x16x32_bf16 v[120:123], a[12:15], a[32:35], v[120:123]
v_add_u32 v23, s68, v14
s_waitcnt lgkmcnt(10)
v_mfma_f32_16x16x32_bf16 v[84:87], a[8:11], a[36:39], v[84:87]
v_add_u32 v24, s68, v15
ds_read_b64_tr_b16 a[16:17], v24 offset:0
v_mfma_f32_16x16x32_bf16 v[124:127], a[12:15], a[36:39], v[124:127]
ds_read_b64_tr_b16 a[18:19], v24 offset:1280
s_waitcnt lgkmcnt(10)
v_mfma_f32_16x16x32_bf16 v[88:91], a[8:11], a[40:43], v[88:91]
ds_read_b64_tr_b16 a[20:21], v24 offset:32
ds_read_b64_tr_b16 a[22:23], v24 offset:1312
v_mfma_f32_16x16x32_bf16 v[128:131], a[12:15], a[40:43], v[128:131]
v_add_u32 v25, s68, v16
buffer_load_dwordx4 v11, s[40:43], s65 offen offset:3072 lds
s_waitcnt lgkmcnt(9)
v_mfma_f32_16x16x32_bf16 v[92:95], a[8:11], a[44:47], v[92:95]
ds_read_b64_tr_b16 a[24:25], v24 offset:64
ds_read_b64_tr_b16 a[26:27], v24 offset:1344
v_mfma_f32_16x16x32_bf16 v[132:135], a[12:15], a[44:47], v[132:135]
s_add_u32 m0, s67, s89
s_waitcnt lgkmcnt(8)
v_mfma_f32_16x16x32_bf16 v[96:99], a[8:11], a[48:51], v[96:99]
ds_read_b64_tr_b16 a[28:29], v24 offset:96
ds_read_b64_tr_b16 a[30:31], v24 offset:1376
v_mfma_f32_16x16x32_bf16 v[136:139], a[12:15], a[48:51], v[136:139]
buffer_load_dwordx4 v12, s[40:43], s65 offen lds
s_waitcnt lgkmcnt(8)
v_mfma_f32_16x16x32_bf16 v[100:103], a[8:11], a[52:55], v[100:103]
ds_read_b64_tr_b16 a[32:33], v24 offset:128
ds_read_b64_tr_b16 a[34:35], v24 offset:1408
v_mfma_f32_16x16x32_bf16 v[140:143], a[12:15], a[52:55], v[140:143]
buffer_load_dword v51, v29, s[48:51], s91 offen
s_lshl_b32 s74, s87, 5
s_add_u32 s91, s91, s74
s_add_u32 s64, s64, 128
s_add_u32 s65, s65, s66
s_add_u32 s67, s67, 36864
s_cmp_eq_u32 s67, 147456
s_cselect_b32 s67, 0, s67
s_add_u32 s63, s63, 1
s_cmp_lt_u32 s63, 8
s_cbranch_scc1 L_loopA_kv
v_mov_b32 v63, 0
global_load_dword v59, v63, s[34:35] sc1
s_getpc_b64 s[96:97]
L_pfr_L_code_p2_2:
s_add_u32 s96, s96, L_code_p2 - L_pfr_L_code_p2_2
s_addc_u32 s97, s97, 0
v_lshrrev_b32 v62, 6, v0
v_and_b32 v61, 0, v0
v_mad_u32_u24 v62, v62, 1, v61
s_lshr_b32 s95, s2, 3
s_mul_i32 s95, s95, 4
v_add_u32 v62, s95, v62
v_min_u32 v62, (L_code_p3 - L_code_p2) >> 7, v62
v_lshlrev_b32 v62, 7, v62
global_load_dword v55, v62, s[96:97]
s_lshl_b32 s73, s3, 10
s_add_u32 s73, s73, 73728
s_lshl_b32 s74, s87, 5
s_mov_b32 s88, 0
s_add_u32 m0, s73, 0
s_nop 0
buffer_load_dwordx4 v29, s[48:51], s88 offen lds
s_add_u32 m0, s73, 4096
s_add_u32 s88, s88, s74
buffer_load_dwordx4 v29, s[48:51], s88 offen lds
s_add_u32 m0, s73, 8192
s_add_u32 s88, s88, s74
buffer_load_dwordx4 v29, s[48:51], s88 offen lds
s_add_u32 m0, s73, 12288
s_add_u32 s88, s88, s74
buffer_load_dwordx4 v29, s[48:51], s88 offen lds
s_add_u32 m0, s73, 16384
s_add_u32 s88, s88, s74
buffer_load_dwordx4 v29, s[48:51], s88 offen lds
s_add_u32 m0, s73, 20480
s_add_u32 s88, s88, s74
buffer_load_dwordx4 v29, s[48:51], s88 offen lds
s_add_u32 m0, s73, 24576
s_add_u32 s88, s88, s74
buffer_load_dwordx4 v29, s[48:51], s88 offen lds
L_loopB_kv:
s_waitcnt lgkmcnt(8)
v_mfma_f32_16x16x32_bf16 v[64:67], a[0:3], a[16:19], v[64:67]
ds_read_b64_tr_b16 a[36:37], v24 offset:160
ds_read_b64_tr_b16 a[38:39], v24 offset:1440
v_mfma_f32_16x16x32_bf16 v[104:107], a[4:7], a[16:19], v[104:107]
s_add_u32 s68, s68, 36864
s_waitcnt lgkmcnt(8)
v_mfma_f32_16x16x32_bf16 v[68:71], a[0:3], a[20:23], v[68:71]
ds_read_b64_tr_b16 a[40:41], v24 offset:192
ds_read_b64_tr_b16 a[42:43], v24 offset:1472
v_mfma_f32_16x16x32_bf16 v[108:111], a[4:7], a[20:23], v[108:111]
s_cmp_eq_u32 s68, 147456
s_cselect_b32 s68, 0, s68
ds_read_b128 a[8:11], v23 offset:0
s_waitcnt lgkmcnt(9)
v_mfma_f32_16x16x32_bf16 v[72:75], a[0:3], a[24:27], v[72:75]
ds_read_b64_tr_b16 a[44:45], v24 offset:224
ds_read_b64_tr_b16 a[46:47], v24 offset:1504
v_mfma_f32_16x16x32_bf16 v[112:115], a[4:7], a[24:27], v[112:115]
v_add_u32 v22, s68, v13
ds_read_b128 a[12:15], v23 offset:2048
s_waitcnt lgkmcnt(10)
v_mfma_f32_16x16x32_bf16 v[76:79], a[0:3], a[28:31], v[76:79]
ds_read_b64_tr_b16 a[48:49], v24 offset:256
v_mfma_f32_16x16x32_bf16 v[116:119], a[4:7], a[28:31], v[116:119]
ds_read_b64_tr_b16 a[50:51], v24 offset:1536
s_waitcnt lgkmcnt(10)
v_mfma_f32_16x16x32_bf16 v[80:83], a[0:3], a[32:35], v[80:83]
ds_read_b64_tr_b16 a[52:53], v25 offset:0
v_mfma_f32_16x16x32_bf16 v[120:123], a[4:7], a[32:35], v[120:123]
ds_read_b64_tr_b16 a[54:55], v25 offset:1280
s_waitcnt lgkmcnt(10)
v_mfma_f32_16x16x32_bf16 v[84:87], a[0:3], a[36:39], v[84:87]
ds_read_b64_tr_b16 a[16:17], v24 offset:10240
v_mfma_f32_16x16x32_bf16 v[124:127], a[4:7], a[36:39], v[124:127]
ds_read_b64_tr_b16 a[18:19], v24 offset:11520
s_waitcnt lgkmcnt(10)
v_mfma_f32_16x16x32_bf16 v[88:91], a[0:3], a[40:43], v[88:91]
ds_read_b64_tr_b16 a[20:21], v24 offset:10272
v_mfma_f32_16x16x32_bf16 v[128:131], a[4:7], a[40:43], v[128:131]
ds_read_b64_tr_b16 a[22:23], v24 offset:11552
s_waitcnt lgkmcnt(9)
v_mfma_f32_16x16x32_bf16 v[92:95], a[0:3], a[44:47], v[92:95]
ds_read_b64_tr_b16 a[24:25], v24 offset:10304
v_mfma_f32_16x16x32_bf16 v[132:135], a[4:7], a[44:47], v[132:135]
ds_read_b64_tr_b16 a[26:27], v24 offset:11584
s_waitcnt lgkmcnt(8)
v_mfma_f32_16x16x32_bf16 v[96:99], a[0:3], a[48:51], v[96:99]
ds_read_b64_tr_b16 a[28:29], v24 offset:10336
v_mfma_f32_16x16x32_bf16 v[136:139], a[4:7], a[48:51], v[136:139]
ds_read_b64_tr_b16 a[30:31], v24 offset:11616
s_waitcnt lgkmcnt(8)
v_mfma_f32_16x16x32_bf16 v[100:103], a[0:3], a[52:55], v[100:103]
ds_read_b64_tr_b16 a[32:33], v24 offset:10368
v_mfma_f32_16x16x32_bf16 v[140:143], a[4:7], a[52:55], v[140:143]
ds_read_b64_tr_b16 a[34:35], v24 offset:11648
s_cmp_eq_u32 s63, 8
s_cbranch_scc0 L_wd_kv_b
s_waitcnt vmcnt(7)
L_wd_kv_b:
s_barrier
s_waitcnt lgkmcnt(8)
v_mfma_f32_16x16x32_bf16 v[64:67], a[8:11], a[16:19], v[64:67]
ds_read_b64_tr_b16 a[36:37], v24 offset:10400
v_mfma_f32_16x16x32_bf16 v[104:107], a[12:15], a[16:19], v[104:107]
ds_read_b64_tr_b16 a[38:39], v24 offset:11680
s_waitcnt lgkmcnt(8)
v_mfma_f32_16x16x32_bf16 v[68:71], a[8:11], a[20:23], v[68:71]
ds_read_b64_tr_b16 a[40:41], v24 offset:10432
ds_read_b64_tr_b16 a[42:43], v24 offset:11712
v_mfma_f32_16x16x32_bf16 v[108:111], a[12:15], a[20:23], v[108:111]
ds_read_b128 a[0:3], v22 offset:0
s_waitcnt lgkmcnt(9)
v_mfma_f32_16x16x32_bf16 v[72:75], a[8:11], a[24:27], v[72:75]
ds_read_b64_tr_b16 a[44:45], v24 offset:10464
ds_read_b64_tr_b16 a[46:47], v24 offset:11744
v_mfma_f32_16x16x32_bf16 v[112:115], a[12:15], a[24:27], v[112:115]
ds_read_b128 a[4:7], v22 offset:2048
s_waitcnt lgkmcnt(10)
v_mfma_f32_16x16x32_bf16 v[76:79], a[8:11], a[28:31], v[76:79]
ds_read_b64_tr_b16 a[48:49], v24 offset:10496
v_mfma_f32_16x16x32_bf16 v[116:119], a[12:15], a[28:31], v[116:119]
ds_read_b64_tr_b16 a[50:51], v24 offset:11776
s_waitcnt lgkmcnt(10)
v_mfma_f32_16x16x32_bf16 v[80:83], a[8:11], a[32:35], v[80:83]
ds_read_b64_tr_b16 a[52:53], v25 offset:10240
ds_read_b64_tr_b16 a[54:55], v25 offset:11520
v_mfma_f32_16x16x32_bf16 v[120:123], a[12:15], a[32:35], v[120:123]
v_add_u32 v23, s68, v14
s_waitcnt lgkmcnt(10)
v_mfma_f32_16x16x32_bf16 v[84:87], a[8:11], a[36:39], v[84:87]
v_add_u32 v24, s68, v15
ds_read_b64_tr_b16 a[16:17], v24 offset:0
v_mfma_f32_16x16x32_bf16 v[124:127], a[12:15], a[36:39], v[124:127]
ds_read_b64_tr_b16 a[18:19], v24 offset:1280
s_waitcnt lgkmcnt(10)
v_mfma_f32_16x16x32_bf16 v[88:91], a[8:11], a[40:43], v[88:91]
ds_read_b64_tr_b16 a[20:21], v24 offset:32
ds_read_b64_tr_b16 a[22:23], v24 offset:1312
v_mfma_f32_16x16x32_bf16 v[128:131], a[12:15], a[40:43], v[128:131]
v_add_u32 v25, s68, v16
s_waitcnt lgkmcnt(9)
v_mfma_f32_16x16x32_bf16 v[92:95], a[8:11], a[44:47], v[92:95]
ds_read_b64_tr_b16 a[24:25], v24 offset:64
v_mfma_f32_16x16x32_bf16 v[132:135], a[12:15], a[44:47], v[132:135]
ds_read_b64_tr_b16 a[26:27], v24 offset:1344
s_waitcnt lgkmcnt(8)
v_mfma_f32_16x16x32_bf16 v[96:99], a[8:11], a[48:51], v[96:99]
ds_read_b64_tr_b16 a[28:29], v24 offset:96
v_mfma_f32_16x16x32_bf16 v[136:139], a[12:15], a[48:51], v[136:139]
ds_read_b64_tr_b16 a[30:31], v24 offset:1376
s_waitcnt lgkmcnt(8)
v_mfma_f32_16x16x32_bf16 v[100:103], a[8:11], a[52:55], v[100:103]
ds_read_b64_tr_b16 a[32:33], v24 offset:128
v_mfma_f32_16x16x32_bf16 v[140:143], a[12:15], a[52:55], v[140:143]
ds_read_b64_tr_b16 a[34:35], v24 offset:1408
s_add_u32 s63, s63, 1
s_cmp_lt_u32 s63, 10
s_cbranch_scc1 L_loopB_kv
s_waitcnt vmcnt(0) lgkmcnt(0)
s_barrier
s_cmp_eq_u32 s82, 0
s_cbranch_scc1 L_rls_done_kv
ds_read_b64_tr_b16 v[172:173], v30 offset:0
ds_read_b64_tr_b16 v[174:175], v30 offset:2048
ds_read_b64_tr_b16 v[176:177], v30 offset:4096
ds_read_b64_tr_b16 v[178:179], v30 offset:6144
ds_read_b64_tr_b16 v[180:181], v30 offset:8192
ds_read_b64_tr_b16 v[182:183], v30 offset:10240
ds_read_b64_tr_b16 v[184:185], v30 offset:12288
ds_read_b64_tr_b16 v[186:187], v30 offset:14336
ds_read_b64_tr_b16 v[188:189], v30 offset:16384
ds_read_b64_tr_b16 v[190:191], v30 offset:18432
ds_read_b64_tr_b16 v[192:193], v30 offset:20480
ds_read_b64_tr_b16 v[194:195], v30 offset:22528
ds_read_b64_tr_b16 v[196:197], v30 offset:24576
ds_read_b64_tr_b16 v[198:199], v30 offset:26624
v_mov_b32 v36, 0
v_mov_b32 v37, 0x3f803f80
s_waitcnt lgkmcnt(12)
buffer_store_dwordx4 v[172:175], v31, s[44:47], s83 offen sc1
s_add_u32 s83, s83, s84
s_waitcnt lgkmcnt(10)
buffer_store_dwordx4 v[176:179], v31, s[44:47], s83 offen sc1
s_add_u32 s83, s83, s84
s_waitcnt lgkmcnt(8)
buffer_store_dwordx4 v[180:183], v31, s[44:47], s83 offen sc1
s_add_u32 s83, s83, s84
s_waitcnt lgkmcnt(6)
buffer_store_dwordx4 v[184:187], v31, s[44:47], s83 offen sc1
s_add_u32 s83, s83, s84
s_waitcnt lgkmcnt(4)
buffer_store_dwordx4 v[188:191], v31, s[44:47], s83 offen sc1
s_add_u32 s83, s83, s84
s_cmp_le_u32 s82, 5
s_cbranch_scc1 L_rls_st_done_kv
s_waitcnt lgkmcnt(2)
buffer_store_dwordx4 v[192:195], v31, s[44:47], s83 offen sc1
s_add_u32 s83, s83, s84
s_cmp_le_u32 s82, 6
s_cbranch_scc1 L_rls_st_done_kv
s_waitcnt lgkmcnt(0)
buffer_store_dwordx4 v[196:199], v31, s[44:47], s83 offen sc1
s_add_u32 s83, s83, s84
L_rls_st_done_kv:
s_waitcnt lgkmcnt(0)
s_cmp_eq_u32 s85, 0
s_cbranch_scc1 L_rls_done_kv
v_mov_b32 v40, 0
v_mov_b32 v41, 0
v_mov_b32 v42, 0
v_dot2_f32_bf16 v36, v172, v37, v36
v_dot2_f32_bf16 v40, v173, v37, v40
v_dot2_f32_bf16 v41, v174, v37, v41
v_dot2_f32_bf16 v42, v175, v37, v42
v_dot2_f32_bf16 v36, v176, v37, v36
v_dot2_f32_bf16 v40, v177, v37, v40
v_dot2_f32_bf16 v41, v178, v37, v41
v_dot2_f32_bf16 v42, v179, v37, v42
v_dot2_f32_bf16 v36, v180, v37, v36
v_dot2_f32_bf16 v40, v181, v37, v40
v_dot2_f32_bf16 v41, v182, v37, v41
v_dot2_f32_bf16 v42, v183, v37, v42
v_dot2_f32_bf16 v36, v184, v37, v36
v_dot2_f32_bf16 v40, v185, v37, v40
v_dot2_f32_bf16 v41, v186, v37, v41
v_dot2_f32_bf16 v42, v187, v37, v42
v_dot2_f32_bf16 v36, v188, v37, v36
v_dot2_f32_bf16 v40, v189, v37, v40
v_dot2_f32_bf16 v41, v190, v37, v41
v_dot2_f32_bf16 v42, v191, v37, v42
v_dot2_f32_bf16 v36, v192, v37, v36
v_dot2_f32_bf16 v40, v193, v37, v40
v_dot2_f32_bf16 v41, v194, v37, v41
v_dot2_f32_bf16 v42, v195, v37, v42
v_dot2_f32_bf16 v36, v196, v37, v36
v_dot2_f32_bf16 v40, v197, v37, v40
v_dot2_f32_bf16 v41, v198, v37, v41
v_dot2_f32_bf16 v42, v199, v37, v42
s_nop 2
v_add_f32 v36, v36, v40
v_add_f32 v41, v41, v42
v_add_f32 v36, v36, v41
v_mov_b32 v39, v36
s_nop 1
v_permlane32_swap_b32 v36, v39
s_nop 1
v_add_f32 v36, v36, v39
v_mov_b32 v39, v36
s_nop 1
v_permlane16_swap_b32 v36, v39
s_nop 1
v_add_f32 v36, v36, v39
v_lshlrev_b32 v39, 2, v1
v_cmp_gt_u32 vcc, 16, v1
s_and_saveexec_b64 s[76:77], vcc
buffer_store_dword v36, v39, s[44:47], s86 offen sc1
s_mov_b64 exec, s[76:77]
L_rls_done_kv:
s_nop 1
v_mov_b32 v172, 0x3fb8aa3b
v_mov_b32 v173, 0x3fb8aa3b
v_mov_b32 v174, 0x358637bd
v_mov_b32 v175, 0x358637bd
s_mul_i32 s71, s3, 10240
s_add_u32 s71, s71, 110592
v_add_u32 v32, s71, v31
s_barrier
v_add_u32 v48, 0, v1
v_mul_u32_u24 v49, 6554, v48
v_lshrrev_b32 v49, 16, v49
v_mul_u32_u24 v50, 10, v49
v_sub_u32 v48, v48, v50
v_mul_u32_u24 v49, 1280, v49
v_lshl_add_u32 v24, v48, 4, v49
v_add_u32 v48, 64, v1
v_mul_u32_u24 v49, 6554, v48
v_lshrrev_b32 v49, 16, v49
v_mul_u32_u24 v50, 10, v49
v_sub_u32 v48, v48, v50
v_mul_u32_u24 v49, 1280, v49
v_lshl_add_u32 v25, v48, 4, v49
v_subrev_u32 v25, 1024, v25
v_add_u32 v48, 128, v1
v_mul_u32_u24 v49, 6554, v48
v_lshrrev_b32 v49, 16, v49
v_mul_u32_u24 v50, 10, v49
v_sub_u32 v48, v48, v50
v_mul_u32_u24 v49, 1280, v49
v_lshl_add_u32 v26, v48, 4, v49
v_subrev_u32 v26, 2048, v26
v_add_u32 v48, 192, v1
v_mul_u32_u24 v49, 6554, v48
v_lshrrev_b32 v49, 16, v49
v_mul_u32_u24 v50, 10, v49
v_sub_u32 v48, v48, v50
v_mul_u32_u24 v49, 1280, v49
v_lshl_add_u32 v27, v48, 4, v49
v_subrev_u32 v27, 3072, v27
v_add_u32 v48, 256, v1
v_mul_u32_u24 v49, 6554, v48
v_lshrrev_b32 v49, 16, v49
v_mul_u32_u24 v50, 10, v49
v_sub_u32 v48, v48, v50
v_mul_u32_u24 v49, 1280, v49
v_lshl_add_u32 v28, v48, 4, v49
s_mul_i32 s65, s31, 160
s_add_u32 s40, s18, s65
s_addc_u32 s41, s19, 0
s_mov_b32 s42, 819200
s_mov_b32 s43, 0x20000
s_mul_i32 s69, s3, 25600
s_mul_i32 s70, s3, 204800
v_cvt_pk_bf16_f32 v188, v84, v85
v_cvt_pk_bf16_f32 v189, v86, v87
v_cvt_pk_bf16_f32 v190, v124, v125
v_cvt_pk_bf16_f32 v191, v126, v127
ds_write_b128 v32, v[188:191] offset:5120
s_add_u32 m0, s69, 0
s_add_u32 s64, s70, 0
buffer_load_dwordx4 v24, s[40:43], s64 offen offset:0 lds
v_cvt_pk_bf16_f32 v192, v88, v89
v_cvt_pk_bf16_f32 v193, v90, v91
v_cvt_pk_bf16_f32 v194, v128, v129
v_cvt_pk_bf16_f32 v195, v130, v131
ds_write_b128 v32, v[192:195] offset:6144
v_cvt_pk_bf16_f32 v196, v92, v93
v_cvt_pk_bf16_f32 v197, v94, v95
v_cvt_pk_bf16_f32 v198, v132, v133
v_cvt_pk_bf16_f32 v199, v134, v135
ds_write_b128 v32, v[196:199] offset:7168
buffer_load_dwordx4 v25, s[40:43], s64 offen offset:1024 lds
v_cvt_pk_bf16_f32 v184, v96, v97
v_cvt_pk_bf16_f32 v185, v98, v99
v_cvt_pk_bf16_f32 v186, v136, v137
v_cvt_pk_bf16_f32 v187, v138, v139
ds_write_b128 v32, v[184:187] offset:8192
v_cvt_pk_bf16_f32 v188, v100, v101
v_cvt_pk_bf16_f32 v189, v102, v103
v_cvt_pk_bf16_f32 v190, v140, v141
v_cvt_pk_bf16_f32 v191, v142, v143
ds_write_b128 v32, v[188:191] offset:9216
buffer_load_dwordx4 v26, s[40:43], s64 offen offset:2048 lds
v_pk_mul_f32 v[176:177], v[64:65], v[172:173]
v_pk_mul_f32 v[178:179], v[66:67], v[172:173]
v_pk_mul_f32 v[180:181], v[104:105], v[172:173]
v_pk_mul_f32 v[182:183], v[106:107], v[172:173]
v_min_f32 v176, 0, v176
v_min_f32 v177, 0, v177
v_min_f32 v178, 0, v178
v_min_f32 v179, 0, v179
v_min_f32 v180, 0, v180
v_min_f32 v181, 0, v181
v_min_f32 v182, 0, v182
v_min_f32 v183, 0, v183
v_exp_f32 v176, v176
v_exp_f32 v177, v177
v_exp_f32 v178, v178
v_exp_f32 v179, v179
v_exp_f32 v180, v180
v_exp_f32 v181, v181
v_exp_f32 v182, v182
v_exp_f32 v183, v183
v_max_f32 v64, 0, v64
v_max_f32 v65, 0, v65
v_max_f32 v66, 0, v66
v_max_f32 v67, 0, v67
v_max_f32 v104, 0, v104
v_max_f32 v105, 0, v105
v_max_f32 v106, 0, v106
v_max_f32 v107, 0, v107
v_pk_add_f32 v[176:177], v[176:177], v[174:175]
v_pk_add_f32 v[178:179], v[178:179], v[174:175]
v_pk_add_f32 v[180:181], v[180:181], v[174:175]
v_pk_add_f32 v[182:183], v[182:183], v[174:175]
v_pk_add_f32 v[64:65], v[64:65], v[176:177]
v_pk_add_f32 v[66:67], v[66:67], v[178:179]
v_pk_add_f32 v[104:105], v[104:105], v[180:181]
v_pk_add_f32 v[106:107], v[106:107], v[182:183]
v_cvt_pk_bf16_f32 v184, v64, v65
v_cvt_pk_bf16_f32 v185, v66, v67
v_cvt_pk_bf16_f32 v186, v104, v105
v_cvt_pk_bf16_f32 v187, v106, v107
ds_write_b128 v32, v[184:187] offset:0
buffer_load_dwordx4 v27, s[40:43], s64 offen offset:3072 lds
s_add_u32 m0, s69, 4096
s_nop 0
buffer_load_dwordx4 v28, s[40:43], s64 offen offset:0 lds
v_pk_mul_f32 v[176:177], v[68:69], v[172:173]
v_pk_mul_f32 v[178:179], v[70:71], v[172:173]
v_pk_mul_f32 v[180:181], v[108:109], v[172:173]
v_pk_mul_f32 v[182:183], v[110:111], v[172:173]
v_min_f32 v176, 0, v176
v_min_f32 v177, 0, v177
v_min_f32 v178, 0, v178
v_min_f32 v179, 0, v179
v_min_f32 v180, 0, v180
v_min_f32 v181, 0, v181
v_min_f32 v182, 0, v182
v_min_f32 v183, 0, v183
v_exp_f32 v176, v176
v_exp_f32 v177, v177
v_exp_f32 v178, v178
v_exp_f32 v179, v179
v_exp_f32 v180, v180
v_exp_f32 v181, v181
v_exp_f32 v182, v182
v_exp_f32 v183, v183
v_max_f32 v68, 0, v68
v_max_f32 v69, 0, v69
v_max_f32 v70, 0, v70
v_max_f32 v71, 0, v71
v_max_f32 v108, 0, v108
v_max_f32 v109, 0, v109
v_max_f32 v110, 0, v110
v_max_f32 v111, 0, v111
v_pk_add_f32 v[176:177], v[176:177], v[174:175]
v_pk_add_f32 v[178:179], v[178:179], v[174:175]
v_pk_add_f32 v[180:181], v[180:181], v[174:175]
v_pk_add_f32 v[182:183], v[182:183], v[174:175]
v_pk_add_f32 v[68:69], v[68:69], v[176:177]
v_pk_add_f32 v[70:71], v[70:71], v[178:179]
v_pk_add_f32 v[108:109], v[108:109], v[180:181]
v_pk_add_f32 v[110:111], v[110:111], v[182:183]
v_cvt_pk_bf16_f32 v188, v68, v69
v_cvt_pk_bf16_f32 v189, v70, v71
v_cvt_pk_bf16_f32 v190, v108, v109
v_cvt_pk_bf16_f32 v191, v110, v111
ds_write_b128 v32, v[188:191] offset:1024
s_add_u32 m0, s69, 5120
s_add_u32 s64, s70, 40960
buffer_load_dwordx4 v24, s[40:43], s64 offen offset:0 lds
buffer_load_dwordx4 v25, s[40:43], s64 offen offset:1024 lds
v_pk_mul_f32 v[176:177], v[72:73], v[172:173]
v_pk_mul_f32 v[178:179], v[74:75], v[172:173]
v_pk_mul_f32 v[180:181], v[112:113], v[172:173]
v_pk_mul_f32 v[182:183], v[114:115], v[172:173]
v_min_f32 v176, 0, v176
v_min_f32 v177, 0, v177
v_min_f32 v178, 0, v178
v_min_f32 v179, 0, v179
v_min_f32 v180, 0, v180
v_min_f32 v181, 0, v181
v_min_f32 v182, 0, v182
v_min_f32 v183, 0, v183
v_exp_f32 v176, v176
v_exp_f32 v177, v177
v_exp_f32 v178, v178
v_exp_f32 v179, v179
v_exp_f32 v180, v180
v_exp_f32 v181, v181
v_exp_f32 v182, v182
v_exp_f32 v183, v183
v_max_f32 v72, 0, v72
v_max_f32 v73, 0, v73
v_max_f32 v74, 0, v74
v_max_f32 v75, 0, v75
v_max_f32 v112, 0, v112
v_max_f32 v113, 0, v113
v_max_f32 v114, 0, v114
v_max_f32 v115, 0, v115
v_pk_add_f32 v[176:177], v[176:177], v[174:175]
v_pk_add_f32 v[178:179], v[178:179], v[174:175]
v_pk_add_f32 v[180:181], v[180:181], v[174:175]
v_pk_add_f32 v[182:183], v[182:183], v[174:175]
v_pk_add_f32 v[72:73], v[72:73], v[176:177]
v_pk_add_f32 v[74:75], v[74:75], v[178:179]
v_pk_add_f32 v[112:113], v[112:113], v[180:181]
v_pk_add_f32 v[114:115], v[114:115], v[182:183]
v_cvt_pk_bf16_f32 v192, v72, v73
v_cvt_pk_bf16_f32 v193, v74, v75
v_cvt_pk_bf16_f32 v194, v112, v113
v_cvt_pk_bf16_f32 v195, v114, v115
ds_write_b128 v32, v[192:195] offset:2048
buffer_load_dwordx4 v26, s[40:43], s64 offen offset:2048 lds
buffer_load_dwordx4 v27, s[40:43], s64 offen offset:3072 lds
v_pk_mul_f32 v[176:177], v[76:77], v[172:173]
v_pk_mul_f32 v[178:179], v[78:79], v[172:173]
v_pk_mul_f32 v[180:181], v[116:117], v[172:173]
v_pk_mul_f32 v[182:183], v[118:119], v[172:173]
v_min_f32 v176, 0, v176
v_min_f32 v177, 0, v177
v_min_f32 v178, 0, v178
v_min_f32 v179, 0, v179
v_min_f32 v180, 0, v180
v_min_f32 v181, 0, v181
v_min_f32 v182, 0, v182
v_min_f32 v183, 0, v183
v_exp_f32 v176, v176
v_exp_f32 v177, v177
v_exp_f32 v178, v178
v_exp_f32 v179, v179
v_exp_f32 v180, v180
v_exp_f32 v181, v181
v_exp_f32 v182, v182
v_exp_f32 v183, v183
v_max_f32 v76, 0, v76
v_max_f32 v77, 0, v77
v_max_f32 v78, 0, v78
v_max_f32 v79, 0, v79
v_max_f32 v116, 0, v116
v_max_f32 v117, 0, v117
v_max_f32 v118, 0, v118
v_max_f32 v119, 0, v119
v_pk_add_f32 v[176:177], v[176:177], v[174:175]
v_pk_add_f32 v[178:179], v[178:179], v[174:175]
v_pk_add_f32 v[180:181], v[180:181], v[174:175]
v_pk_add_f32 v[182:183], v[182:183], v[174:175]
v_pk_add_f32 v[76:77], v[76:77], v[176:177]
v_pk_add_f32 v[78:79], v[78:79], v[178:179]
v_pk_add_f32 v[116:117], v[116:117], v[180:181]
v_pk_add_f32 v[118:119], v[118:119], v[182:183]
v_cvt_pk_bf16_f32 v196, v76, v77
v_cvt_pk_bf16_f32 v197, v78, v79
v_cvt_pk_bf16_f32 v198, v116, v117
v_cvt_pk_bf16_f32 v199, v118, v119
ds_write_b128 v32, v[196:199] offset:3072
s_add_u32 m0, s69, 9216
s_nop 0
buffer_load_dwordx4 v28, s[40:43], s64 offen offset:0 lds
s_add_u32 m0, s69, 10240
s_add_u32 s64, s70, 81920
buffer_load_dwordx4 v24, s[40:43], s64 offen offset:0 lds
v_pk_mul_f32 v[176:177], v[80:81], v[172:173]
v_pk_mul_f32 v[178:179], v[82:83], v[172:173]
v_pk_mul_f32 v[180:181], v[120:121], v[172:173]
v_pk_mul_f32 v[182:183], v[122:123], v[172:173]
v_min_f32 v176, 0, v176
v_min_f32 v177, 0, v177
v_min_f32 v178, 0, v178
v_min_f32 v179, 0, v179
v_min_f32 v180, 0, v180
v_min_f32 v181, 0, v181
v_min_f32 v182, 0, v182
v_min_f32 v183, 0, v183
v_exp_f32 v176, v176
v_exp_f32 v177, v177
v_exp_f32 v178, v178
v_exp_f32 v179, v179
v_exp_f32 v180, v180
v_exp_f32 v181, v181
v_exp_f32 v182, v182
v_exp_f32 v183, v183
v_max_f32 v80, 0, v80
v_max_f32 v81, 0, v81
v_max_f32 v82, 0, v82
v_max_f32 v83, 0, v83
v_max_f32 v120, 0, v120
v_max_f32 v121, 0, v121
v_max_f32 v122, 0, v122
v_max_f32 v123, 0, v123
v_pk_add_f32 v[176:177], v[176:177], v[174:175]
v_pk_add_f32 v[178:179], v[178:179], v[174:175]
v_pk_add_f32 v[180:181], v[180:181], v[174:175]
v_pk_add_f32 v[182:183], v[182:183], v[174:175]
v_pk_add_f32 v[80:81], v[80:81], v[176:177]
v_pk_add_f32 v[82:83], v[82:83], v[178:179]
v_pk_add_f32 v[120:121], v[120:121], v[180:181]
v_pk_add_f32 v[122:123], v[122:123], v[182:183]
v_cvt_pk_bf16_f32 v184, v80, v81
v_cvt_pk_bf16_f32 v185, v82, v83
v_cvt_pk_bf16_f32 v186, v120, v121
v_cvt_pk_bf16_f32 v187, v122, v123
ds_write_b128 v32, v[184:187] offset:4096
buffer_load_dwordx4 v25, s[40:43], s64 offen offset:1024 lds
buffer_load_dwordx4 v26, s[40:43], s64 offen offset:2048 lds
buffer_load_dwordx4 v27, s[40:43], s64 offen offset:3072 lds
s_add_u32 m0, s69, 14336
s_nop 0
buffer_load_dwordx4 v28, s[40:43], s64 offen offset:0 lds
s_add_u32 m0, s69, 15360
s_add_u32 s64, s70, 122880
buffer_load_dwordx4 v24, s[40:43], s64 offen offset:0 lds
buffer_load_dwordx4 v25, s[40:43], s64 offen offset:1024 lds
buffer_load_dwordx4 v26, s[40:43], s64 offen offset:2048 lds
s_waitcnt lgkmcnt(0)
s_barrier
s_lshl_b32 s71, s3, 10
s_add_u32 s71, s71, 109568
v_add_u32 v32, s71, v31
s_cmp_eq_u32 s3, 0
s_movk_i32 s72, 4096
s_cselect_b32 s72, 3072, s72
s_cmp_eq_u32 s3, 3
s_cselect_b32 s72, 1024, s72
s_add_u32 s72, s72, 110592
v_add_u32 v33, s72, v31
v_add_u32 v34, 119808, v31
v_mov_b32 v200, 0
v_mov_b32 v201, 0
v_mov_b32 v202, 0
v_mov_b32 v203, 0
v_mov_b32 v204, 0
v_mov_b32 v205, 0
v_mov_b32 v206, 0
v_mov_b32 v207, 0
v_mov_b32 v208, 0
v_mov_b32 v209, 0
v_mov_b32 v210, 0
v_mov_b32 v211, 0
v_mov_b32 v212, 0
v_mov_b32 v213, 0
v_mov_b32 v214, 0
v_mov_b32 v215, 0
v_mov_b32 v216, 0
v_mov_b32 v217, 0
v_mov_b32 v218, 0
v_mov_b32 v219, 0
v_mov_b32 v220, 0
v_mov_b32 v221, 0
v_mov_b32 v222, 0
v_mov_b32 v223, 0
ds_read_b128 a[96:99], v32 offset:0
ds_read_b128 a[100:103], v32 offset:1024
ds_read_b128 a[104:107], v32 offset:2048
ds_read_b128 a[108:111], v32 offset:6144
ds_read_b128 a[112:115], v33 offset:0
ds_read_b128 a[116:119], v34 offset:0
ds_read_b128 a[120:123], v32 offset:10240
ds_read_b128 a[124:127], v32 offset:11264
ds_read_b128 a[128:131], v32 offset:12288
ds_read_b128 a[132:135], v32 offset:16384
ds_read_b128 a[136:139], v33 offset:10240
ds_read_b128 a[140:143], v34 offset:10240
s_waitcnt lgkmcnt(6)
v_mfma_f32_16x16x32_bf16 v[200:203], a[96:99], a[108:111], v[200:203]
v_mfma_f32_16x16x32_bf16 v[204:207], a[100:103], a[108:111], v[204:207]
v_mfma_f32_16x16x32_bf16 v[208:211], a[104:107], a[108:111], v[208:211]
v_mfma_f32_16x16x32_bf16 v[212:215], a[100:103], a[76:79], v[212:215]
v_mfma_f32_16x16x32_bf16 v[216:219], a[112:115], a[116:119], v[216:219]
v_mfma_f32_16x16x32_bf16 v[220:223], a[112:115], a[76:79], v[220:223]
ds_read_b128 a[144:147], v32 offset:20480
ds_read_b128 a[148:151], v32 offset:21504
ds_read_b128 a[152:155], v32 offset:22528
ds_read_b128 a[156:159], v32 offset:26624
ds_read_b128 a[160:163], v33 offset:20480
ds_read_b128 a[164:167], v34 offset:20480
s_waitcnt lgkmcnt(6)
v_mfma_f32_16x16x32_bf16 v[200:203], a[120:123], a[132:135], v[200:203]
v_mfma_f32_16x16x32_bf16 v[204:207], a[124:127], a[132:135], v[204:207]
v_mfma_f32_16x16x32_bf16 v[208:211], a[128:131], a[132:135], v[208:211]
v_mfma_f32_16x16x32_bf16 v[212:215], a[124:127], a[76:79], v[212:215]
v_mfma_f32_16x16x32_bf16 v[216:219], a[136:139], a[140:143], v[216:219]
v_mfma_f32_16x16x32_bf16 v[220:223], a[136:139], a[76:79], v[220:223]
ds_read_b128 a[168:171], v32 offset:30720
ds_read_b128 a[172:175], v32 offset:31744
ds_read_b128 a[176:179], v32 offset:32768
ds_read_b128 a[180:183], v32 offset:36864
ds_read_b128 a[184:187], v33 offset:30720
ds_read_b128 a[188:191], v34 offset:30720
s_waitcnt lgkmcnt(6)
v_mfma_f32_16x16x32_bf16 v[200:203], a[144:147], a[156:159], v[200:203]
v_mfma_f32_16x16x32_bf16 v[204:207], a[148:151], a[156:159], v[204:207]
v_mfma_f32_16x16x32_bf16 v[208:211], a[152:155], a[156:159], v[208:211]
v_mfma_f32_16x16x32_bf16 v[212:215], a[148:151], a[76:79], v[212:215]
v_mfma_f32_16x16x32_bf16 v[216:219], a[160:163], a[164:167], v[216:219]
v_mfma_f32_16x16x32_bf16 v[220:223], a[160:163], a[76:79], v[220:223]
s_waitcnt lgkmcnt(0)
v_mfma_f32_16x16x32_bf16 v[200:203], a[168:171], a[180:183], v[200:203]
v_mfma_f32_16x16x32_bf16 v[204:207], a[172:175], a[180:183], v[204:207]
v_mfma_f32_16x16x32_bf16 v[208:211], a[176:179], a[180:183], v[208:211]
v_mfma_f32_16x16x32_bf16 v[212:215], a[172:175], a[76:79], v[212:215]
v_mfma_f32_16x16x32_bf16 v[216:219], a[184:187], a[188:191], v[216:219]
v_mfma_f32_16x16x32_bf16 v[220:223], a[184:187], a[76:79], v[220:223]
s_mul_i32 s71, s31, 131072
s_lshl_b32 s73, s30, 10
s_add_u32 s71, s71, s73
s_lshl_b32 s73, s3, 15
s_add_u32 s71, s71, s73
s_add_u32 s71, s71, 5242880
s_add_u32 s74, s71, 16384
s_cmp_eq_u32 s3, 3
s_cselect_b32 s73, 1, 4
v_cmp_eq_u32 s[78:79], s73, v3
s_nop 1
v_cvt_pk_bf16_f32 v224, v204, v205
v_cvt_pk_bf16_f32 v225, v206, v207
v_cvt_pk_bf16_f32 v226, v208, v209
v_cvt_pk_bf16_f32 v227, v210, v211
buffer_store_dwordx4 v[224:227], v31, s[44:47], s71 offen sc1
v_cvt_pk_bf16_f32 v228, v200, v201
v_cvt_pk_bf16_f32 v229, v202, v203
v_cvt_pk_bf16_f32 v230, v216, v217
v_cvt_pk_bf16_f32 v231, v218, v219
v_cvt_pk_bf16_f32 v232, v212, v213
v_cvt_pk_bf16_f32 v233, v214, v215
v_cvt_pk_bf16_f32 v234, v220, v221
v_cvt_pk_bf16_f32 v235, v222, v223
s_cmp_eq_u32 s3, 0
s_cbranch_scc0 L_kv_n0
v_mov_b32 v228, v232
v_mov_b32 v229, v233
L_kv_n0:
s_cmp_lt_u32 s3, 2
s_cbranch_scc1 L_kv_n2
v_cndmask_b32 v230, v232, v234, s[78:79]
v_cndmask_b32 v231, v233, v235, s[78:79]
L_kv_n2:
buffer_store_dwordx4 v[228:231], v31, s[44:47], s74 offen sc1
v_readfirstlane_b32 s90, v59
s_mov_b32 s91, 0x40000
s_nop 2
L_tag_get_kv:
s_cmp_lg_u32 s90, 0
s_cbranch_scc1 L_tag_got_kv
s_sub_u32 s91, s91, 1
s_cmp_eq_u32 s91, 0
s_cbranch_scc1 L_tag_got_kv
global_load_dword v59, v63, s[34:35] sc1
s_waitcnt vmcnt(0)
v_readfirstlane_b32 s90, v59
s_nop 2
s_branch L_tag_get_kv
L_tag_got_kv:
s_lshl_b32 s72, s31, 7
s_lshl_b32 s73, s30, 2
s_add_u32 s72, s72, s73
s_add_u32 s72, s72, 28508160
buffer_load_dwordx4 v27, s[40:43], s64 offen offset:3072 lds
s_add_u32 m0, s69, 19456
s_nop 0
buffer_load_dwordx4 v28, s[40:43], s64 offen offset:0 lds
s_add_u32 m0, s69, 20480
s_add_u32 s64, s70, 163840
buffer_load_dwordx4 v24, s[40:43], s64 offen offset:0 lds
buffer_load_dwordx4 v25, s[40:43], s64 offen offset:1024 lds
buffer_load_dwordx4 v26, s[40:43], s64 offen offset:2048 lds
buffer_load_dwordx4 v27, s[40:43], s64 offen offset:3072 lds
s_add_u32 m0, s69, 24576
s_nop 0
buffer_load_dwordx4 v28, s[40:43], s64 offen offset:0 lds
s_waitcnt vmcnt(7) lgkmcnt(0)
s_barrier
s_cmp_eq_u32 s3, 0
s_cbranch_scc0 L_pub_p1kv
v_mov_b32 v60, s90
v_mov_b32 v61, 0
s_mov_b64 s[94:95], exec
s_mov_b64 exec, 1
buffer_store_dword v60, v61, s[44:47], s72 offen sc1
s_mov_b64 exec, s[94:95]
L_pub_p1kv:
s_branch L_k1_fin
L_k1_q:
ds_read_b128 a[0:3], v22 offset:0
ds_read_b128 a[4:7], v22 offset:2048
ds_read_b64_tr_b16 a[16:17], v24 offset:0
ds_read_b64_tr_b16 a[18:19], v24 offset:1280
ds_read_b64_tr_b16 a[20:21], v24 offset:32
ds_read_b64_tr_b16 a[22:23], v24 offset:1312
ds_read_b64_tr_b16 a[24:25], v24 offset:64
ds_read_b64_tr_b16 a[26:27], v24 offset:1344
ds_read_b64_tr_b16 a[28:29], v24 offset:96
ds_read_b64_tr_b16 a[30:31], v24 offset:1376
ds_read_b64_tr_b16 a[32:33], v24 offset:128
ds_read_b64_tr_b16 a[34:35], v24 offset:1408
s_waitcnt lgkmcnt(10)
s_mov_b32 s63, 0
L_loopA_q:
s_waitcnt lgkmcnt(8)
v_mfma_f32_16x16x32_bf16 v[64:67], a[16:19], a[0:3], v[64:67]
ds_read_b64_tr_b16 a[36:37], v24 offset:160
ds_read_b64_tr_b16 a[38:39], v24 offset:1440
v_mfma_f32_16x16x32_bf16 v[104:107], a[16:19], a[4:7], v[104:107]
s_add_u32 s68, s68, 36864
s_add_u32 m0, s67, s69
s_waitcnt lgkmcnt(8)
v_mfma_f32_16x16x32_bf16 v[68:71], a[20:23], a[0:3], v[68:71]
ds_read_b64_tr_b16 a[40:41], v24 offset:192
ds_read_b64_tr_b16 a[42:43], v24 offset:1472
s_cmp_eq_u32 s68, 147456
s_cselect_b32 s68, 0, s68
v_mfma_f32_16x16x32_bf16 v[108:111], a[20:23], a[4:7], v[108:111]
ds_read_b128 a[8:11], v23 offset:0
buffer_load_dwordx4 v4, s[36:39], s64 offen offset:0 lds
s_waitcnt lgkmcnt(9)
v_mfma_f32_16x16x32_bf16 v[72:75], a[24:27], a[0:3], v[72:75]
ds_read_b64_tr_b16 a[44:45], v24 offset:224
ds_read_b64_tr_b16 a[46:47], v24 offset:1504
v_mfma_f32_16x16x32_bf16 v[112:115], a[24:27], a[4:7], v[112:115]
v_add_u32 v22, s68, v13
ds_read_b128 a[12:15], v23 offset:2048
s_waitcnt lgkmcnt(10)
v_mfma_f32_16x16x32_bf16 v[76:79], a[28:31], a[0:3], v[76:79]
ds_read_b64_tr_b16 a[48:49], v24 offset:256
ds_read_b64_tr_b16 a[50:51], v24 offset:1536
v_mfma_f32_16x16x32_bf16 v[116:119], a[28:31], a[4:7], v[116:119]
buffer_load_dwordx4 v5, s[36:39], s64 offen offset:1024 lds
s_waitcnt lgkmcnt(10)
v_mfma_f32_16x16x32_bf16 v[80:83], a[32:35], a[0:3], v[80:83]
ds_read_b64_tr_b16 a[52:53], v25 offset:0
v_mfma_f32_16x16x32_bf16 v[120:123], a[32:35], a[4:7], v[120:123]
ds_read_b64_tr_b16 a[54:55], v25 offset:1280
s_waitcnt lgkmcnt(10)
v_mfma_f32_16x16x32_bf16 v[84:87], a[36:39], a[0:3], v[84:87]
ds_read_b64_tr_b16 a[16:17], v24 offset:10240
ds_read_b64_tr_b16 a[18:19], v24 offset:11520
v_mfma_f32_16x16x32_bf16 v[124:127], a[36:39], a[4:7], v[124:127]
buffer_load_dwordx4 v6, s[36:39], s64 offen offset:2048 lds
s_waitcnt lgkmcnt(10)
v_mfma_f32_16x16x32_bf16 v[88:91], a[40:43], a[0:3], v[88:91]
ds_read_b64_tr_b16 a[20:21], v24 offset:10272
v_mfma_f32_16x16x32_bf16 v[128:131], a[40:43], a[4:7], v[128:131]
ds_read_b64_tr_b16 a[22:23], v24 offset:11552
s_waitcnt lgkmcnt(9)
v_mfma_f32_16x16x32_bf16 v[92:95], a[44:47], a[0:3], v[92:95]
ds_read_b64_tr_b16 a[24:25], v24 offset:10304
ds_read_b64_tr_b16 a[26:27], v24 offset:11584
v_mfma_f32_16x16x32_bf16 v[132:135], a[44:47], a[4:7], v[132:135]
buffer_load_dwordx4 v7, s[36:39], s64 offen offset:3072 lds
s_waitcnt lgkmcnt(8)
v_mfma_f32_16x16x32_bf16 v[96:99], a[48:51], a[0:3], v[96:99]
ds_read_b64_tr_b16 a[28:29], v24 offset:10336
ds_read_b64_tr_b16 a[30:31], v24 offset:11616
v_mfma_f32_16x16x32_bf16 v[136:139], a[48:51], a[4:7], v[136:139]
s_add_u32 m0, s67, s70
s_waitcnt lgkmcnt(8)
v_mfma_f32_16x16x32_bf16 v[100:103], a[52:55], a[0:3], v[100:103]
ds_read_b64_tr_b16 a[32:33], v24 offset:10368
ds_read_b64_tr_b16 a[34:35], v24 offset:11648
v_mfma_f32_16x16x32_bf16 v[140:143], a[52:55], a[4:7], v[140:143]
buffer_load_dwordx4 v8, s[40:43], s65 offen offset:0 lds
s_waitcnt vmcnt(6)
s_barrier
s_waitcnt lgkmcnt(8)
v_mfma_f32_16x16x32_bf16 v[64:67], a[16:19], a[8:11], v[64:67]
ds_read_b64_tr_b16 a[36:37], v24 offset:10400
v_mfma_f32_16x16x32_bf16 v[104:107], a[16:19], a[12:15], v[104:107]
ds_read_b64_tr_b16 a[38:39], v24 offset:11680
s_waitcnt lgkmcnt(8)
v_mfma_f32_16x16x32_bf16 v[68:71], a[20:23], a[8:11], v[68:71]
ds_read_b64_tr_b16 a[40:41], v24 offset:10432
ds_read_b64_tr_b16 a[42:43], v24 offset:11712
v_mfma_f32_16x16x32_bf16 v[108:111], a[20:23], a[12:15], v[108:111]
ds_read_b128 a[0:3], v22 offset:0
buffer_load_dwordx4 v9, s[40:43], s65 offen offset:1024 lds
s_waitcnt lgkmcnt(9)
v_mfma_f32_16x16x32_bf16 v[72:75], a[24:27], a[8:11], v[72:75]
ds_read_b64_tr_b16 a[44:45], v24 offset:10464
ds_read_b64_tr_b16 a[46:47], v24 offset:11744
v_mfma_f32_16x16x32_bf16 v[112:115], a[24:27], a[12:15], v[112:115]
ds_read_b128 a[4:7], v22 offset:2048
s_waitcnt lgkmcnt(10)
v_mfma_f32_16x16x32_bf16 v[76:79], a[28:31], a[8:11], v[76:79]
ds_read_b64_tr_b16 a[48:49], v24 offset:10496
ds_read_b64_tr_b16 a[50:51], v24 offset:11776
v_mfma_f32_16x16x32_bf16 v[116:119], a[28:31], a[12:15], v[116:119]
buffer_load_dwordx4 v10, s[40:43], s65 offen offset:2048 lds
s_waitcnt lgkmcnt(10)
v_mfma_f32_16x16x32_bf16 v[80:83], a[32:35], a[8:11], v[80:83]
ds_read_b64_tr_b16 a[52:53], v25 offset:10240
ds_read_b64_tr_b16 a[54:55], v25 offset:11520
v_mfma_f32_16x16x32_bf16 v[120:123], a[32:35], a[12:15], v[120:123]
v_add_u32 v23, s68, v14
s_waitcnt lgkmcnt(10)
v_mfma_f32_16x16x32_bf16 v[84:87], a[36:39], a[8:11], v[84:87]
v_add_u32 v24, s68, v15
ds_read_b64_tr_b16 a[16:17], v24 offset:0
v_mfma_f32_16x16x32_bf16 v[124:127], a[36:39], a[12:15], v[124:127]
ds_read_b64_tr_b16 a[18:19], v24 offset:1280
s_waitcnt lgkmcnt(10)
v_mfma_f32_16x16x32_bf16 v[88:91], a[40:43], a[8:11], v[88:91]
ds_read_b64_tr_b16 a[20:21], v24 offset:32
ds_read_b64_tr_b16 a[22:23], v24 offset:1312
v_mfma_f32_16x16x32_bf16 v[128:131], a[40:43], a[12:15], v[128:131]
v_add_u32 v25, s68, v16
buffer_load_dwordx4 v11, s[40:43], s65 offen offset:3072 lds
s_waitcnt lgkmcnt(9)
v_mfma_f32_16x16x32_bf16 v[92:95], a[44:47], a[8:11], v[92:95]
ds_read_b64_tr_b16 a[24:25], v24 offset:64
ds_read_b64_tr_b16 a[26:27], v24 offset:1344
v_mfma_f32_16x16x32_bf16 v[132:135], a[44:47], a[12:15], v[132:135]
s_add_u32 m0, s67, s89
s_waitcnt lgkmcnt(8)
v_mfma_f32_16x16x32_bf16 v[96:99], a[48:51], a[8:11], v[96:99]
ds_read_b64_tr_b16 a[28:29], v24 offset:96
ds_read_b64_tr_b16 a[30:31], v24 offset:1376
v_mfma_f32_16x16x32_bf16 v[136:139], a[48:51], a[12:15], v[136:139]
buffer_load_dwordx4 v12, s[40:43], s65 offen lds
s_waitcnt lgkmcnt(8)
v_mfma_f32_16x16x32_bf16 v[100:103], a[52:55], a[8:11], v[100:103]
ds_read_b64_tr_b16 a[32:33], v24 offset:128
ds_read_b64_tr_b16 a[34:35], v24 offset:1408
v_mfma_f32_16x16x32_bf16 v[140:143], a[52:55], a[12:15], v[140:143]
buffer_load_dword v51, v29, s[48:51], s91 offen
s_lshl_b32 s74, s87, 5
s_add_u32 s91, s91, s74
s_add_u32 s64, s64, 128
s_add_u32 s65, s65, s66
s_add_u32 s67, s67, 36864
s_cmp_eq_u32 s67, 147456
s_cselect_b32 s67, 0, s67
s_add_u32 s63, s63, 1
s_cmp_lt_u32 s63, 8
s_cbranch_scc1 L_loopA_q
v_mov_b32 v63, 0
global_load_dword v59, v63, s[34:35] sc1
s_getpc_b64 s[96:97]
L_pfr_L_code_p2_3:
s_add_u32 s96, s96, L_code_p2 - L_pfr_L_code_p2_3
s_addc_u32 s97, s97, 0
v_lshrrev_b32 v62, 6, v0
v_and_b32 v61, 0, v0
v_mad_u32_u24 v62, v62, 1, v61
s_lshr_b32 s95, s2, 3
s_mul_i32 s95, s95, 4
v_add_u32 v62, s95, v62
v_min_u32 v62, (L_code_p3 - L_code_p2) >> 7, v62
v_lshlrev_b32 v62, 7, v62
global_load_dword v55, v62, s[96:97]
s_lshl_b32 s73, s3, 10
s_add_u32 s73, s73, 73728
s_lshl_b32 s74, s87, 5
s_mov_b32 s88, 0
s_add_u32 m0, s73, 0
s_nop 0
buffer_load_dwordx4 v29, s[48:51], s88 offen lds
s_add_u32 m0, s73, 4096
s_add_u32 s88, s88, s74
buffer_load_dwordx4 v29, s[48:51], s88 offen lds
s_add_u32 m0, s73, 8192
s_add_u32 s88, s88, s74
buffer_load_dwordx4 v29, s[48:51], s88 offen lds
s_add_u32 m0, s73, 12288
s_add_u32 s88, s88, s74
buffer_load_dwordx4 v29, s[48:51], s88 offen lds
s_add_u32 m0, s73, 16384
s_add_u32 s88, s88, s74
buffer_load_dwordx4 v29, s[48:51], s88 offen lds
s_add_u32 m0, s73, 20480
s_add_u32 s88, s88, s74
buffer_load_dwordx4 v29, s[48:51], s88 offen lds
s_add_u32 m0, s73, 24576
s_add_u32 s88, s88, s74
buffer_load_dwordx4 v29, s[48:51], s88 offen lds
L_loopB_q:
s_waitcnt lgkmcnt(8)
v_mfma_f32_16x16x32_bf16 v[64:67], a[16:19], a[0:3], v[64:67]
ds_read_b64_tr_b16 a[36:37], v24 offset:160
ds_read_b64_tr_b16 a[38:39], v24 offset:1440
v_mfma_f32_16x16x32_bf16 v[104:107], a[16:19], a[4:7], v[104:107]
s_add_u32 s68, s68, 36864
s_waitcnt lgkmcnt(8)
v_mfma_f32_16x16x32_bf16 v[68:71], a[20:23], a[0:3], v[68:71]
ds_read_b64_tr_b16 a[40:41], v24 offset:192
ds_read_b64_tr_b16 a[42:43], v24 offset:1472
v_mfma_f32_16x16x32_bf16 v[108:111], a[20:23], a[4:7], v[108:111]
s_cmp_eq_u32 s68, 147456
s_cselect_b32 s68, 0, s68
ds_read_b128 a[8:11], v23 offset:0
s_waitcnt lgkmcnt(9)
v_mfma_f32_16x16x32_bf16 v[72:75], a[24:27], a[0:3], v[72:75]
ds_read_b64_tr_b16 a[44:45], v24 offset:224
ds_read_b64_tr_b16 a[46:47], v24 offset:1504
v_mfma_f32_16x16x32_bf16 v[112:115], a[24:27], a[4:7], v[112:115]
v_add_u32 v22, s68, v13
ds_read_b128 a[12:15], v23 offset:2048
s_waitcnt lgkmcnt(10)
v_mfma_f32_16x16x32_bf16 v[76:79], a[28:31], a[0:3], v[76:79]
ds_read_b64_tr_b16 a[48:49], v24 offset:256
v_mfma_f32_16x16x32_bf16 v[116:119], a[28:31], a[4:7], v[116:119]
ds_read_b64_tr_b16 a[50:51], v24 offset:1536
s_waitcnt lgkmcnt(10)
v_mfma_f32_16x16x32_bf16 v[80:83], a[32:35], a[0:3], v[80:83]
ds_read_b64_tr_b16 a[52:53], v25 offset:0
v_mfma_f32_16x16x32_bf16 v[120:123], a[32:35], a[4:7], v[120:123]
ds_read_b64_tr_b16 a[54:55], v25 offset:1280
s_waitcnt lgkmcnt(10)
v_mfma_f32_16x16x32_bf16 v[84:87], a[36:39], a[0:3], v[84:87]
ds_read_b64_tr_b16 a[16:17], v24 offset:10240
v_mfma_f32_16x16x32_bf16 v[124:127], a[36:39], a[4:7], v[124:127]
ds_read_b64_tr_b16 a[18:19], v24 offset:11520
s_waitcnt lgkmcnt(10)
v_mfma_f32_16x16x32_bf16 v[88:91], a[40:43], a[0:3], v[88:91]
ds_read_b64_tr_b16 a[20:21], v24 offset:10272
v_mfma_f32_16x16x32_bf16 v[128:131], a[40:43], a[4:7], v[128:131]
ds_read_b64_tr_b16 a[22:23], v24 offset:11552
s_waitcnt lgkmcnt(9)
v_mfma_f32_16x16x32_bf16 v[92:95], a[44:47], a[0:3], v[92:95]
ds_read_b64_tr_b16 a[24:25], v24 offset:10304
v_mfma_f32_16x16x32_bf16 v[132:135], a[44:47], a[4:7], v[132:135]
ds_read_b64_tr_b16 a[26:27], v24 offset:11584
s_waitcnt lgkmcnt(8)
v_mfma_f32_16x16x32_bf16 v[96:99], a[48:51], a[0:3], v[96:99]
ds_read_b64_tr_b16 a[28:29], v24 offset:10336
v_mfma_f32_16x16x32_bf16 v[136:139], a[48:51], a[4:7], v[136:139]
ds_read_b64_tr_b16 a[30:31], v24 offset:11616
s_waitcnt lgkmcnt(8)
v_mfma_f32_16x16x32_bf16 v[100:103], a[52:55], a[0:3], v[100:103]
ds_read_b64_tr_b16 a[32:33], v24 offset:10368
v_mfma_f32_16x16x32_bf16 v[140:143], a[52:55], a[4:7], v[140:143]
ds_read_b64_tr_b16 a[34:35], v24 offset:11648
s_cmp_eq_u32 s63, 8
s_cbranch_scc0 L_wd_q_b
s_waitcnt vmcnt(7)
L_wd_q_b:
s_barrier
s_waitcnt lgkmcnt(8)
v_mfma_f32_16x16x32_bf16 v[64:67], a[16:19], a[8:11], v[64:67]
ds_read_b64_tr_b16 a[36:37], v24 offset:10400
v_mfma_f32_16x16x32_bf16 v[104:107], a[16:19], a[12:15], v[104:107]
ds_read_b64_tr_b16 a[38:39], v24 offset:11680
s_waitcnt lgkmcnt(8)
v_mfma_f32_16x16x32_bf16 v[68:71], a[20:23], a[8:11], v[68:71]
ds_read_b64_tr_b16 a[40:41], v24 offset:10432
ds_read_b64_tr_b16 a[42:43], v24 offset:11712
v_mfma_f32_16x16x32_bf16 v[108:111], a[20:23], a[12:15], v[108:111]
ds_read_b128 a[0:3], v22 offset:0
s_waitcnt lgkmcnt(9)
v_mfma_f32_16x16x32_bf16 v[72:75], a[24:27], a[8:11], v[72:75]
ds_read_b64_tr_b16 a[44:45], v24 offset:10464
ds_read_b64_tr_b16 a[46:47], v24 offset:11744
v_mfma_f32_16x16x32_bf16 v[112:115], a[24:27], a[12:15], v[112:115]
ds_read_b128 a[4:7], v22 offset:2048
s_waitcnt lgkmcnt(10)
v_mfma_f32_16x16x32_bf16 v[76:79], a[28:31], a[8:11], v[76:79]
ds_read_b64_tr_b16 a[48:49], v24 offset:10496
v_mfma_f32_16x16x32_bf16 v[116:119], a[28:31], a[12:15], v[116:119]
ds_read_b64_tr_b16 a[50:51], v24 offset:11776
s_waitcnt lgkmcnt(10)
v_mfma_f32_16x16x32_bf16 v[80:83], a[32:35], a[8:11], v[80:83]
ds_read_b64_tr_b16 a[52:53], v25 offset:10240
ds_read_b64_tr_b16 a[54:55], v25 offset:11520
v_mfma_f32_16x16x32_bf16 v[120:123], a[32:35], a[12:15], v[120:123]
v_add_u32 v23, s68, v14
s_waitcnt lgkmcnt(10)
v_mfma_f32_16x16x32_bf16 v[84:87], a[36:39], a[8:11], v[84:87]
v_add_u32 v24, s68, v15
ds_read_b64_tr_b16 a[16:17], v24 offset:0
v_mfma_f32_16x16x32_bf16 v[124:127], a[36:39], a[12:15], v[124:127]
ds_read_b64_tr_b16 a[18:19], v24 offset:1280
s_waitcnt lgkmcnt(10)
v_mfma_f32_16x16x32_bf16 v[88:91], a[40:43], a[8:11], v[88:91]
ds_read_b64_tr_b16 a[20:21], v24 offset:32
ds_read_b64_tr_b16 a[22:23], v24 offset:1312
v_mfma_f32_16x16x32_bf16 v[128:131], a[40:43], a[12:15], v[128:131]
v_add_u32 v25, s68, v16
s_waitcnt lgkmcnt(9)
v_mfma_f32_16x16x32_bf16 v[92:95], a[44:47], a[8:11], v[92:95]
ds_read_b64_tr_b16 a[24:25], v24 offset:64
v_mfma_f32_16x16x32_bf16 v[132:135], a[44:47], a[12:15], v[132:135]
ds_read_b64_tr_b16 a[26:27], v24 offset:1344
s_waitcnt lgkmcnt(8)
v_mfma_f32_16x16x32_bf16 v[96:99], a[48:51], a[8:11], v[96:99]
ds_read_b64_tr_b16 a[28:29], v24 offset:96
v_mfma_f32_16x16x32_bf16 v[136:139], a[48:51], a[12:15], v[136:139]
ds_read_b64_tr_b16 a[30:31], v24 offset:1376
s_waitcnt lgkmcnt(8)
v_mfma_f32_16x16x32_bf16 v[100:103], a[52:55], a[8:11], v[100:103]
ds_read_b64_tr_b16 a[32:33], v24 offset:128
v_mfma_f32_16x16x32_bf16 v[140:143], a[52:55], a[12:15], v[140:143]
ds_read_b64_tr_b16 a[34:35], v24 offset:1408
s_add_u32 s63, s63, 1
s_cmp_lt_u32 s63, 10
s_cbranch_scc1 L_loopB_q
s_waitcnt vmcnt(0) lgkmcnt(0)
s_barrier
s_cmp_eq_u32 s82, 0
s_cbranch_scc1 L_rls_done_q
ds_read_b64_tr_b16 v[172:173], v30 offset:0
ds_read_b64_tr_b16 v[174:175], v30 offset:2048
ds_read_b64_tr_b16 v[176:177], v30 offset:4096
ds_read_b64_tr_b16 v[178:179], v30 offset:6144
ds_read_b64_tr_b16 v[180:181], v30 offset:8192
ds_read_b64_tr_b16 v[182:183], v30 offset:10240
ds_read_b64_tr_b16 v[184:185], v30 offset:12288
ds_read_b64_tr_b16 v[186:187], v30 offset:14336
ds_read_b64_tr_b16 v[188:189], v30 offset:16384
ds_read_b64_tr_b16 v[190:191], v30 offset:18432
ds_read_b64_tr_b16 v[192:193], v30 offset:20480
ds_read_b64_tr_b16 v[194:195], v30 offset:22528
ds_read_b64_tr_b16 v[196:197], v30 offset:24576
ds_read_b64_tr_b16 v[198:199], v30 offset:26624
v_mov_b32 v36, 0
v_mov_b32 v37, 0x3f803f80
s_waitcnt lgkmcnt(12)
buffer_store_dwordx4 v[172:175], v31, s[44:47], s83 offen sc1
s_add_u32 s83, s83, s84
s_waitcnt lgkmcnt(10)
buffer_store_dwordx4 v[176:179], v31, s[44:47], s83 offen sc1
s_add_u32 s83, s83, s84
s_waitcnt lgkmcnt(8)
buffer_store_dwordx4 v[180:183], v31, s[44:47], s83 offen sc1
s_add_u32 s83, s83, s84
s_waitcnt lgkmcnt(6)
buffer_store_dwordx4 v[184:187], v31, s[44:47], s83 offen sc1
s_add_u32 s83, s83, s84
s_waitcnt lgkmcnt(4)
buffer_store_dwordx4 v[188:191], v31, s[44:47], s83 offen sc1
s_add_u32 s83, s83, s84
s_cmp_le_u32 s82, 5
s_cbranch_scc1 L_rls_st_done_q
s_waitcnt lgkmcnt(2)
buffer_store_dwordx4 v[192:195], v31, s[44:47], s83 offen sc1
s_add_u32 s83, s83, s84
s_cmp_le_u32 s82, 6
s_cbranch_scc1 L_rls_st_done_q
s_waitcnt lgkmcnt(0)
buffer_store_dwordx4 v[196:199], v31, s[44:47], s83 offen sc1
s_add_u32 s83, s83, s84
L_rls_st_done_q:
s_waitcnt lgkmcnt(0)
s_cmp_eq_u32 s85, 0
s_cbranch_scc1 L_rls_done_q
v_mov_b32 v40, 0
v_mov_b32 v41, 0
v_mov_b32 v42, 0
v_dot2_f32_bf16 v36, v172, v37, v36
v_dot2_f32_bf16 v40, v173, v37, v40
v_dot2_f32_bf16 v41, v174, v37, v41
v_dot2_f32_bf16 v42, v175, v37, v42
v_dot2_f32_bf16 v36, v176, v37, v36
v_dot2_f32_bf16 v40, v177, v37, v40
v_dot2_f32_bf16 v41, v178, v37, v41
v_dot2_f32_bf16 v42, v179, v37, v42
v_dot2_f32_bf16 v36, v180, v37, v36
v_dot2_f32_bf16 v40, v181, v37, v40
v_dot2_f32_bf16 v41, v182, v37, v41
v_dot2_f32_bf16 v42, v183, v37, v42
v_dot2_f32_bf16 v36, v184, v37, v36
v_dot2_f32_bf16 v40, v185, v37, v40
v_dot2_f32_bf16 v41, v186, v37, v41
v_dot2_f32_bf16 v42, v187, v37, v42
v_dot2_f32_bf16 v36, v188, v37, v36
v_dot2_f32_bf16 v40, v189, v37, v40
v_dot2_f32_bf16 v41, v190, v37, v41
v_dot2_f32_bf16 v42, v191, v37, v42
v_dot2_f32_bf16 v36, v192, v37, v36
v_dot2_f32_bf16 v40, v193, v37, v40
v_dot2_f32_bf16 v41, v194, v37, v41
v_dot2_f32_bf16 v42, v195, v37, v42
v_dot2_f32_bf16 v36, v196, v37, v36
v_dot2_f32_bf16 v40, v197, v37, v40
v_dot2_f32_bf16 v41, v198, v37, v41
v_dot2_f32_bf16 v42, v199, v37, v42
s_nop 2
v_add_f32 v36, v36, v40
v_add_f32 v41, v41, v42
v_add_f32 v36, v36, v41
v_mov_b32 v39, v36
s_nop 1
v_permlane32_swap_b32 v36, v39
s_nop 1
v_add_f32 v36, v36, v39
v_mov_b32 v39, v36
s_nop 1
v_permlane16_swap_b32 v36, v39
s_nop 1
v_add_f32 v36, v36, v39
v_lshlrev_b32 v39, 2, v1
v_cmp_gt_u32 vcc, 16, v1
s_and_saveexec_b64 s[76:77], vcc
buffer_store_dword v36, v39, s[44:47], s86 offen sc1
s_mov_b64 exec, s[76:77]
L_rls_done_q:
s_nop 1
v_mov_b32 v172, 0x3fb8aa3b
v_mov_b32 v173, 0x3fb8aa3b
v_mov_b32 v174, 0x358637bd
v_mov_b32 v175, 0x358637bd
s_lshl_b32 s71, s30, 3
s_lshl_b32 s72, s3, 1
s_add_u32 s71, s71, s72
s_lshl_b32 s71, s71, 3
s_lshl_b32 s72, s31, 1
s_add_u32 s71, s71, s72
s_mul_i32 s71, s71, 2560
s_add_u32 s71, s71, 2621440
v_lshlrev_b32 v32, 3, v1
v_add_u32 v32, 2048, v32
v_pk_mul_f32 v[176:177], v[64:65], v[172:173]
v_pk_mul_f32 v[178:179], v[66:67], v[172:173]
v_pk_mul_f32 v[180:181], v[68:69], v[172:173]
v_pk_mul_f32 v[182:183], v[70:71], v[172:173]
v_min_f32 v176, 0, v176
v_min_f32 v177, 0, v177
v_min_f32 v178, 0, v178
v_min_f32 v179, 0, v179
v_min_f32 v180, 0, v180
v_min_f32 v181, 0, v181
v_min_f32 v182, 0, v182
v_min_f32 v183, 0, v183
v_exp_f32 v176, v176
v_exp_f32 v177, v177
v_exp_f32 v178, v178
v_exp_f32 v179, v179
v_exp_f32 v180, v180
v_exp_f32 v181, v181
v_exp_f32 v182, v182
v_exp_f32 v183, v183
v_max_f32 v64, 0, v64
v_max_f32 v65, 0, v65
v_max_f32 v66, 0, v66
v_max_f32 v67, 0, v67
v_max_f32 v68, 0, v68
v_max_f32 v69, 0, v69
v_max_f32 v70, 0, v70
v_max_f32 v71, 0, v71
v_pk_add_f32 v[176:177], v[176:177], v[174:175]
v_pk_add_f32 v[178:179], v[178:179], v[174:175]
v_pk_add_f32 v[180:181], v[180:181], v[174:175]
v_pk_add_f32 v[182:183], v[182:183], v[174:175]
v_pk_add_f32 v[64:65], v[64:65], v[176:177]
v_pk_add_f32 v[66:67], v[66:67], v[178:179]
v_pk_add_f32 v[68:69], v[68:69], v[180:181]
v_pk_add_f32 v[70:71], v[70:71], v[182:183]
v_cvt_pk_bf16_f32 v184, v64, v65
v_cvt_pk_bf16_f32 v185, v66, v67
v_cvt_pk_bf16_f32 v186, v68, v69
v_cvt_pk_bf16_f32 v187, v70, v71
s_add_u32 s72, s71, 0
buffer_store_dwordx4 v[184:187], v31, s[44:47], s72 offen sc1
v_pk_mul_f32 v[176:177], v[72:73], v[172:173]
v_pk_mul_f32 v[178:179], v[74:75], v[172:173]
v_pk_mul_f32 v[180:181], v[76:77], v[172:173]
v_pk_mul_f32 v[182:183], v[78:79], v[172:173]
v_min_f32 v176, 0, v176
v_min_f32 v177, 0, v177
v_min_f32 v178, 0, v178
v_min_f32 v179, 0, v179
v_min_f32 v180, 0, v180
v_min_f32 v181, 0, v181
v_min_f32 v182, 0, v182
v_min_f32 v183, 0, v183
v_exp_f32 v176, v176
v_exp_f32 v177, v177
v_exp_f32 v178, v178
v_exp_f32 v179, v179
v_exp_f32 v180, v180
v_exp_f32 v181, v181
v_exp_f32 v182, v182
v_exp_f32 v183, v183
v_max_f32 v72, 0, v72
v_max_f32 v73, 0, v73
v_max_f32 v74, 0, v74
v_max_f32 v75, 0, v75
v_max_f32 v76, 0, v76
v_max_f32 v77, 0, v77
v_max_f32 v78, 0, v78
v_max_f32 v79, 0, v79
v_pk_add_f32 v[176:177], v[176:177], v[174:175]
v_pk_add_f32 v[178:179], v[178:179], v[174:175]
v_pk_add_f32 v[180:181], v[180:181], v[174:175]
v_pk_add_f32 v[182:183], v[182:183], v[174:175]
v_pk_add_f32 v[72:73], v[72:73], v[176:177]
v_pk_add_f32 v[74:75], v[74:75], v[178:179]
v_pk_add_f32 v[76:77], v[76:77], v[180:181]
v_pk_add_f32 v[78:79], v[78:79], v[182:183]
v_cvt_pk_bf16_f32 v188, v72, v73
v_cvt_pk_bf16_f32 v189, v74, v75
v_cvt_pk_bf16_f32 v190, v76, v77
v_cvt_pk_bf16_f32 v191, v78, v79
buffer_store_dwordx4 v[188:191], v31, s[44:47], s72 offen offset:1024 sc1
v_pk_mul_f32 v[176:177], v[80:81], v[172:173]
v_pk_mul_f32 v[178:179], v[82:83], v[172:173]
v_min_f32 v176, 0, v176
v_min_f32 v177, 0, v177
v_min_f32 v178, 0, v178
v_min_f32 v179, 0, v179
v_exp_f32 v176, v176
v_exp_f32 v177, v177
v_exp_f32 v178, v178
v_exp_f32 v179, v179
v_max_f32 v80, 0, v80
v_max_f32 v81, 0, v81
v_max_f32 v82, 0, v82
v_max_f32 v83, 0, v83
v_pk_add_f32 v[176:177], v[176:177], v[174:175]
v_pk_add_f32 v[178:179], v[178:179], v[174:175]
v_pk_add_f32 v[80:81], v[80:81], v[176:177]
v_pk_add_f32 v[82:83], v[82:83], v[178:179]
v_cvt_pk_bf16_f32 v192, v80, v81
v_cvt_pk_bf16_f32 v193, v82, v83
buffer_store_dwordx2 v[192:193], v32, s[44:47], s72 offen sc1
v_pk_mul_f32 v[176:177], v[84:85], v[172:173]
v_pk_mul_f32 v[178:179], v[86:87], v[172:173]
v_pk_mul_f32 v[180:181], v[88:89], v[172:173]
v_pk_mul_f32 v[182:183], v[90:91], v[172:173]
v_min_f32 v176, 0, v176
v_min_f32 v177, 0, v177
v_min_f32 v178, 0, v178
v_min_f32 v179, 0, v179
v_min_f32 v180, 0, v180
v_min_f32 v181, 0, v181
v_min_f32 v182, 0, v182
v_min_f32 v183, 0, v183
v_exp_f32 v176, v176
v_exp_f32 v177, v177
v_exp_f32 v178, v178
v_exp_f32 v179, v179
v_exp_f32 v180, v180
v_exp_f32 v181, v181
v_exp_f32 v182, v182
v_exp_f32 v183, v183
v_max_f32 v84, 0, v84
v_max_f32 v85, 0, v85
v_max_f32 v86, 0, v86
v_max_f32 v87, 0, v87
v_max_f32 v88, 0, v88
v_max_f32 v89, 0, v89
v_max_f32 v90, 0, v90
v_max_f32 v91, 0, v91
v_pk_add_f32 v[176:177], v[176:177], v[174:175]
v_pk_add_f32 v[178:179], v[178:179], v[174:175]
v_pk_add_f32 v[180:181], v[180:181], v[174:175]
v_pk_add_f32 v[182:183], v[182:183], v[174:175]
v_pk_add_f32 v[84:85], v[84:85], v[176:177]
v_pk_add_f32 v[86:87], v[86:87], v[178:179]
v_pk_add_f32 v[88:89], v[88:89], v[180:181]
v_pk_add_f32 v[90:91], v[90:91], v[182:183]
v_cvt_pk_bf16_f32 v194, v84, v85
v_cvt_pk_bf16_f32 v195, v86, v87
v_cvt_pk_bf16_f32 v196, v88, v89
v_cvt_pk_bf16_f32 v197, v90, v91
s_add_u32 s72, s71, 2560
buffer_store_dwordx4 v[194:197], v31, s[44:47], s72 offen sc1
v_pk_mul_f32 v[176:177], v[92:93], v[172:173]
v_pk_mul_f32 v[178:179], v[94:95], v[172:173]
v_pk_mul_f32 v[180:181], v[96:97], v[172:173]
v_pk_mul_f32 v[182:183], v[98:99], v[172:173]
v_min_f32 v176, 0, v176
v_min_f32 v177, 0, v177
v_min_f32 v178, 0, v178
v_min_f32 v179, 0, v179
v_min_f32 v180, 0, v180
v_min_f32 v181, 0, v181
v_min_f32 v182, 0, v182
v_min_f32 v183, 0, v183
v_exp_f32 v176, v176
v_exp_f32 v177, v177
v_exp_f32 v178, v178
v_exp_f32 v179, v179
v_exp_f32 v180, v180
v_exp_f32 v181, v181
v_exp_f32 v182, v182
v_exp_f32 v183, v183
v_max_f32 v92, 0, v92
v_max_f32 v93, 0, v93
v_max_f32 v94, 0, v94
v_max_f32 v95, 0, v95
v_max_f32 v96, 0, v96
v_max_f32 v97, 0, v97
v_max_f32 v98, 0, v98
v_max_f32 v99, 0, v99
v_pk_add_f32 v[176:177], v[176:177], v[174:175]
v_pk_add_f32 v[178:179], v[178:179], v[174:175]
v_pk_add_f32 v[180:181], v[180:181], v[174:175]
v_pk_add_f32 v[182:183], v[182:183], v[174:175]
v_pk_add_f32 v[92:93], v[92:93], v[176:177]
v_pk_add_f32 v[94:95], v[94:95], v[178:179]
v_pk_add_f32 v[96:97], v[96:97], v[180:181]
v_pk_add_f32 v[98:99], v[98:99], v[182:183]
v_cvt_pk_bf16_f32 v198, v92, v93
v_cvt_pk_bf16_f32 v199, v94, v95
v_cvt_pk_bf16_f32 v200, v96, v97
v_cvt_pk_bf16_f32 v201, v98, v99
buffer_store_dwordx4 v[198:201], v31, s[44:47], s72 offen offset:1024 sc1
v_pk_mul_f32 v[176:177], v[100:101], v[172:173]
v_pk_mul_f32 v[178:179], v[102:103], v[172:173]
v_min_f32 v176, 0, v176
v_min_f32 v177, 0, v177
v_min_f32 v178, 0, v178
v_min_f32 v179, 0, v179
v_exp_f32 v176, v176
v_exp_f32 v177, v177
v_exp_f32 v178, v178
v_exp_f32 v179, v179
v_max_f32 v100, 0, v100
v_max_f32 v101, 0, v101
v_max_f32 v102, 0, v102
v_max_f32 v103, 0, v103
v_pk_add_f32 v[176:177], v[176:177], v[174:175]
v_pk_add_f32 v[178:179], v[178:179], v[174:175]
v_pk_add_f32 v[100:101], v[100:101], v[176:177]
v_pk_add_f32 v[102:103], v[102:103], v[178:179]
v_cvt_pk_bf16_f32 v202, v100, v101
v_cvt_pk_bf16_f32 v203, v102, v103
buffer_store_dwordx2 v[202:203], v32, s[44:47], s72 offen sc1
v_pk_mul_f32 v[176:177], v[104:105], v[172:173]
v_pk_mul_f32 v[178:179], v[106:107], v[172:173]
v_pk_mul_f32 v[180:181], v[108:109], v[172:173]
v_pk_mul_f32 v[182:183], v[110:111], v[172:173]
v_min_f32 v176, 0, v176
v_min_f32 v177, 0, v177
v_min_f32 v178, 0, v178
v_min_f32 v179, 0, v179
v_min_f32 v180, 0, v180
v_min_f32 v181, 0, v181
v_min_f32 v182, 0, v182
v_min_f32 v183, 0, v183
v_exp_f32 v176, v176
v_exp_f32 v177, v177
v_exp_f32 v178, v178
v_exp_f32 v179, v179
v_exp_f32 v180, v180
v_exp_f32 v181, v181
v_exp_f32 v182, v182
v_exp_f32 v183, v183
v_max_f32 v104, 0, v104
v_max_f32 v105, 0, v105
v_max_f32 v106, 0, v106
v_max_f32 v107, 0, v107
v_max_f32 v108, 0, v108
v_max_f32 v109, 0, v109
v_max_f32 v110, 0, v110
v_max_f32 v111, 0, v111
v_pk_add_f32 v[176:177], v[176:177], v[174:175]
v_pk_add_f32 v[178:179], v[178:179], v[174:175]
v_pk_add_f32 v[180:181], v[180:181], v[174:175]
v_pk_add_f32 v[182:183], v[182:183], v[174:175]
v_pk_add_f32 v[104:105], v[104:105], v[176:177]
v_pk_add_f32 v[106:107], v[106:107], v[178:179]
v_pk_add_f32 v[108:109], v[108:109], v[180:181]
v_pk_add_f32 v[110:111], v[110:111], v[182:183]
v_cvt_pk_bf16_f32 v204, v104, v105
v_cvt_pk_bf16_f32 v205, v106, v107
v_cvt_pk_bf16_f32 v206, v108, v109
v_cvt_pk_bf16_f32 v207, v110, v111
s_add_u32 s72, s71, 20480
buffer_store_dwordx4 v[204:207], v31, s[44:47], s72 offen sc1
v_pk_mul_f32 v[176:177], v[112:113], v[172:173]
v_pk_mul_f32 v[178:179], v[114:115], v[172:173]
v_pk_mul_f32 v[180:181], v[116:117], v[172:173]
v_pk_mul_f32 v[182:183], v[118:119], v[172:173]
v_min_f32 v176, 0, v176
v_min_f32 v177, 0, v177
v_min_f32 v178, 0, v178
v_min_f32 v179, 0, v179
v_min_f32 v180, 0, v180
v_min_f32 v181, 0, v181
v_min_f32 v182, 0, v182
v_min_f32 v183, 0, v183
v_exp_f32 v176, v176
v_exp_f32 v177, v177
v_exp_f32 v178, v178
v_exp_f32 v179, v179
v_exp_f32 v180, v180
v_exp_f32 v181, v181
v_exp_f32 v182, v182
v_exp_f32 v183, v183
v_max_f32 v112, 0, v112
v_max_f32 v113, 0, v113
v_max_f32 v114, 0, v114
v_max_f32 v115, 0, v115
v_max_f32 v116, 0, v116
v_max_f32 v117, 0, v117
v_max_f32 v118, 0, v118
v_max_f32 v119, 0, v119
v_pk_add_f32 v[176:177], v[176:177], v[174:175]
v_pk_add_f32 v[178:179], v[178:179], v[174:175]
v_pk_add_f32 v[180:181], v[180:181], v[174:175]
v_pk_add_f32 v[182:183], v[182:183], v[174:175]
v_pk_add_f32 v[112:113], v[112:113], v[176:177]
v_pk_add_f32 v[114:115], v[114:115], v[178:179]
v_pk_add_f32 v[116:117], v[116:117], v[180:181]
v_pk_add_f32 v[118:119], v[118:119], v[182:183]
v_cvt_pk_bf16_f32 v208, v112, v113
v_cvt_pk_bf16_f32 v209, v114, v115
v_cvt_pk_bf16_f32 v210, v116, v117
v_cvt_pk_bf16_f32 v211, v118, v119
buffer_store_dwordx4 v[208:211], v31, s[44:47], s72 offen offset:1024 sc1
v_pk_mul_f32 v[176:177], v[120:121], v[172:173]
v_pk_mul_f32 v[178:179], v[122:123], v[172:173]
v_min_f32 v176, 0, v176
v_min_f32 v177, 0, v177
v_min_f32 v178, 0, v178
v_min_f32 v179, 0, v179
v_exp_f32 v176, v176
v_exp_f32 v177, v177
v_exp_f32 v178, v178
v_exp_f32 v179, v179
v_max_f32 v120, 0, v120
v_max_f32 v121, 0, v121
v_max_f32 v122, 0, v122
v_max_f32 v123, 0, v123
v_pk_add_f32 v[176:177], v[176:177], v[174:175]
v_pk_add_f32 v[178:179], v[178:179], v[174:175]
v_pk_add_f32 v[120:121], v[120:121], v[176:177]
v_pk_add_f32 v[122:123], v[122:123], v[178:179]
v_cvt_pk_bf16_f32 v212, v120, v121
v_cvt_pk_bf16_f32 v213, v122, v123
buffer_store_dwordx2 v[212:213], v32, s[44:47], s72 offen sc1
v_pk_mul_f32 v[176:177], v[124:125], v[172:173]
v_pk_mul_f32 v[178:179], v[126:127], v[172:173]
v_pk_mul_f32 v[180:181], v[128:129], v[172:173]
v_pk_mul_f32 v[182:183], v[130:131], v[172:173]
v_min_f32 v176, 0, v176
v_min_f32 v177, 0, v177
v_min_f32 v178, 0, v178
v_min_f32 v179, 0, v179
v_min_f32 v180, 0, v180
v_min_f32 v181, 0, v181
v_min_f32 v182, 0, v182
v_min_f32 v183, 0, v183
v_exp_f32 v176, v176
v_exp_f32 v177, v177
v_exp_f32 v178, v178
v_exp_f32 v179, v179
v_exp_f32 v180, v180
v_exp_f32 v181, v181
v_exp_f32 v182, v182
v_exp_f32 v183, v183
v_max_f32 v124, 0, v124
v_max_f32 v125, 0, v125
v_max_f32 v126, 0, v126
v_max_f32 v127, 0, v127
v_max_f32 v128, 0, v128
v_max_f32 v129, 0, v129
v_max_f32 v130, 0, v130
v_max_f32 v131, 0, v131
v_pk_add_f32 v[176:177], v[176:177], v[174:175]
v_pk_add_f32 v[178:179], v[178:179], v[174:175]
v_pk_add_f32 v[180:181], v[180:181], v[174:175]
v_pk_add_f32 v[182:183], v[182:183], v[174:175]
v_pk_add_f32 v[124:125], v[124:125], v[176:177]
v_pk_add_f32 v[126:127], v[126:127], v[178:179]
v_pk_add_f32 v[128:129], v[128:129], v[180:181]
v_pk_add_f32 v[130:131], v[130:131], v[182:183]
v_cvt_pk_bf16_f32 v214, v124, v125
v_cvt_pk_bf16_f32 v215, v126, v127
v_cvt_pk_bf16_f32 v216, v128, v129
v_cvt_pk_bf16_f32 v217, v130, v131
s_add_u32 s72, s71, 23040
buffer_store_dwordx4 v[214:217], v31, s[44:47], s72 offen sc1
v_pk_mul_f32 v[176:177], v[132:133], v[172:173]
v_pk_mul_f32 v[178:179], v[134:135], v[172:173]
v_pk_mul_f32 v[180:181], v[136:137], v[172:173]
v_pk_mul_f32 v[182:183], v[138:139], v[172:173]
v_min_f32 v176, 0, v176
v_min_f32 v177, 0, v177
v_min_f32 v178, 0, v178
v_min_f32 v179, 0, v179
v_min_f32 v180, 0, v180
v_min_f32 v181, 0, v181
v_min_f32 v182, 0, v182
v_min_f32 v183, 0, v183
v_exp_f32 v176, v176
v_exp_f32 v177, v177
v_exp_f32 v178, v178
v_exp_f32 v179, v179
v_exp_f32 v180, v180
v_exp_f32 v181, v181
v_exp_f32 v182, v182
v_exp_f32 v183, v183
v_max_f32 v132, 0, v132
v_max_f32 v133, 0, v133
v_max_f32 v134, 0, v134
v_max_f32 v135, 0, v135
v_max_f32 v136, 0, v136
v_max_f32 v137, 0, v137
v_max_f32 v138, 0, v138
v_max_f32 v139, 0, v139
v_pk_add_f32 v[176:177], v[176:177], v[174:175]
v_pk_add_f32 v[178:179], v[178:179], v[174:175]
v_pk_add_f32 v[180:181], v[180:181], v[174:175]
v_pk_add_f32 v[182:183], v[182:183], v[174:175]
v_pk_add_f32 v[132:133], v[132:133], v[176:177]
v_pk_add_f32 v[134:135], v[134:135], v[178:179]
v_pk_add_f32 v[136:137], v[136:137], v[180:181]
v_pk_add_f32 v[138:139], v[138:139], v[182:183]
v_cvt_pk_bf16_f32 v218, v132, v133
v_cvt_pk_bf16_f32 v219, v134, v135
v_cvt_pk_bf16_f32 v220, v136, v137
v_cvt_pk_bf16_f32 v221, v138, v139
buffer_store_dwordx4 v[218:221], v31, s[44:47], s72 offen offset:1024 sc1
v_pk_mul_f32 v[176:177], v[140:141], v[172:173]
v_pk_mul_f32 v[178:179], v[142:143], v[172:173]
v_min_f32 v176, 0, v176
v_min_f32 v177, 0, v177
v_min_f32 v178, 0, v178
v_min_f32 v179, 0, v179
v_exp_f32 v176, v176
v_exp_f32 v177, v177
v_exp_f32 v178, v178
v_exp_f32 v179, v179
v_max_f32 v140, 0, v140
v_max_f32 v141, 0, v141
v_max_f32 v142, 0, v142
v_max_f32 v143, 0, v143
v_pk_add_f32 v[176:177], v[176:177], v[174:175]
v_pk_add_f32 v[178:179], v[178:179], v[174:175]
v_pk_add_f32 v[140:141], v[140:141], v[176:177]
v_pk_add_f32 v[142:143], v[142:143], v[178:179]
v_cvt_pk_bf16_f32 v222, v140, v141
v_cvt_pk_bf16_f32 v223, v142, v143
buffer_store_dwordx2 v[222:223], v32, s[44:47], s72 offen sc1
v_readfirstlane_b32 s90, v59
s_mov_b32 s91, 0x40000
s_nop 2
L_tag_get_q:
s_cmp_lg_u32 s90, 0
s_cbranch_scc1 L_tag_got_q
s_sub_u32 s91, s91, 1
s_cmp_eq_u32 s91, 0
s_cbranch_scc1 L_tag_got_q
global_load_dword v59, v63, s[34:35] sc1
s_waitcnt vmcnt(0)
v_readfirstlane_b32 s90, v59
s_nop 2
s_branch L_tag_get_q
L_tag_got_q:
s_lshl_b32 s72, s30, 7
s_lshl_b32 s73, s31, 2
s_add_u32 s72, s72, s73
s_add_u32 s72, s72, 28509184
s_waitcnt vmcnt(0) lgkmcnt(0)
s_barrier
s_cmp_eq_u32 s3, 0
s_cbranch_scc0 L_pub_p1q
v_mov_b32 v60, s90
v_mov_b32 v61, 0
s_mov_b64 s[94:95], exec
s_mov_b64 exec, 1
buffer_store_dword v60, v61, s[44:47], s72 offen sc1
s_mov_b64 exec, s[94:95]
L_pub_p1q:
s_branch L_k1_fin
L_k1_fin:
L_code_p2:
s_mov_b32 s4, s8
s_mov_b32 s5, s9
s_mov_b32 s6, s26
s_mov_b32 s7, s27
s_mov_b32 s52, s18
s_mov_b32 s53, s19
v_lshrrev_b32 v8, 6, v0
v_and_b32 v1, 63, v0
v_readfirstlane_b32 s3, v8
v_lshrrev_b32 v2, 4, v1
v_and_b32 v3, 15, v1
v_lshlrev_b32 v4, 4, v1
v_mov_b32 v5, v4
v_add_u32 v6, 0x10000, v4
v_add_u32 v7, 0x20000, v4
s_and_b32 s10, s2, 7
s_lshr_b32 s11, s2, 3
s_getpc_b64 s[96:97]
L_pfr_L_code_p3_1:
s_add_u32 s96, s96, L_code_p3 - L_pfr_L_code_p3_1
s_addc_u32 s97, s97, 0
v_lshrrev_b32 v62, 6, v0
v_and_b32 v61, 1, v0
v_mad_u32_u24 v62, v62, 2, v61
s_lshr_b32 s95, s2, 3
s_mul_i32 s95, s95, 8
v_add_u32 v62, s95, v62
v_min_u32 v62, (L_code_p4 - L_code_p3) >> 7, v62
v_lshlrev_b32 v62, 7, v62
global_load_dword v55, v62, s[96:97]
s_and_b32 s14, s10, 3
s_lshr_b32 s14, s14, 1
s_lshl_b32 s14, s14, 3
s_lshr_b32 s15, s11, 2
s_add_u32 s12, s14, s15
s_and_b32 s14, s10, 1
s_lshl_b32 s14, s14, 2
s_and_b32 s15, s11, 3
s_add_u32 s13, s14, s15
s_cmp_lt_u32 s10, 4
s_cbranch_scc0 L_k2_o
v_add_u32 v8, 0, v1
v_mul_u32_u24 v9, 6554, v8
v_lshrrev_b32 v9, 16, v9
v_mul_u32_u24 v10, 10, v9
v_sub_u32 v8, v8, v10
v_mul_u32_u24 v9, 1280, v9
v_lshl_add_u32 v24, v8, 4, v9
v_add_u32 v8, 64, v1
v_mul_u32_u24 v9, 6554, v8
v_lshrrev_b32 v9, 16, v9
v_mul_u32_u24 v10, 10, v9
v_sub_u32 v8, v8, v10
v_mul_u32_u24 v9, 1280, v9
v_lshl_add_u32 v25, v8, 4, v9
v_subrev_u32 v25, 1024, v25
v_add_u32 v8, 128, v1
v_mul_u32_u24 v9, 6554, v8
v_lshrrev_b32 v9, 16, v9
v_mul_u32_u24 v10, 10, v9
v_sub_u32 v8, v8, v10
v_mul_u32_u24 v9, 1280, v9
v_lshl_add_u32 v26, v8, 4, v9
v_subrev_u32 v26, 2048, v26
v_add_u32 v8, 192, v1
v_mul_u32_u24 v9, 6554, v8
v_lshrrev_b32 v9, 16, v9
v_mul_u32_u24 v10, 10, v9
v_sub_u32 v8, v8, v10
v_mul_u32_u24 v9, 1280, v9
v_lshl_add_u32 v27, v8, 4, v9
v_subrev_u32 v27, 3072, v27
v_add_u32 v8, 256, v1
v_mul_u32_u24 v9, 6554, v8
v_lshrrev_b32 v9, 16, v9
v_mul_u32_u24 v10, 10, v9
v_sub_u32 v8, v8, v10
v_mul_u32_u24 v9, 1280, v9
v_lshl_add_u32 v28, v8, 4, v9
s_lshl_b32 s14, s12, 3
s_lshl_b32 s15, s3, 1
s_add_u32 s14, s14, s15
s_mov_b32 s48, s14
s_mul_i32 s32, s14, 20480
s_add_u32 s16, s6, 0
s_addc_u32 s17, s7, 0
s_mov_b32 s18, 2621440
s_mov_b32 s19, 0x20000
s_mov_b32 s24, s6
s_mov_b32 s25, s7
s_mov_b32 s26, 28520448
s_mov_b32 s27, 0x20000
v_lshrrev_b32 v8, 2, v3
v_lshl_add_u32 v8, v2, 2, v8
v_mul_u32_u24 v8, 160, v8
v_and_b32 v9, 3, v3
v_lshl_add_u32 v5, v9, 3, v8
v_add_u32 v6, 0x10000, v5
s_lshl_b32 s14, s48, 4
s_mul_i32 s14, s14, 1280
s_mul_i32 s15, s13, 160
s_add_u32 s14, s14, s15
s_add_u32 s28, s4, s14
s_addc_u32 s29, s5, 0
s_mov_b32 s30, 40960
s_mov_b32 s31, 0x20000
s_mul_i32 s49, s3, 5120
s_add_u32 s49, s49, 114688
v_mov_b32 v8, 0x3f803f80
v_accvgpr_write_b32 a200, v8
v_accvgpr_write_b32 a201, v8
v_accvgpr_write_b32 a202, v8
v_accvgpr_write_b32 a203, v8
s_mov_b32 m0, s49
s_nop 0
buffer_load_dwordx4 v24, s[28:31], 0 offen offset:0 lds
buffer_load_dwordx4 v25, s[28:31], 0 offen offset:1024 lds
buffer_load_dwordx4 v26, s[28:31], 0 offen offset:2048 lds
buffer_load_dwordx4 v27, s[28:31], 0 offen offset:3072 lds
s_add_u32 m0, s49, 4096
s_nop 0
buffer_load_dwordx4 v28, s[28:31], 0 offen offset:0 lds
s_mov_b32 s14, 28511232
s_cmp_eq_u32 s3, 0
s_cbranch_scc0 L_pd_p2w
v_and_b32 v60, 63, v0
v_min_u32 v60, 11, v60
v_lshrrev_b32 v61, 2, v60
s_sub_u32 s15, s12, 1
v_add_u32 v61, s15, v61
v_max_i32 v61, 0, v61
v_min_i32 v61, 15, v61
v_and_b32 v60, 3, v60
v_lshlrev_b32 v60, 2, v60
v_lshl_add_u32 v60, v61, 7, v60
s_mov_b32 s93, 0x40000
L_pl_p2w:
buffer_load_dword v56, v60, s[24:27], s14 offen sc1
s_waitcnt vmcnt(0)
v_cmp_eq_u32 vcc, s90, v56
s_sub_u32 s93, s93, 1
s_cmp_eq_u32 s93, 0
s_cbranch_scc1 L_pd_p2w
s_cmp_eq_u64 vcc, exec
s_cbranch_scc1 L_pd_p2w
s_sleep 2
s_branch L_pl_p2w
L_pd_p2w:
s_waitcnt vmcnt(0)
s_barrier
v_and_b32 v52, 63, v0
v_lshrrev_b32 v53, 2, v52
v_lshlrev_b32 v53, 7, v53
v_and_b32 v54, 3, v52
v_lshl_add_u32 v53, v54, 4, v53
v_subrev_u32 v54, 32, v52
v_lshlrev_b32 v54, 7, v54
v_add_u32 v54, 1024, v54
v_cmp_gt_u32 vcc, 32, v52
s_nop 1
v_cndmask_b32 v52, v54, v53, vcc
s_add_u32 s37, s32, 0
buffer_load_dwordx4 a[0:3], v4, s[16:19], s37 offen sc1
s_add_u32 s37, s32, 20480
buffer_load_dwordx4 a[4:7], v4, s[16:19], s37 offen sc1
s_add_u32 s37, s32, 1024
buffer_load_dwordx4 a[8:11], v4, s[16:19], s37 offen sc1
s_add_u32 s37, s32, 21504
buffer_load_dwordx4 a[12:15], v4, s[16:19], s37 offen sc1
s_add_u32 s37, s32, 2048
buffer_load_dwordx4 a[16:19], v4, s[16:19], s37 offen sc1
s_add_u32 s37, s32, 22528
buffer_load_dwordx4 a[20:23], v4, s[16:19], s37 offen sc1
s_add_u32 s37, s32, 3072
buffer_load_dwordx4 a[24:27], v4, s[16:19], s37 offen sc1
s_add_u32 s37, s32, 23552
buffer_load_dwordx4 a[28:31], v4, s[16:19], s37 offen sc1
v_mul_u32_u24 v8, 160, v3
v_lshl_add_u32 v8, v2, 3, v8
v_add_u32 v8, s49, v8
ds_read_b64 v[32:33], v8 offset:0
ds_read_b64 v[34:35], v8 offset:32
ds_read_b64 v[36:37], v8 offset:64
ds_read_b64 v[38:39], v8 offset:96
ds_read_b64 v[40:41], v8 offset:128
ds_read_b64 v[42:43], v8 offset:2560
ds_read_b64 v[44:45], v8 offset:2592
ds_read_b64 v[46:47], v8 offset:2624
ds_read_b64 v[48:49], v8 offset:2656
ds_read_b64 v[50:51], v8 offset:2688
s_waitcnt lgkmcnt(5)
v_lshlrev_b32 v64, 16, v32
v_and_b32 v65, 0xffff0000, v32
v_lshlrev_b32 v66, 16, v33
v_and_b32 v67, 0xffff0000, v33
v_lshlrev_b32 v68, 16, v34
v_and_b32 v69, 0xffff0000, v34
v_lshlrev_b32 v70, 16, v35
v_and_b32 v71, 0xffff0000, v35
v_lshlrev_b32 v72, 16, v36
v_and_b32 v73, 0xffff0000, v36
v_lshlrev_b32 v74, 16, v37
v_and_b32 v75, 0xffff0000, v37
v_lshlrev_b32 v76, 16, v38
v_and_b32 v77, 0xffff0000, v38
v_lshlrev_b32 v78, 16, v39
v_and_b32 v79, 0xffff0000, v39
v_lshlrev_b32 v80, 16, v40
v_and_b32 v81, 0xffff0000, v40
v_lshlrev_b32 v82, 16, v41
v_and_b32 v83, 0xffff0000, v41
s_waitcnt lgkmcnt(0)
v_lshlrev_b32 v84, 16, v42
v_and_b32 v85, 0xffff0000, v42
v_lshlrev_b32 v86, 16, v43
v_and_b32 v87, 0xffff0000, v43
v_lshlrev_b32 v88, 16, v44
v_and_b32 v89, 0xffff0000, v44
v_lshlrev_b32 v90, 16, v45
v_and_b32 v91, 0xffff0000, v45
v_lshlrev_b32 v92, 16, v46
v_and_b32 v93, 0xffff0000, v46
v_lshlrev_b32 v94, 16, v47
v_and_b32 v95, 0xffff0000, v47
v_lshlrev_b32 v96, 16, v48
v_and_b32 v97, 0xffff0000, v48
v_lshlrev_b32 v98, 16, v49
v_and_b32 v99, 0xffff0000, v49
v_lshlrev_b32 v100, 16, v50
v_and_b32 v101, 0xffff0000, v50
v_lshlrev_b32 v102, 16, v51
v_and_b32 v103, 0xffff0000, v51
ds_read_b64_tr_b16 a[160:161], v5 offset:0
ds_read_b64_tr_b16 a[162:163], v5 offset:2560
ds_read_b64_tr_b16 a[164:165], v5 offset:32
ds_read_b64_tr_b16 a[166:167], v5 offset:2592
ds_read_b64_tr_b16 a[168:169], v5 offset:64
ds_read_b64_tr_b16 a[170:171], v5 offset:2624
ds_read_b64_tr_b16 a[172:173], v5 offset:96
ds_read_b64_tr_b16 a[174:175], v5 offset:2656
ds_read_b64_tr_b16 a[176:177], v5 offset:128
ds_read_b64_tr_b16 a[178:179], v5 offset:2688
s_waitcnt vmcnt(6) lgkmcnt(8)
v_mfma_f32_16x16x32_bf16 v[64:67], a[160:163], a[0:3], v[64:67]
s_add_u32 s37, s32, 4096
buffer_load_dwordx4 a[32:35], v4, s[16:19], s37 offen sc1
v_mfma_f32_16x16x32_bf16 v[84:87], a[160:163], a[4:7], v[84:87]
ds_read_b64_tr_b16 a[160:161], v5 offset:5120
ds_read_b64_tr_b16 a[162:163], v5 offset:7680
s_add_u32 s37, s32, 24576
buffer_load_dwordx4 a[36:39], v4, s[16:19], s37 offen sc1
s_waitcnt lgkmcnt(8)
v_mfma_f32_16x16x32_bf16 v[68:71], a[164:167], a[0:3], v[68:71]
s_add_u32 s37, s32, 5120
buffer_load_dwordx4 a[40:43], v4, s[16:19], s37 offen sc1
v_mfma_f32_16x16x32_bf16 v[88:91], a[164:167], a[4:7], v[88:91]
ds_read_b64_tr_b16 a[164:165], v5 offset:5152
ds_read_b64_tr_b16 a[166:167], v5 offset:7712
s_add_u32 s37, s32, 25600
buffer_load_dwordx4 a[44:47], v4, s[16:19], s37 offen sc1
s_waitcnt lgkmcnt(8)
v_mfma_f32_16x16x32_bf16 v[72:75], a[168:171], a[0:3], v[72:75]
s_add_u32 s37, s32, 6144
buffer_load_dwordx4 a[48:51], v4, s[16:19], s37 offen sc1
v_mfma_f32_16x16x32_bf16 v[92:95], a[168:171], a[4:7], v[92:95]
ds_read_b64_tr_b16 a[168:169], v5 offset:5184
ds_read_b64_tr_b16 a[170:171], v5 offset:7744
s_add_u32 s37, s32, 26624
buffer_load_dwordx4 a[52:55], v4, s[16:19], s37 offen sc1
s_waitcnt lgkmcnt(8)
v_mfma_f32_16x16x32_bf16 v[76:79], a[172:175], a[0:3], v[76:79]
v_mfma_f32_16x16x32_bf16 v[96:99], a[172:175], a[4:7], v[96:99]
ds_read_b64_tr_b16 a[172:173], v5 offset:5216
ds_read_b64_tr_b16 a[174:175], v5 offset:7776
s_waitcnt lgkmcnt(8)
v_mfma_f32_16x16x32_bf16 v[80:83], a[176:179], a[0:3], v[80:83]
v_mfma_f32_16x16x32_bf16 v[100:103], a[176:179], a[4:7], v[100:103]
ds_read_b64_tr_b16 a[176:177], v5 offset:5248
ds_read_b64_tr_b16 a[178:179], v5 offset:7808
s_waitcnt vmcnt(10) lgkmcnt(8)
v_mfma_f32_16x16x32_bf16 v[64:67], a[160:163], a[8:11], v[64:67]
s_add_u32 s37, s32, 7168
buffer_load_dwordx4 a[56:59], v4, s[16:19], s37 offen sc1
v_mfma_f32_16x16x32_bf16 v[84:87], a[160:163], a[12:15], v[84:87]
ds_read_b64_tr_b16 a[160:161], v5 offset:10240
ds_read_b64_tr_b16 a[162:163], v5 offset:12800
s_add_u32 s37, s32, 27648
buffer_load_dwordx4 a[60:63], v4, s[16:19], s37 offen sc1
s_waitcnt lgkmcnt(8)
v_mfma_f32_16x16x32_bf16 v[68:71], a[164:167], a[8:11], v[68:71]
v_mfma_f32_16x16x32_bf16 v[88:91], a[164:167], a[12:15], v[88:91]
ds_read_b64_tr_b16 a[164:165], v5 offset:10272
ds_read_b64_tr_b16 a[166:167], v5 offset:12832
s_waitcnt lgkmcnt(8)
v_mfma_f32_16x16x32_bf16 v[72:75], a[168:171], a[8:11], v[72:75]
v_mfma_f32_16x16x32_bf16 v[92:95], a[168:171], a[12:15], v[92:95]
ds_read_b64_tr_b16 a[168:169], v5 offset:10304
ds_read_b64_tr_b16 a[170:171], v5 offset:12864
s_waitcnt lgkmcnt(8)
v_mfma_f32_16x16x32_bf16 v[76:79], a[172:175], a[8:11], v[76:79]
v_mfma_f32_16x16x32_bf16 v[96:99], a[172:175], a[12:15], v[96:99]
ds_read_b64_tr_b16 a[172:173], v5 offset:10336
ds_read_b64_tr_b16 a[174:175], v5 offset:12896
s_waitcnt lgkmcnt(8)
v_mfma_f32_16x16x32_bf16 v[80:83], a[176:179], a[8:11], v[80:83]
v_mfma_f32_16x16x32_bf16 v[100:103], a[176:179], a[12:15], v[100:103]
ds_read_b64_tr_b16 a[176:177], v5 offset:10368
ds_read_b64_tr_b16 a[178:179], v5 offset:12928
s_waitcnt vmcnt(10) lgkmcnt(8)
v_mfma_f32_16x16x32_bf16 v[64:67], a[160:163], a[16:19], v[64:67]
s_add_u32 s37, s32, 8192
buffer_load_dwordx4 a[64:67], v4, s[16:19], s37 offen sc1
v_mfma_f32_16x16x32_bf16 v[84:87], a[160:163], a[20:23], v[84:87]
ds_read_b64_tr_b16 a[160:161], v5 offset:15360
ds_read_b64_tr_b16 a[162:163], v5 offset:17920
s_add_u32 s37, s32, 28672
buffer_load_dwordx4 a[68:71], v4, s[16:19], s37 offen sc1
s_waitcnt lgkmcnt(8)
v_mfma_f32_16x16x32_bf16 v[68:71], a[164:167], a[16:19], v[68:71]
v_mfma_f32_16x16x32_bf16 v[88:91], a[164:167], a[20:23], v[88:91]
ds_read_b64_tr_b16 a[164:165], v5 offset:15392
ds_read_b64_tr_b16 a[166:167], v5 offset:17952
s_waitcnt lgkmcnt(8)
v_mfma_f32_16x16x32_bf16 v[72:75], a[168:171], a[16:19], v[72:75]
v_mfma_f32_16x16x32_bf16 v[92:95], a[168:171], a[20:23], v[92:95]
ds_read_b64_tr_b16 a[168:169], v5 offset:15424
ds_read_b64_tr_b16 a[170:171], v5 offset:17984
s_waitcnt lgkmcnt(8)
v_mfma_f32_16x16x32_bf16 v[76:79], a[172:175], a[16:19], v[76:79]
v_mfma_f32_16x16x32_bf16 v[96:99], a[172:175], a[20:23], v[96:99]
ds_read_b64_tr_b16 a[172:173], v5 offset:15456
ds_read_b64_tr_b16 a[174:175], v5 offset:18016
s_waitcnt lgkmcnt(8)
v_mfma_f32_16x16x32_bf16 v[80:83], a[176:179], a[16:19], v[80:83]
v_mfma_f32_16x16x32_bf16 v[100:103], a[176:179], a[20:23], v[100:103]
ds_read_b64_tr_b16 a[176:177], v5 offset:15488
ds_read_b64_tr_b16 a[178:179], v5 offset:18048
s_waitcnt vmcnt(10) lgkmcnt(8)
v_mfma_f32_16x16x32_bf16 v[64:67], a[160:163], a[24:27], v[64:67]
s_add_u32 s37, s32, 9216
buffer_load_dwordx4 a[72:75], v4, s[16:19], s37 offen sc1
v_mfma_f32_16x16x32_bf16 v[84:87], a[160:163], a[28:31], v[84:87]
ds_read_b64_tr_b16 a[160:161], v5 offset:20480
ds_read_b64_tr_b16 a[162:163], v5 offset:23040
s_add_u32 s37, s32, 29696
buffer_load_dwordx4 a[76:79], v4, s[16:19], s37 offen sc1
s_waitcnt lgkmcnt(8)
v_mfma_f32_16x16x32_bf16 v[68:71], a[164:167], a[24:27], v[68:71]
v_mfma_f32_16x16x32_bf16 v[88:91], a[164:167], a[28:31], v[88:91]
ds_read_b64_tr_b16 a[164:165], v5 offset:20512
ds_read_b64_tr_b16 a[166:167], v5 offset:23072
s_waitcnt lgkmcnt(8)
v_mfma_f32_16x16x32_bf16 v[72:75], a[168:171], a[24:27], v[72:75]
v_mfma_f32_16x16x32_bf16 v[92:95], a[168:171], a[28:31], v[92:95]
ds_read_b64_tr_b16 a[168:169], v5 offset:20544
ds_read_b64_tr_b16 a[170:171], v5 offset:23104
s_waitcnt lgkmcnt(8)
v_mfma_f32_16x16x32_bf16 v[76:79], a[172:175], a[24:27], v[76:79]
v_mfma_f32_16x16x32_bf16 v[96:99], a[172:175], a[28:31], v[96:99]
ds_read_b64_tr_b16 a[172:173], v5 offset:20576
ds_read_b64_tr_b16 a[174:175], v5 offset:23136
s_waitcnt lgkmcnt(8)
v_mfma_f32_16x16x32_bf16 v[80:83], a[176:179], a[24:27], v[80:83]
v_mfma_f32_16x16x32_bf16 v[100:103], a[176:179], a[28:31], v[100:103]
ds_read_b64_tr_b16 a[176:177], v5 offset:20608
ds_read_b64_tr_b16 a[178:179], v5 offset:23168
s_waitcnt vmcnt(10) lgkmcnt(8)
v_mfma_f32_16x16x32_bf16 v[64:67], a[160:163], a[32:35], v[64:67]
s_add_u32 s37, s32, 10240
buffer_load_dwordx4 a[80:83], v4, s[16:19], s37 offen sc1
v_mfma_f32_16x16x32_bf16 v[84:87], a[160:163], a[36:39], v[84:87]
ds_read_b64_tr_b16 a[160:161], v5 offset:25600
ds_read_b64_tr_b16 a[162:163], v5 offset:28160
s_add_u32 s37, s32, 30720
buffer_load_dwordx4 a[84:87], v4, s[16:19], s37 offen sc1
s_waitcnt lgkmcnt(8)
v_mfma_f32_16x16x32_bf16 v[68:71], a[164:167], a[32:35], v[68:71]
v_mfma_f32_16x16x32_bf16 v[88:91], a[164:167], a[36:39], v[88:91]
ds_read_b64_tr_b16 a[164:165], v5 offset:25632
ds_read_b64_tr_b16 a[166:167], v5 offset:28192
s_waitcnt lgkmcnt(8)
v_mfma_f32_16x16x32_bf16 v[72:75], a[168:171], a[32:35], v[72:75]
v_mfma_f32_16x16x32_bf16 v[92:95], a[168:171], a[36:39], v[92:95]
ds_read_b64_tr_b16 a[168:169], v5 offset:25664
ds_read_b64_tr_b16 a[170:171], v5 offset:28224
s_waitcnt lgkmcnt(8)
v_mfma_f32_16x16x32_bf16 v[76:79], a[172:175], a[32:35], v[76:79]
v_mfma_f32_16x16x32_bf16 v[96:99], a[172:175], a[36:39], v[96:99]
ds_read_b64_tr_b16 a[172:173], v5 offset:25696
ds_read_b64_tr_b16 a[174:175], v5 offset:28256
s_waitcnt lgkmcnt(8)
v_mfma_f32_16x16x32_bf16 v[80:83], a[176:179], a[32:35], v[80:83]
v_mfma_f32_16x16x32_bf16 v[100:103], a[176:179], a[36:39], v[100:103]
ds_read_b64_tr_b16 a[176:177], v5 offset:25728
ds_read_b64_tr_b16 a[178:179], v5 offset:28288
s_waitcnt vmcnt(10) lgkmcnt(8)
v_mfma_f32_16x16x32_bf16 v[64:67], a[160:163], a[40:43], v[64:67]
s_add_u32 s37, s32, 11264
buffer_load_dwordx4 a[88:91], v4, s[16:19], s37 offen sc1
v_mfma_f32_16x16x32_bf16 v[84:87], a[160:163], a[44:47], v[84:87]
ds_read_b64_tr_b16 a[160:161], v5 offset:30720
ds_read_b64_tr_b16 a[162:163], v5 offset:33280
s_add_u32 s37, s32, 31744
buffer_load_dwordx4 a[92:95], v4, s[16:19], s37 offen sc1
s_waitcnt lgkmcnt(8)
v_mfma_f32_16x16x32_bf16 v[68:71], a[164:167], a[40:43], v[68:71]
v_mfma_f32_16x16x32_bf16 v[88:91], a[164:167], a[44:47], v[88:91]
ds_read_b64_tr_b16 a[164:165], v5 offset:30752
ds_read_b64_tr_b16 a[166:167], v5 offset:33312
s_waitcnt lgkmcnt(8)
v_mfma_f32_16x16x32_bf16 v[72:75], a[168:171], a[40:43], v[72:75]
v_mfma_f32_16x16x32_bf16 v[92:95], a[168:171], a[44:47], v[92:95]
ds_read_b64_tr_b16 a[168:169], v5 offset:30784
ds_read_b64_tr_b16 a[170:171], v5 offset:33344
s_waitcnt lgkmcnt(8)
v_mfma_f32_16x16x32_bf16 v[76:79], a[172:175], a[40:43], v[76:79]
v_mfma_f32_16x16x32_bf16 v[96:99], a[172:175], a[44:47], v[96:99]
ds_read_b64_tr_b16 a[172:173], v5 offset:30816
ds_read_b64_tr_b16 a[174:175], v5 offset:33376
s_waitcnt lgkmcnt(8)
v_mfma_f32_16x16x32_bf16 v[80:83], a[176:179], a[40:43], v[80:83]
v_mfma_f32_16x16x32_bf16 v[100:103], a[176:179], a[44:47], v[100:103]
ds_read_b64_tr_b16 a[176:177], v5 offset:30848
ds_read_b64_tr_b16 a[178:179], v5 offset:33408
s_waitcnt vmcnt(10) lgkmcnt(8)
v_mfma_f32_16x16x32_bf16 v[64:67], a[160:163], a[48:51], v[64:67]
s_add_u32 s37, s32, 12288
buffer_load_dwordx4 a[96:99], v4, s[16:19], s37 offen sc1
v_mfma_f32_16x16x32_bf16 v[84:87], a[160:163], a[52:55], v[84:87]
ds_read_b64_tr_b16 a[160:161], v5 offset:35840
ds_read_b64_tr_b16 a[162:163], v5 offset:38400
s_add_u32 s37, s32, 32768
buffer_load_dwordx4 a[100:103], v4, s[16:19], s37 offen sc1
s_waitcnt lgkmcnt(8)
v_mfma_f32_16x16x32_bf16 v[68:71], a[164:167], a[48:51], v[68:71]
v_mfma_f32_16x16x32_bf16 v[88:91], a[164:167], a[52:55], v[88:91]
ds_read_b64_tr_b16 a[164:165], v5 offset:35872
ds_read_b64_tr_b16 a[166:167], v5 offset:38432
s_waitcnt lgkmcnt(8)
v_mfma_f32_16x16x32_bf16 v[72:75], a[168:171], a[48:51], v[72:75]
v_mfma_f32_16x16x32_bf16 v[92:95], a[168:171], a[52:55], v[92:95]
ds_read_b64_tr_b16 a[168:169], v5 offset:35904
ds_read_b64_tr_b16 a[170:171], v5 offset:38464
s_waitcnt lgkmcnt(8)
v_mfma_f32_16x16x32_bf16 v[76:79], a[172:175], a[48:51], v[76:79]
v_mfma_f32_16x16x32_bf16 v[96:99], a[172:175], a[52:55], v[96:99]
ds_read_b64_tr_b16 a[172:173], v5 offset:35936
ds_read_b64_tr_b16 a[174:175], v5 offset:38496
s_waitcnt lgkmcnt(8)
v_mfma_f32_16x16x32_bf16 v[80:83], a[176:179], a[48:51], v[80:83]
v_mfma_f32_16x16x32_bf16 v[100:103], a[176:179], a[52:55], v[100:103]
ds_read_b64_tr_b16 a[176:177], v5 offset:35968
ds_read_b64_tr_b16 a[178:179], v5 offset:38528
s_waitcnt vmcnt(10) lgkmcnt(8)
v_mfma_f32_16x16x32_bf16 v[64:67], a[160:163], a[56:59], v[64:67]
s_add_u32 s37, s32, 13312
buffer_load_dwordx4 a[104:107], v4, s[16:19], s37 offen sc1
v_mfma_f32_16x16x32_bf16 v[84:87], a[160:163], a[60:63], v[84:87]
ds_read_b64_tr_b16 a[160:161], v5 offset:40960
ds_read_b64_tr_b16 a[162:163], v5 offset:43520
s_add_u32 s37, s32, 33792
buffer_load_dwordx4 a[108:111], v4, s[16:19], s37 offen sc1
s_waitcnt lgkmcnt(8)
v_mfma_f32_16x16x32_bf16 v[68:71], a[164:167], a[56:59], v[68:71]
v_mfma_f32_16x16x32_bf16 v[88:91], a[164:167], a[60:63], v[88:91]
ds_read_b64_tr_b16 a[164:165], v5 offset:40992
ds_read_b64_tr_b16 a[166:167], v5 offset:43552
s_waitcnt lgkmcnt(8)
v_mfma_f32_16x16x32_bf16 v[72:75], a[168:171], a[56:59], v[72:75]
v_mfma_f32_16x16x32_bf16 v[92:95], a[168:171], a[60:63], v[92:95]
ds_read_b64_tr_b16 a[168:169], v5 offset:41024
ds_read_b64_tr_b16 a[170:171], v5 offset:43584
s_waitcnt lgkmcnt(8)
v_mfma_f32_16x16x32_bf16 v[76:79], a[172:175], a[56:59], v[76:79]
v_mfma_f32_16x16x32_bf16 v[96:99], a[172:175], a[60:63], v[96:99]
ds_read_b64_tr_b16 a[172:173], v5 offset:41056
ds_read_b64_tr_b16 a[174:175], v5 offset:43616
s_waitcnt lgkmcnt(8)
v_mfma_f32_16x16x32_bf16 v[80:83], a[176:179], a[56:59], v[80:83]
v_mfma_f32_16x16x32_bf16 v[100:103], a[176:179], a[60:63], v[100:103]
ds_read_b64_tr_b16 a[176:177], v5 offset:41088
ds_read_b64_tr_b16 a[178:179], v5 offset:43648
s_waitcnt vmcnt(10) lgkmcnt(8)
v_mfma_f32_16x16x32_bf16 v[64:67], a[160:163], a[64:67], v[64:67]
s_add_u32 s37, s32, 14336
buffer_load_dwordx4 a[112:115], v4, s[16:19], s37 offen sc1
v_mfma_f32_16x16x32_bf16 v[84:87], a[160:163], a[68:71], v[84:87]
ds_read_b64_tr_b16 a[160:161], v5 offset:46080
ds_read_b64_tr_b16 a[162:163], v5 offset:48640
s_add_u32 s37, s32, 34816
buffer_load_dwordx4 a[116:119], v4, s[16:19], s37 offen sc1
s_waitcnt lgkmcnt(8)
v_mfma_f32_16x16x32_bf16 v[68:71], a[164:167], a[64:67], v[68:71]
v_mfma_f32_16x16x32_bf16 v[88:91], a[164:167], a[68:71], v[88:91]
ds_read_b64_tr_b16 a[164:165], v5 offset:46112
ds_read_b64_tr_b16 a[166:167], v5 offset:48672
s_waitcnt lgkmcnt(8)
v_mfma_f32_16x16x32_bf16 v[72:75], a[168:171], a[64:67], v[72:75]
v_mfma_f32_16x16x32_bf16 v[92:95], a[168:171], a[68:71], v[92:95]
ds_read_b64_tr_b16 a[168:169], v5 offset:46144
ds_read_b64_tr_b16 a[170:171], v5 offset:48704
s_waitcnt lgkmcnt(8)
v_mfma_f32_16x16x32_bf16 v[76:79], a[172:175], a[64:67], v[76:79]
v_mfma_f32_16x16x32_bf16 v[96:99], a[172:175], a[68:71], v[96:99]
ds_read_b64_tr_b16 a[172:173], v5 offset:46176
ds_read_b64_tr_b16 a[174:175], v5 offset:48736
s_waitcnt lgkmcnt(8)
v_mfma_f32_16x16x32_bf16 v[80:83], a[176:179], a[64:67], v[80:83]
v_mfma_f32_16x16x32_bf16 v[100:103], a[176:179], a[68:71], v[100:103]
ds_read_b64_tr_b16 a[176:177], v5 offset:46208
ds_read_b64_tr_b16 a[178:179], v5 offset:48768
s_waitcnt vmcnt(10) lgkmcnt(8)
v_mfma_f32_16x16x32_bf16 v[64:67], a[160:163], a[72:75], v[64:67]
s_add_u32 s37, s32, 15360
buffer_load_dwordx4 a[120:123], v4, s[16:19], s37 offen sc1
v_mfma_f32_16x16x32_bf16 v[84:87], a[160:163], a[76:79], v[84:87]
ds_read_b64_tr_b16 a[160:161], v5 offset:51200
ds_read_b64_tr_b16 a[162:163], v5 offset:53760
s_add_u32 s37, s32, 35840
buffer_load_dwordx4 a[124:127], v4, s[16:19], s37 offen sc1
s_waitcnt lgkmcnt(8)
v_mfma_f32_16x16x32_bf16 v[68:71], a[164:167], a[72:75], v[68:71]
v_mfma_f32_16x16x32_bf16 v[88:91], a[164:167], a[76:79], v[88:91]
ds_read_b64_tr_b16 a[164:165], v5 offset:51232
ds_read_b64_tr_b16 a[166:167], v5 offset:53792
s_waitcnt lgkmcnt(8)
v_mfma_f32_16x16x32_bf16 v[72:75], a[168:171], a[72:75], v[72:75]
v_mfma_f32_16x16x32_bf16 v[92:95], a[168:171], a[76:79], v[92:95]
ds_read_b64_tr_b16 a[168:169], v5 offset:51264
ds_read_b64_tr_b16 a[170:171], v5 offset:53824
s_waitcnt lgkmcnt(8)
v_mfma_f32_16x16x32_bf16 v[76:79], a[172:175], a[72:75], v[76:79]
v_mfma_f32_16x16x32_bf16 v[96:99], a[172:175], a[76:79], v[96:99]
ds_read_b64_tr_b16 a[172:173], v5 offset:51296
ds_read_b64_tr_b16 a[174:175], v5 offset:53856
s_waitcnt lgkmcnt(8)
v_mfma_f32_16x16x32_bf16 v[80:83], a[176:179], a[72:75], v[80:83]
v_mfma_f32_16x16x32_bf16 v[100:103], a[176:179], a[76:79], v[100:103]
ds_read_b64_tr_b16 a[176:177], v5 offset:51328
ds_read_b64_tr_b16 a[178:179], v5 offset:53888
s_waitcnt vmcnt(10) lgkmcnt(8)
v_mfma_f32_16x16x32_bf16 v[64:67], a[160:163], a[80:83], v[64:67]
s_add_u32 s37, s32, 16384
buffer_load_dwordx4 a[128:131], v4, s[16:19], s37 offen sc1
v_mfma_f32_16x16x32_bf16 v[84:87], a[160:163], a[84:87], v[84:87]
ds_read_b64_tr_b16 a[160:161], v5 offset:56320
ds_read_b64_tr_b16 a[162:163], v5 offset:58880
s_add_u32 s37, s32, 36864
buffer_load_dwordx4 a[132:135], v4, s[16:19], s37 offen sc1
s_waitcnt lgkmcnt(8)
v_mfma_f32_16x16x32_bf16 v[68:71], a[164:167], a[80:83], v[68:71]
v_mfma_f32_16x16x32_bf16 v[88:91], a[164:167], a[84:87], v[88:91]
ds_read_b64_tr_b16 a[164:165], v5 offset:56352
ds_read_b64_tr_b16 a[166:167], v5 offset:58912
s_waitcnt lgkmcnt(8)
v_mfma_f32_16x16x32_bf16 v[72:75], a[168:171], a[80:83], v[72:75]
v_mfma_f32_16x16x32_bf16 v[92:95], a[168:171], a[84:87], v[92:95]
ds_read_b64_tr_b16 a[168:169], v5 offset:56384
ds_read_b64_tr_b16 a[170:171], v5 offset:58944
s_waitcnt lgkmcnt(8)
v_mfma_f32_16x16x32_bf16 v[76:79], a[172:175], a[80:83], v[76:79]
v_mfma_f32_16x16x32_bf16 v[96:99], a[172:175], a[84:87], v[96:99]
ds_read_b64_tr_b16 a[172:173], v5 offset:56416
ds_read_b64_tr_b16 a[174:175], v5 offset:58976
s_waitcnt lgkmcnt(8)
v_mfma_f32_16x16x32_bf16 v[80:83], a[176:179], a[80:83], v[80:83]
v_mfma_f32_16x16x32_bf16 v[100:103], a[176:179], a[84:87], v[100:103]
ds_read_b64_tr_b16 a[176:177], v5 offset:56448
ds_read_b64_tr_b16 a[178:179], v5 offset:59008
s_waitcnt vmcnt(10) lgkmcnt(8)
v_mfma_f32_16x16x32_bf16 v[64:67], a[160:163], a[88:91], v[64:67]
s_add_u32 s37, s32, 17408
buffer_load_dwordx4 a[136:139], v4, s[16:19], s37 offen sc1
v_mfma_f32_16x16x32_bf16 v[84:87], a[160:163], a[92:95], v[84:87]
ds_read_b64_tr_b16 a[160:161], v5 offset:61440
ds_read_b64_tr_b16 a[162:163], v5 offset:64000
s_add_u32 s37, s32, 37888
buffer_load_dwordx4 a[140:143], v4, s[16:19], s37 offen sc1
s_waitcnt lgkmcnt(8)
v_mfma_f32_16x16x32_bf16 v[68:71], a[164:167], a[88:91], v[68:71]
v_mfma_f32_16x16x32_bf16 v[88:91], a[164:167], a[92:95], v[88:91]
ds_read_b64_tr_b16 a[164:165], v5 offset:61472
ds_read_b64_tr_b16 a[166:167], v5 offset:64032
s_waitcnt lgkmcnt(8)
v_mfma_f32_16x16x32_bf16 v[72:75], a[168:171], a[88:91], v[72:75]
v_mfma_f32_16x16x32_bf16 v[92:95], a[168:171], a[92:95], v[92:95]
ds_read_b64_tr_b16 a[168:169], v5 offset:61504
ds_read_b64_tr_b16 a[170:171], v5 offset:64064
s_waitcnt lgkmcnt(8)
v_mfma_f32_16x16x32_bf16 v[76:79], a[172:175], a[88:91], v[76:79]
v_mfma_f32_16x16x32_bf16 v[96:99], a[172:175], a[92:95], v[96:99]
ds_read_b64_tr_b16 a[172:173], v5 offset:61536
ds_read_b64_tr_b16 a[174:175], v5 offset:64096
s_waitcnt lgkmcnt(8)
v_mfma_f32_16x16x32_bf16 v[80:83], a[176:179], a[88:91], v[80:83]
v_mfma_f32_16x16x32_bf16 v[100:103], a[176:179], a[92:95], v[100:103]
ds_read_b64_tr_b16 a[176:177], v5 offset:61568
ds_read_b64_tr_b16 a[178:179], v5 offset:64128
s_waitcnt vmcnt(10) lgkmcnt(8)
v_mfma_f32_16x16x32_bf16 v[64:67], a[160:163], a[96:99], v[64:67]
s_add_u32 s37, s32, 18432
buffer_load_dwordx4 a[144:147], v4, s[16:19], s37 offen sc1
v_mfma_f32_16x16x32_bf16 v[84:87], a[160:163], a[100:103], v[84:87]
ds_read_b64_tr_b16 a[160:161], v6 offset:1024
ds_read_b64_tr_b16 a[162:163], v6 offset:3584
s_add_u32 s37, s32, 38912
buffer_load_dwordx4 a[148:151], v4, s[16:19], s37 offen sc1
s_waitcnt lgkmcnt(8)
v_mfma_f32_16x16x32_bf16 v[68:71], a[164:167], a[96:99], v[68:71]
s_mov_b32 s14, 28508160
buffer_load_dwordx4 v[56:59], v52, s[24:27], s14 offen sc1
v_mfma_f32_16x16x32_bf16 v[88:91], a[164:167], a[100:103], v[88:91]
ds_read_b64_tr_b16 a[164:165], v6 offset:1056
ds_read_b64_tr_b16 a[166:167], v6 offset:3616
s_waitcnt lgkmcnt(8)
v_mfma_f32_16x16x32_bf16 v[72:75], a[168:171], a[96:99], v[72:75]
v_mfma_f32_16x16x32_bf16 v[92:95], a[168:171], a[100:103], v[92:95]
ds_read_b64_tr_b16 a[168:169], v6 offset:1088
ds_read_b64_tr_b16 a[170:171], v6 offset:3648
s_waitcnt lgkmcnt(8)
v_mfma_f32_16x16x32_bf16 v[76:79], a[172:175], a[96:99], v[76:79]
v_mfma_f32_16x16x32_bf16 v[96:99], a[172:175], a[100:103], v[96:99]
ds_read_b64_tr_b16 a[172:173], v6 offset:1120
ds_read_b64_tr_b16 a[174:175], v6 offset:3680
s_waitcnt lgkmcnt(8)
v_mfma_f32_16x16x32_bf16 v[80:83], a[176:179], a[96:99], v[80:83]
v_mfma_f32_16x16x32_bf16 v[100:103], a[176:179], a[100:103], v[100:103]
ds_read_b64_tr_b16 a[176:177], v6 offset:1152
ds_read_b64_tr_b16 a[178:179], v6 offset:3712
s_waitcnt vmcnt(11) lgkmcnt(8)
v_mfma_f32_16x16x32_bf16 v[64:67], a[160:163], a[104:107], v[64:67]
s_add_u32 s37, s32, 19456
buffer_load_dwordx4 a[152:155], v4, s[16:19], s37 offen sc1
v_mfma_f32_16x16x32_bf16 v[84:87], a[160:163], a[108:111], v[84:87]
ds_read_b64_tr_b16 a[160:161], v6 offset:6144
ds_read_b64_tr_b16 a[162:163], v6 offset:8704
s_add_u32 s37, s32, 39936
buffer_load_dwordx4 a[156:159], v4, s[16:19], s37 offen sc1
s_waitcnt lgkmcnt(8)
v_mfma_f32_16x16x32_bf16 v[68:71], a[164:167], a[104:107], v[68:71]
v_mfma_f32_16x16x32_bf16 v[88:91], a[164:167], a[108:111], v[88:91]
ds_read_b64_tr_b16 a[164:165], v6 offset:6176
ds_read_b64_tr_b16 a[166:167], v6 offset:8736
s_waitcnt lgkmcnt(8)
v_mfma_f32_16x16x32_bf16 v[72:75], a[168:171], a[104:107], v[72:75]
v_mfma_f32_16x16x32_bf16 v[92:95], a[168:171], a[108:111], v[92:95]
ds_read_b64_tr_b16 a[168:169], v6 offset:6208
ds_read_b64_tr_b16 a[170:171], v6 offset:8768
s_waitcnt lgkmcnt(8)
v_mfma_f32_16x16x32_bf16 v[76:79], a[172:175], a[104:107], v[76:79]
v_mfma_f32_16x16x32_bf16 v[96:99], a[172:175], a[108:111], v[96:99]
ds_read_b64_tr_b16 a[172:173], v6 offset:6240
ds_read_b64_tr_b16 a[174:175], v6 offset:8800
s_waitcnt lgkmcnt(8)
v_mfma_f32_16x16x32_bf16 v[80:83], a[176:179], a[104:107], v[80:83]
v_mfma_f32_16x16x32_bf16 v[100:103], a[176:179], a[108:111], v[100:103]
ds_read_b64_tr_b16 a[176:177], v6 offset:6272
ds_read_b64_tr_b16 a[178:179], v6 offset:8832
s_waitcnt vmcnt(11) lgkmcnt(8)
v_mfma_f32_16x16x32_bf16 v[64:67], a[160:163], a[112:115], v[64:67]
v_mfma_f32_16x16x32_bf16 v[84:87], a[160:163], a[116:119], v[84:87]
ds_read_b64_tr_b16 a[160:161], v6 offset:11264
ds_read_b64_tr_b16 a[162:163], v6 offset:13824
s_waitcnt lgkmcnt(8)
v_mfma_f32_16x16x32_bf16 v[68:71], a[164:167], a[112:115], v[68:71]
v_mfma_f32_16x16x32_bf16 v[88:91], a[164:167], a[116:119], v[88:91]
ds_read_b64_tr_b16 a[164:165], v6 offset:11296
ds_read_b64_tr_b16 a[166:167], v6 offset:13856
s_waitcnt lgkmcnt(8)
v_mfma_f32_16x16x32_bf16 v[72:75], a[168:171], a[112:115], v[72:75]
v_mfma_f32_16x16x32_bf16 v[92:95], a[168:171], a[116:119], v[92:95]
ds_read_b64_tr_b16 a[168:169], v6 offset:11328
ds_read_b64_tr_b16 a[170:171], v6 offset:13888
s_waitcnt lgkmcnt(8)
v_mfma_f32_16x16x32_bf16 v[76:79], a[172:175], a[112:115], v[76:79]
v_mfma_f32_16x16x32_bf16 v[96:99], a[172:175], a[116:119], v[96:99]
ds_read_b64_tr_b16 a[172:173], v6 offset:11360
ds_read_b64_tr_b16 a[174:175], v6 offset:13920
s_waitcnt lgkmcnt(8)
v_mfma_f32_16x16x32_bf16 v[80:83], a[176:179], a[112:115], v[80:83]
v_mfma_f32_16x16x32_bf16 v[100:103], a[176:179], a[116:119], v[100:103]
ds_read_b64_tr_b16 a[176:177], v6 offset:11392
ds_read_b64_tr_b16 a[178:179], v6 offset:13952
s_waitcnt vmcnt(9) lgkmcnt(8)
v_mfma_f32_16x16x32_bf16 v[64:67], a[160:163], a[120:123], v[64:67]
v_mfma_f32_16x16x32_bf16 v[84:87], a[160:163], a[124:127], v[84:87]
ds_read_b64_tr_b16 a[160:161], v6 offset:16384
ds_read_b64_tr_b16 a[162:163], v6 offset:18944
s_waitcnt lgkmcnt(8)
v_mfma_f32_16x16x32_bf16 v[68:71], a[164:167], a[120:123], v[68:71]
v_mfma_f32_16x16x32_bf16 v[88:91], a[164:167], a[124:127], v[88:91]
ds_read_b64_tr_b16 a[164:165], v6 offset:16416
ds_read_b64_tr_b16 a[166:167], v6 offset:18976
s_waitcnt lgkmcnt(8)
v_mfma_f32_16x16x32_bf16 v[72:75], a[168:171], a[120:123], v[72:75]
v_mfma_f32_16x16x32_bf16 v[92:95], a[168:171], a[124:127], v[92:95]
ds_read_b64_tr_b16 a[168:169], v6 offset:16448
ds_read_b64_tr_b16 a[170:171], v6 offset:19008
s_waitcnt lgkmcnt(8)
v_mfma_f32_16x16x32_bf16 v[76:79], a[172:175], a[120:123], v[76:79]
v_mfma_f32_16x16x32_bf16 v[96:99], a[172:175], a[124:127], v[96:99]
ds_read_b64_tr_b16 a[172:173], v6 offset:16480
ds_read_b64_tr_b16 a[174:175], v6 offset:19040
s_waitcnt lgkmcnt(8)
v_mfma_f32_16x16x32_bf16 v[80:83], a[176:179], a[120:123], v[80:83]
v_mfma_f32_16x16x32_bf16 v[100:103], a[176:179], a[124:127], v[100:103]
ds_read_b64_tr_b16 a[176:177], v6 offset:16512
ds_read_b64_tr_b16 a[178:179], v6 offset:19072
s_waitcnt vmcnt(7) lgkmcnt(8)
v_mfma_f32_16x16x32_bf16 v[64:67], a[160:163], a[128:131], v[64:67]
v_mfma_f32_16x16x32_bf16 v[84:87], a[160:163], a[132:135], v[84:87]
ds_read_b64_tr_b16 a[160:161], v6 offset:21504
ds_read_b64_tr_b16 a[162:163], v6 offset:24064
s_waitcnt lgkmcnt(8)
v_mfma_f32_16x16x32_bf16 v[68:71], a[164:167], a[128:131], v[68:71]
v_mfma_f32_16x16x32_bf16 v[88:91], a[164:167], a[132:135], v[88:91]
ds_read_b64_tr_b16 a[164:165], v6 offset:21536
ds_read_b64_tr_b16 a[166:167], v6 offset:24096
s_waitcnt lgkmcnt(8)
v_mfma_f32_16x16x32_bf16 v[72:75], a[168:171], a[128:131], v[72:75]
v_mfma_f32_16x16x32_bf16 v[92:95], a[168:171], a[132:135], v[92:95]
ds_read_b64_tr_b16 a[168:169], v6 offset:21568
ds_read_b64_tr_b16 a[170:171], v6 offset:24128
s_waitcnt lgkmcnt(8)
v_mfma_f32_16x16x32_bf16 v[76:79], a[172:175], a[128:131], v[76:79]
v_mfma_f32_16x16x32_bf16 v[96:99], a[172:175], a[132:135], v[96:99]
ds_read_b64_tr_b16 a[172:173], v6 offset:21600
ds_read_b64_tr_b16 a[174:175], v6 offset:24160
s_waitcnt lgkmcnt(8)
v_mfma_f32_16x16x32_bf16 v[80:83], a[176:179], a[128:131], v[80:83]
v_mfma_f32_16x16x32_bf16 v[100:103], a[176:179], a[132:135], v[100:103]
ds_read_b64_tr_b16 a[176:177], v6 offset:21632
ds_read_b64_tr_b16 a[178:179], v6 offset:24192
s_waitcnt vmcnt(5) lgkmcnt(8)
v_mfma_f32_16x16x32_bf16 v[64:67], a[160:163], a[136:139], v[64:67]
v_mfma_f32_16x16x32_bf16 v[84:87], a[160:163], a[140:143], v[84:87]
ds_read_b64_tr_b16 a[160:161], v6 offset:26624
ds_read_b64_tr_b16 a[162:163], v6 offset:29184
s_waitcnt lgkmcnt(8)
v_mfma_f32_16x16x32_bf16 v[68:71], a[164:167], a[136:139], v[68:71]
v_mfma_f32_16x16x32_bf16 v[88:91], a[164:167], a[140:143], v[88:91]
ds_read_b64_tr_b16 a[164:165], v6 offset:26656
ds_read_b64_tr_b16 a[166:167], v6 offset:29216
s_waitcnt lgkmcnt(8)
v_mfma_f32_16x16x32_bf16 v[72:75], a[168:171], a[136:139], v[72:75]
v_mfma_f32_16x16x32_bf16 v[92:95], a[168:171], a[140:143], v[92:95]
ds_read_b64_tr_b16 a[168:169], v6 offset:26688
ds_read_b64_tr_b16 a[170:171], v6 offset:29248
s_waitcnt lgkmcnt(8)
v_mfma_f32_16x16x32_bf16 v[76:79], a[172:175], a[136:139], v[76:79]
v_mfma_f32_16x16x32_bf16 v[96:99], a[172:175], a[140:143], v[96:99]
ds_read_b64_tr_b16 a[172:173], v6 offset:26720
ds_read_b64_tr_b16 a[174:175], v6 offset:29280
s_waitcnt lgkmcnt(8)
v_mfma_f32_16x16x32_bf16 v[80:83], a[176:179], a[136:139], v[80:83]
v_mfma_f32_16x16x32_bf16 v[100:103], a[176:179], a[140:143], v[100:103]
ds_read_b64_tr_b16 a[176:177], v6 offset:26752
ds_read_b64_tr_b16 a[178:179], v6 offset:29312
s_waitcnt vmcnt(3) lgkmcnt(8)
v_mfma_f32_16x16x32_bf16 v[64:67], a[160:163], a[144:147], v[64:67]
v_mfma_f32_16x16x32_bf16 v[84:87], a[160:163], a[148:151], v[84:87]
ds_read_b64_tr_b16 a[160:161], v6 offset:31744
ds_read_b64_tr_b16 a[162:163], v6 offset:34304
s_waitcnt lgkmcnt(8)
v_mfma_f32_16x16x32_bf16 v[68:71], a[164:167], a[144:147], v[68:71]
v_mfma_f32_16x16x32_bf16 v[88:91], a[164:167], a[148:151], v[88:91]
ds_read_b64_tr_b16 a[164:165], v6 offset:31776
ds_read_b64_tr_b16 a[166:167], v6 offset:34336
s_waitcnt lgkmcnt(8)
v_mfma_f32_16x16x32_bf16 v[72:75], a[168:171], a[144:147], v[72:75]
v_mfma_f32_16x16x32_bf16 v[92:95], a[168:171], a[148:151], v[92:95]
ds_read_b64_tr_b16 a[168:169], v6 offset:31808
ds_read_b64_tr_b16 a[170:171], v6 offset:34368
s_waitcnt lgkmcnt(8)
v_mfma_f32_16x16x32_bf16 v[76:79], a[172:175], a[144:147], v[76:79]
v_mfma_f32_16x16x32_bf16 v[96:99], a[172:175], a[148:151], v[96:99]
ds_read_b64_tr_b16 a[172:173], v6 offset:31840
ds_read_b64_tr_b16 a[174:175], v6 offset:34400
s_waitcnt lgkmcnt(8)
v_mfma_f32_16x16x32_bf16 v[80:83], a[176:179], a[144:147], v[80:83]
v_mfma_f32_16x16x32_bf16 v[100:103], a[176:179], a[148:151], v[100:103]
ds_read_b64_tr_b16 a[176:177], v6 offset:31872
ds_read_b64_tr_b16 a[178:179], v6 offset:34432
s_waitcnt vmcnt(0) lgkmcnt(8)
v_mfma_f32_16x16x32_bf16 v[64:67], a[160:163], a[152:155], v[64:67]
v_mfma_f32_16x16x32_bf16 v[84:87], a[160:163], a[156:159], v[84:87]
s_waitcnt lgkmcnt(6)
v_mfma_f32_16x16x32_bf16 v[68:71], a[164:167], a[152:155], v[68:71]
v_mfma_f32_16x16x32_bf16 v[88:91], a[164:167], a[156:159], v[88:91]
s_waitcnt lgkmcnt(4)
v_mfma_f32_16x16x32_bf16 v[72:75], a[168:171], a[152:155], v[72:75]
v_mfma_f32_16x16x32_bf16 v[92:95], a[168:171], a[156:159], v[92:95]
s_waitcnt lgkmcnt(2)
v_mfma_f32_16x16x32_bf16 v[76:79], a[172:175], a[152:155], v[76:79]
v_mfma_f32_16x16x32_bf16 v[96:99], a[172:175], a[156:159], v[96:99]
s_waitcnt lgkmcnt(0)
v_mfma_f32_16x16x32_bf16 v[80:83], a[176:179], a[152:155], v[80:83]
v_mfma_f32_16x16x32_bf16 v[100:103], a[176:179], a[156:159], v[100:103]
s_mov_b32 s93, 0x40000
L_ck_w2:
v_xor_b32 v56, s90, v56
v_xor_b32 v57, s90, v57
v_xor_b32 v58, s90, v58
v_xor_b32 v59, s90, v59
v_or_b32 v56, v56, v57
v_or_b32 v58, v58, v59
v_or_b32 v56, v56, v58
v_cmp_eq_u32 vcc, 0, v56
s_sub_u32 s93, s93, 1
s_cmp_eq_u32 s93, 0
s_cbranch_scc1 L_cd_w2
s_cmp_eq_u64 vcc, exec
s_cbranch_scc1 L_cd_w2
s_sleep 8
s_mov_b32 s14, 28508160
buffer_load_dwordx4 v[56:59], v52, s[24:27], s14 offen sc1
s_waitcnt vmcnt(0)
s_branch L_ck_w2
L_cd_w2:
s_barrier
s_and_b32 s33, s11, 3
s_cmp_lt_u32 s10, 6
s_cbranch_scc0 L_nw3_wo_0
s_lshr_b32 s34, s10, 1
s_lshl_b32 s34, s34, 2
s_add_u32 s33, s33, s34
s_mul_i32 s33, s33, 184320
s_add_u32 s33, s33, 7905280
s_branch L_nw3_d_0
L_nw3_wo_0:
s_mul_i32 s33, s33, 204800
s_add_u32 s33, s33, 12328960
L_nw3_d_0:
s_lshl_b32 s34, s3, 12
s_add_u32 s33, s33, s34
s_lshl_b32 s51, s12, 7
s_lshl_b32 s14, s13, 2
s_add_u32 s51, s51, s14
s_add_u32 s51, s51, 28513280
s_mul_i32 s14, s13, 5
s_and_b32 s50, s14, 1
s_lshr_b32 s14, s14, 1
s_lshl_b32 s14, s14, 10
s_mul_i32 s15, s48, 20480
s_add_u32 s14, s14, s15
s_add_u32 s14, s14, 13172736
s_add_u32 s15, s14, 20480
v_cvt_pk_bf16_f32 v112, v64, v65
v_cvt_pk_bf16_f32 v113, v66, v67
v_cvt_pk_bf16_f32 v114, v68, v69
v_cvt_pk_bf16_f32 v115, v70, v71
v_cvt_pk_bf16_f32 v116, v72, v73
v_cvt_pk_bf16_f32 v117, v74, v75
v_cvt_pk_bf16_f32 v118, v76, v77
v_cvt_pk_bf16_f32 v119, v78, v79
v_cvt_pk_bf16_f32 v120, v80, v81
v_cvt_pk_bf16_f32 v121, v82, v83
v_cvt_pk_bf16_f32 v122, v84, v85
v_cvt_pk_bf16_f32 v123, v86, v87
v_cvt_pk_bf16_f32 v124, v88, v89
v_cvt_pk_bf16_f32 v125, v90, v91
v_cvt_pk_bf16_f32 v126, v92, v93
v_cvt_pk_bf16_f32 v127, v94, v95
v_cvt_pk_bf16_f32 v128, v96, v97
v_cvt_pk_bf16_f32 v129, v98, v99
v_cvt_pk_bf16_f32 v130, v100, v101
v_cvt_pk_bf16_f32 v131, v102, v103
s_nop 0
v_mfma_f32_16x16x32_bf16 v[140:143], a[200:203], v[112:115], 0
v_mfma_f32_16x16x32_bf16 v[144:147], v[112:115], v[112:115], 0
v_mfma_f32_16x16x32_bf16 v[148:151], a[200:203], v[122:125], 0
v_mfma_f32_16x16x32_bf16 v[152:155], v[122:125], v[122:125], 0
v_mfma_f32_16x16x32_bf16 v[140:143], a[200:203], v[116:119], v[140:143]
v_mfma_f32_16x16x32_bf16 v[144:147], v[116:119], v[116:119], v[144:147]
v_mfma_f32_16x16x32_bf16 v[148:151], a[200:203], v[126:129], v[148:151]
v_mfma_f32_16x16x32_bf16 v[152:155], v[126:129], v[126:129], v[152:155]
s_cmp_eq_u32 s50, 0
s_cbranch_scc0 L_x1_0_odd
buffer_store_dwordx4 v[112:115], v4, s[24:27], s14 offen offset:0 sc1
buffer_store_dwordx4 v[116:119], v4, s[24:27], s14 offen offset:1024 sc1
buffer_store_dwordx2 v[120:121], v4, s[24:27], s14 offen offset:2048 sc1
s_branch L_x1_0_std
L_x1_0_odd:
buffer_store_dwordx2 v[112:113], v4, s[24:27], s14 offen offset:8 sc1
buffer_store_dwordx4 v[114:117], v4, s[24:27], s14 offen offset:1024 sc1
buffer_store_dwordx4 v[118:121], v4, s[24:27], s14 offen offset:2048 sc1
L_x1_0_std:
s_cmp_eq_u32 s50, 0
s_cbranch_scc0 L_x1_1_odd
buffer_store_dwordx4 v[122:125], v4, s[24:27], s15 offen offset:0 sc1
buffer_store_dwordx4 v[126:129], v4, s[24:27], s15 offen offset:1024 sc1
buffer_store_dwordx2 v[130:131], v4, s[24:27], s15 offen offset:2048 sc1
s_branch L_x1_1_std
L_x1_1_odd:
buffer_store_dwordx2 v[122:123], v4, s[24:27], s15 offen offset:8 sc1
buffer_store_dwordx4 v[124:127], v4, s[24:27], s15 offen offset:1024 sc1
buffer_store_dwordx4 v[128:131], v4, s[24:27], s15 offen offset:2048 sc1
L_x1_1_std:
s_nop 1
v_mfma_f32_16x16x16_bf16 v[140:143], a[200:201], v[120:121], v[140:143]
v_mfma_f32_16x16x16_bf16 v[144:147], v[120:121], v[120:121], v[144:147]
v_mfma_f32_16x16x16_bf16 v[148:151], a[200:201], v[130:131], v[148:151]
v_mfma_f32_16x16x16_bf16 v[152:155], v[130:131], v[130:131], v[152:155]
v_and_b32 v9, 3, v3
v_cmp_eq_u32 s[40:41], 1, v9
v_cmp_eq_u32 s[42:43], 2, v9
v_cmp_eq_u32 s[44:45], 3, v9
v_lshrrev_b32 v10, 2, v3
v_lshlrev_b32 v10, 4, v10
v_add_u32 v10, v10, v3
v_lshlrev_b32 v10, 2, v10
v_lshlrev_b32 v11, 3, v1
s_lshl_b32 s14, s12, 3
s_add_u32 s14, s14, s13
s_lshl_b32 s14, s14, 10
s_lshl_b32 s15, s3, 8
s_add_u32 s14, s14, s15
s_add_u32 s14, s14, 15794176
s_nop 3
v_cndmask_b32 v12, v144, v145, s[40:41]
v_cndmask_b32 v12, v12, v146, s[42:43]
v_cndmask_b32 v12, v12, v147, s[44:45]
v_mov_b32 v14, v140
ds_bpermute_b32 v15, v10, v12
s_nop 0
v_cndmask_b32 v12, v152, v153, s[40:41]
v_cndmask_b32 v12, v12, v154, s[42:43]
v_cndmask_b32 v12, v12, v155, s[44:45]
v_mov_b32 v16, v148
ds_bpermute_b32 v17, v10, v12
s_nop 0
s_waitcnt lgkmcnt(0)
v_cmp_eq_u32 vcc, 1, v2
s_nop 1
v_cndmask_b32 v14, v14, v16, vcc
v_cndmask_b32 v15, v15, v17, vcc
v_cmp_gt_u32 vcc, 32, v1
s_and_saveexec_b64 s[40:41], vcc
buffer_store_dwordx2 v[14:15], v11, s[24:27], s14 offen sc1
s_mov_b64 exec, s[40:41]
s_add_u32 m0, s34, 0
s_add_u32 s36, s33, 0
buffer_load_dwordx4 v4, s[24:27], s36 offen offset:0  lds
buffer_load_dwordx4 v4, s[24:27], s36 offen offset:1024  lds
buffer_load_dwordx4 v4, s[24:27], s36 offen offset:2048  lds
buffer_load_dwordx4 v4, s[24:27], s36 offen offset:3072  lds
s_add_u32 m0, s34, 16384
s_add_u32 s36, s33, 16384
buffer_load_dwordx4 v4, s[24:27], s36 offen offset:0  lds
buffer_load_dwordx4 v4, s[24:27], s36 offen offset:1024  lds
buffer_load_dwordx4 v4, s[24:27], s36 offen offset:2048  lds
buffer_load_dwordx4 v4, s[24:27], s36 offen offset:3072  lds
s_waitcnt vmcnt(8) lgkmcnt(0)
s_barrier
s_cmp_eq_u32 s3, 0
s_cbranch_scc0 L_pub_p2w
v_mov_b32 v60, s90
v_mov_b32 v61, 0
s_mov_b64 s[94:95], exec
s_mov_b64 exec, 1
buffer_store_dword v60, v61, s[24:27], s51 offen sc1
s_mov_b64 exec, s[94:95]
L_pub_p2w:
s_add_u32 m0, s34, 32768
s_add_u32 s36, s33, 32768
buffer_load_dwordx4 v4, s[24:27], s36 offen offset:0  lds
buffer_load_dwordx4 v4, s[24:27], s36 offen offset:1024  lds
buffer_load_dwordx4 v4, s[24:27], s36 offen offset:2048  lds
buffer_load_dwordx4 v4, s[24:27], s36 offen offset:3072  lds
s_add_u32 m0, s34, 49152
s_add_u32 s36, s33, 49152
buffer_load_dwordx4 v4, s[24:27], s36 offen offset:0  lds
buffer_load_dwordx4 v4, s[24:27], s36 offen offset:1024  lds
buffer_load_dwordx4 v4, s[24:27], s36 offen offset:2048  lds
buffer_load_dwordx4 v4, s[24:27], s36 offen offset:3072  lds
s_add_u32 m0, s34, 65536
s_add_u32 s36, s33, 65536
buffer_load_dwordx4 v4, s[24:27], s36 offen offset:0  lds
buffer_load_dwordx4 v4, s[24:27], s36 offen offset:1024  lds
buffer_load_dwordx4 v4, s[24:27], s36 offen offset:2048  lds
buffer_load_dwordx4 v4, s[24:27], s36 offen offset:3072  lds
s_add_u32 m0, s34, 81920
s_add_u32 s36, s33, 81920
buffer_load_dwordx4 v4, s[24:27], s36 offen offset:0  lds
buffer_load_dwordx4 v4, s[24:27], s36 offen offset:1024  lds
buffer_load_dwordx4 v4, s[24:27], s36 offen offset:2048  lds
buffer_load_dwordx4 v4, s[24:27], s36 offen offset:3072  lds
s_branch L_k2_kernel_fin
L_k2_o:
s_lshl_b32 s14, s12, 3
s_lshl_b32 s15, s3, 1
s_add_u32 s48, s14, s15
s_mov_b32 s24, s6
s_mov_b32 s25, s7
s_mov_b32 s26, 28520448
s_mov_b32 s27, 0x20000
s_mov_b32 s14, 28508160
s_cmp_eq_u32 s3, 0
s_cbranch_scc0 L_pd_p2o
v_and_b32 v60, 63, v0
v_min_u32 v60, 16, v60
v_lshlrev_b32 v61, 2, v60
s_lshl_b32 s15, s13, 7
v_add_u32 v61, s15, v61
s_lshl_b32 s15, s12, 7
s_lshr_b32 s38, s13, 1
s_lshl_b32 s38, s38, 2
s_add_u32 s15, s15, s38
s_add_u32 s15, s15, 1024
v_cmp_eq_u32 vcc, 16, v60
v_mov_b32 v60, s15
s_nop 0
v_cndmask_b32 v60, v61, v60, vcc
s_mov_b32 s93, 0x40000
L_pl_p2o:
buffer_load_dword v56, v60, s[24:27], s14 offen sc1
s_waitcnt vmcnt(0)
v_cmp_eq_u32 vcc, s90, v56
s_sub_u32 s93, s93, 1
s_cmp_eq_u32 s93, 0
s_cbranch_scc1 L_pd_p2o
s_cmp_eq_u64 vcc, exec
s_cbranch_scc1 L_pd_p2o
s_sleep 2
s_branch L_pl_p2o
L_pd_p2o:
s_waitcnt vmcnt(0)
s_barrier
v_and_b32 v52, 63, v0
v_lshrrev_b32 v53, 2, v52
v_lshlrev_b32 v53, 7, v53
v_and_b32 v54, 3, v52
v_lshl_add_u32 v53, v54, 4, v53
v_subrev_u32 v54, 32, v52
v_lshlrev_b32 v54, 7, v54
v_add_u32 v54, 1024, v54
v_cmp_gt_u32 vcc, 32, v52
s_nop 1
v_cndmask_b32 v52, v54, v53, vcc
s_mul_i32 s32, s13, 131072
s_lshl_b32 s14, s3, 15
s_add_u32 s32, s32, s14
s_add_u32 s32, s32, 5242880
v_mov_b32 v20, 0x00003f80
v_mov_b32 v21, 0x3f800000
s_add_u32 s14, s32, 0
buffer_load_dwordx4 v[64:67], v4, s[24:27], s14 offen offset:0 sc1
buffer_load_dwordx4 v[68:71], v4, s[24:27], s14 offen offset:1024 sc1
buffer_load_dwordx4 v[72:75], v4, s[24:27], s14 offen offset:2048 sc1
buffer_load_dwordx4 v[76:79], v4, s[24:27], s14 offen offset:3072 sc1
s_add_u32 s14, s32, 4096
buffer_load_dwordx4 v[80:83], v4, s[24:27], s14 offen offset:0 sc1
buffer_load_dwordx4 v[84:87], v4, s[24:27], s14 offen offset:1024 sc1
buffer_load_dwordx4 v[88:91], v4, s[24:27], s14 offen offset:2048 sc1
buffer_load_dwordx4 v[92:95], v4, s[24:27], s14 offen offset:3072 sc1
s_add_u32 s14, s32, 8192
buffer_load_dwordx4 v[96:99], v4, s[24:27], s14 offen offset:0 sc1
buffer_load_dwordx4 v[100:103], v4, s[24:27], s14 offen offset:1024 sc1
buffer_load_dwordx4 v[104:107], v4, s[24:27], s14 offen offset:2048 sc1
buffer_load_dwordx4 v[108:111], v4, s[24:27], s14 offen offset:3072 sc1
s_add_u32 s14, s32, 12288
buffer_load_dwordx4 v[112:115], v4, s[24:27], s14 offen offset:0 sc1
buffer_load_dwordx4 v[116:119], v4, s[24:27], s14 offen offset:1024 sc1
buffer_load_dwordx4 v[120:123], v4, s[24:27], s14 offen offset:2048 sc1
buffer_load_dwordx4 v[124:127], v4, s[24:27], s14 offen offset:3072 sc1
s_add_u32 s14, s32, 16384
buffer_load_dwordx4 v[128:131], v4, s[24:27], s14 offen offset:0 sc1
buffer_load_dwordx4 v[132:135], v4, s[24:27], s14 offen offset:1024 sc1
buffer_load_dwordx4 v[136:139], v4, s[24:27], s14 offen offset:2048 sc1
buffer_load_dwordx4 v[140:143], v4, s[24:27], s14 offen offset:3072 sc1
s_add_u32 s14, s32, 20480
buffer_load_dwordx4 v[144:147], v4, s[24:27], s14 offen offset:0 sc1
buffer_load_dwordx4 v[148:151], v4, s[24:27], s14 offen offset:1024 sc1
buffer_load_dwordx4 v[152:155], v4, s[24:27], s14 offen offset:2048 sc1
buffer_load_dwordx4 v[156:159], v4, s[24:27], s14 offen offset:3072 sc1
s_add_u32 s14, s32, 24576
buffer_load_dwordx4 v[160:163], v4, s[24:27], s14 offen offset:0 sc1
buffer_load_dwordx4 v[164:167], v4, s[24:27], s14 offen offset:1024 sc1
buffer_load_dwordx4 v[168:171], v4, s[24:27], s14 offen offset:2048 sc1
buffer_load_dwordx4 v[172:175], v4, s[24:27], s14 offen offset:3072 sc1
s_add_u32 s14, s32, 28672
buffer_load_dwordx4 v[176:179], v4, s[24:27], s14 offen offset:0 sc1
buffer_load_dwordx4 v[180:183], v4, s[24:27], s14 offen offset:1024 sc1
buffer_load_dwordx4 v[184:187], v4, s[24:27], s14 offen offset:2048 sc1
buffer_load_dwordx4 v[188:191], v4, s[24:27], s14 offen offset:3072 sc1
s_lshl_b32 s14, s48, 3
s_add_u32 s14, s14, s13
s_mul_i32 s14, s14, 2560
s_add_u32 s33, s14, 2621440
v_lshlrev_b32 v8, 3, v1
v_add_u32 v8, 2048, v8
s_add_u32 s14, s33, 0
buffer_load_dwordx4 a[0:3], v4, s[24:27], s14 offen sc1
buffer_load_dwordx4 a[4:7], v4, s[24:27], s14 offen offset:1024 sc1
buffer_load_dwordx2 a[8:9], v8, s[24:27], s14 offen sc1
s_add_u32 s14, s33, 20480
buffer_load_dwordx4 a[12:15], v4, s[24:27], s14 offen sc1
buffer_load_dwordx4 a[16:19], v4, s[24:27], s14 offen offset:1024 sc1
buffer_load_dwordx2 a[20:21], v8, s[24:27], s14 offen sc1
s_mov_b32 s14, 28508160
buffer_load_dwordx4 v[56:59], v52, s[24:27], s14 offen sc1
v_and_b32 v17, 3, v3
v_lshlrev_b32 v16, 2, v2
v_add_u32 v16, 0, v16
v_mul_u32_u24 v16, 3277, v16
v_lshrrev_b32 v16, 16, v16
v_cmp_eq_u32 s[62:63], v16, v17
v_lshlrev_b32 v16, 2, v2
v_add_u32 v16, 16, v16
v_mul_u32_u24 v16, 3277, v16
v_lshrrev_b32 v16, 16, v16
v_cmp_eq_u32 s[64:65], v16, v17
v_lshlrev_b32 v16, 2, v2
v_add_u32 v16, 32, v16
v_mul_u32_u24 v16, 3277, v16
v_lshrrev_b32 v16, 16, v16
v_cmp_eq_u32 s[66:67], v16, v17
v_lshlrev_b32 v16, 2, v2
v_add_u32 v16, 48, v16
v_mul_u32_u24 v16, 3277, v16
v_lshrrev_b32 v16, 16, v16
v_cmp_eq_u32 s[68:69], v16, v17
v_lshlrev_b32 v16, 2, v2
v_add_u32 v16, 64, v16
v_mul_u32_u24 v16, 3277, v16
v_lshrrev_b32 v16, 16, v16
v_cmp_eq_u32 s[70:71], v16, v17
v_cmp_eq_u32 s[80:81], 0, v2
v_cmp_gt_u32 s[82:83], 2, v2
v_cmp_gt_u32 s[84:85], 3, v2
s_mov_b32 s15, s3
s_mov_b32 s38, s3
s_lshl_b32 s39, s15, 4
v_lshl_add_u32 v16, v2, 2, s39
s_lshl_b32 s39, s38, 4
v_add_u32 v17, s39, v3
v_mul_u32_u24 v16, 3277, v16
v_mul_u32_u24 v17, 3277, v17
v_lshrrev_b32 v16, 16, v16
v_lshrrev_b32 v17, 16, v17
v_cmp_eq_u32 s[72:73], v16, v17
s_mul_i32 s39, s38, 3
s_lshr_b32 s38, s15, 1
s_add_u32 s39, s39, s38
s_lshl_b32 s39, s39, 10
s_and_b32 s38, s15, 1
s_lshl_b32 s38, s38, 3
s_add_u32 s39, s39, s38
v_add_u32 v24, s39, v4
s_add_u32 s15, s3, 1
s_mov_b32 s38, s3
s_lshl_b32 s39, s15, 4
v_lshl_add_u32 v16, v2, 2, s39
s_lshl_b32 s39, s38, 4
v_add_u32 v17, s39, v3
v_mul_u32_u24 v16, 3277, v16
v_mul_u32_u24 v17, 3277, v17
v_lshrrev_b32 v16, 16, v16
v_lshrrev_b32 v17, 16, v17
v_cmp_eq_u32 s[74:75], v16, v17
s_mul_i32 s39, s38, 3
s_lshr_b32 s38, s15, 1
s_add_u32 s39, s39, s38
s_lshl_b32 s39, s39, 10
s_and_b32 s38, s15, 1
s_lshl_b32 s38, s38, 3
s_add_u32 s39, s39, s38
v_add_u32 v25, s39, v4
s_sub_u32 s15, s3, 1
s_mov_b32 s38, s3
s_lshl_b32 s39, s15, 4
v_lshl_add_u32 v16, v2, 2, s39
s_lshl_b32 s39, s38, 4
v_add_u32 v17, s39, v3
v_mul_u32_u24 v16, 3277, v16
v_mul_u32_u24 v17, 3277, v17
v_lshrrev_b32 v16, 16, v16
v_lshrrev_b32 v17, 16, v17
v_cmp_eq_u32 s[76:77], v16, v17
s_mul_i32 s39, s38, 3
s_lshr_b32 s38, s15, 1
s_add_u32 s39, s39, s38
s_lshl_b32 s39, s39, 10
s_and_b32 s38, s15, 1
s_lshl_b32 s38, s38, 3
s_add_u32 s39, s39, s38
v_add_u32 v26, s39, v4
s_add_u32 s15, s3, 3
s_mov_b32 s38, 4
s_lshl_b32 s39, s15, 4
v_lshl_add_u32 v16, v2, 2, s39
s_lshl_b32 s39, s38, 4
v_add_u32 v17, s39, v3
v_mul_u32_u24 v16, 3277, v16
v_mul_u32_u24 v17, 3277, v17
v_lshrrev_b32 v16, 16, v16
v_lshrrev_b32 v17, 16, v17
v_cmp_eq_u32 s[78:79], v16, v17
s_mul_i32 s39, s38, 3
s_lshr_b32 s38, s15, 1
s_add_u32 s39, s39, s38
s_lshl_b32 s39, s39, 10
s_and_b32 s38, s15, 1
s_lshl_b32 s38, s38, 3
s_add_u32 s39, s39, s38
v_add_u32 v27, s39, v4
v_lshl_add_u32 v28, v3, 2, v2
v_lshlrev_b32 v28, 3, v28
s_mul_i32 s14, s13, 5
s_and_b32 s50, s14, 1
s_lshr_b32 s14, s14, 1
s_lshl_b32 s14, s14, 10
s_mul_i32 s15, s48, 20480
s_add_u32 s14, s14, s15
s_add_u32 s49, s14, 15925248
v_mov_b32 v16, 0
v_mov_b32 v17, 0
ds_write_b64 v4, v[16:17] offset:4104
ds_write_b64 v4, v[16:17] offset:6144
ds_write_b64 v4, v[16:17] offset:13312
v_mov_b32 v192, 0
v_mov_b32 v193, 0
v_mov_b32 v194, 0
v_mov_b32 v195, 0
v_mov_b32 v196, 0
v_mov_b32 v197, 0
v_mov_b32 v198, 0
v_mov_b32 v199, 0
s_waitcnt vmcnt(37)
v_dot2_f32_bf16 v192, v64, v20, v192
v_dot2_f32_bf16 v193, v64, v21, v193
v_dot2_f32_bf16 v194, v65, v20, v194
v_dot2_f32_bf16 v195, v65, v21, v195
v_dot2_f32_bf16 v196, v66, v20, v196
v_dot2_f32_bf16 v197, v66, v21, v197
v_dot2_f32_bf16 v198, v67, v20, v198
v_dot2_f32_bf16 v199, v67, v21, v199
v_dot2_f32_bf16 v192, v68, v20, v192
v_dot2_f32_bf16 v193, v68, v21, v193
v_dot2_f32_bf16 v194, v69, v20, v194
v_dot2_f32_bf16 v195, v69, v21, v195
v_dot2_f32_bf16 v196, v70, v20, v196
v_dot2_f32_bf16 v197, v70, v21, v197
v_dot2_f32_bf16 v198, v71, v20, v198
v_dot2_f32_bf16 v199, v71, v21, v199
s_waitcnt vmcnt(35)
v_dot2_f32_bf16 v192, v72, v20, v192
v_dot2_f32_bf16 v193, v72, v21, v193
v_dot2_f32_bf16 v194, v73, v20, v194
v_dot2_f32_bf16 v195, v73, v21, v195
v_dot2_f32_bf16 v196, v74, v20, v196
v_dot2_f32_bf16 v197, v74, v21, v197
v_dot2_f32_bf16 v198, v75, v20, v198
v_dot2_f32_bf16 v199, v75, v21, v199
v_dot2_f32_bf16 v192, v76, v20, v192
v_dot2_f32_bf16 v193, v76, v21, v193
v_dot2_f32_bf16 v194, v77, v20, v194
v_dot2_f32_bf16 v195, v77, v21, v195
v_dot2_f32_bf16 v196, v78, v20, v196
v_dot2_f32_bf16 v197, v78, v21, v197
v_dot2_f32_bf16 v198, v79, v20, v198
v_dot2_f32_bf16 v199, v79, v21, v199
s_waitcnt vmcnt(33)
v_dot2_f32_bf16 v192, v80, v20, v192
v_dot2_f32_bf16 v193, v80, v21, v193
v_dot2_f32_bf16 v194, v81, v20, v194
v_dot2_f32_bf16 v195, v81, v21, v195
v_dot2_f32_bf16 v196, v82, v20, v196
v_dot2_f32_bf16 v197, v82, v21, v197
v_dot2_f32_bf16 v198, v83, v20, v198
v_dot2_f32_bf16 v199, v83, v21, v199
v_dot2_f32_bf16 v192, v84, v20, v192
v_dot2_f32_bf16 v193, v84, v21, v193
v_dot2_f32_bf16 v194, v85, v20, v194
v_dot2_f32_bf16 v195, v85, v21, v195
v_dot2_f32_bf16 v196, v86, v20, v196
v_dot2_f32_bf16 v197, v86, v21, v197
v_dot2_f32_bf16 v198, v87, v20, v198
v_dot2_f32_bf16 v199, v87, v21, v199
s_waitcnt vmcnt(31)
v_dot2_f32_bf16 v192, v88, v20, v192
v_dot2_f32_bf16 v193, v88, v21, v193
v_dot2_f32_bf16 v194, v89, v20, v194
v_dot2_f32_bf16 v195, v89, v21, v195
v_dot2_f32_bf16 v196, v90, v20, v196
v_dot2_f32_bf16 v197, v90, v21, v197
v_dot2_f32_bf16 v198, v91, v20, v198
v_dot2_f32_bf16 v199, v91, v21, v199
v_dot2_f32_bf16 v192, v92, v20, v192
v_dot2_f32_bf16 v193, v92, v21, v193
v_dot2_f32_bf16 v194, v93, v20, v194
v_dot2_f32_bf16 v195, v93, v21, v195
v_dot2_f32_bf16 v196, v94, v20, v196
v_dot2_f32_bf16 v197, v94, v21, v197
v_dot2_f32_bf16 v198, v95, v20, v198
v_dot2_f32_bf16 v199, v95, v21, v199
s_waitcnt vmcnt(29)
v_dot2_f32_bf16 v192, v96, v20, v192
v_dot2_f32_bf16 v193, v96, v21, v193
v_dot2_f32_bf16 v194, v97, v20, v194
v_dot2_f32_bf16 v195, v97, v21, v195
v_dot2_f32_bf16 v196, v98, v20, v196
v_dot2_f32_bf16 v197, v98, v21, v197
v_dot2_f32_bf16 v198, v99, v20, v198
v_dot2_f32_bf16 v199, v99, v21, v199
v_dot2_f32_bf16 v192, v100, v20, v192
v_dot2_f32_bf16 v193, v100, v21, v193
v_dot2_f32_bf16 v194, v101, v20, v194
v_dot2_f32_bf16 v195, v101, v21, v195
v_dot2_f32_bf16 v196, v102, v20, v196
v_dot2_f32_bf16 v197, v102, v21, v197
v_dot2_f32_bf16 v198, v103, v20, v198
v_dot2_f32_bf16 v199, v103, v21, v199
s_waitcnt vmcnt(27)
v_dot2_f32_bf16 v192, v104, v20, v192
v_dot2_f32_bf16 v193, v104, v21, v193
v_dot2_f32_bf16 v194, v105, v20, v194
v_dot2_f32_bf16 v195, v105, v21, v195
v_dot2_f32_bf16 v196, v106, v20, v196
v_dot2_f32_bf16 v197, v106, v21, v197
v_dot2_f32_bf16 v198, v107, v20, v198
v_dot2_f32_bf16 v199, v107, v21, v199
v_dot2_f32_bf16 v192, v108, v20, v192
v_dot2_f32_bf16 v193, v108, v21, v193
v_dot2_f32_bf16 v194, v109, v20, v194
v_dot2_f32_bf16 v195, v109, v21, v195
v_dot2_f32_bf16 v196, v110, v20, v196
v_dot2_f32_bf16 v197, v110, v21, v197
v_dot2_f32_bf16 v198, v111, v20, v198
v_dot2_f32_bf16 v199, v111, v21, v199
s_waitcnt vmcnt(25)
v_dot2_f32_bf16 v192, v112, v20, v192
v_dot2_f32_bf16 v193, v112, v21, v193
v_dot2_f32_bf16 v194, v113, v20, v194
v_dot2_f32_bf16 v195, v113, v21, v195
v_dot2_f32_bf16 v196, v114, v20, v196
v_dot2_f32_bf16 v197, v114, v21, v197
v_dot2_f32_bf16 v198, v115, v20, v198
v_dot2_f32_bf16 v199, v115, v21, v199
v_dot2_f32_bf16 v192, v116, v20, v192
v_dot2_f32_bf16 v193, v116, v21, v193
v_dot2_f32_bf16 v194, v117, v20, v194
v_dot2_f32_bf16 v195, v117, v21, v195
v_dot2_f32_bf16 v196, v118, v20, v196
v_dot2_f32_bf16 v197, v118, v21, v197
v_dot2_f32_bf16 v198, v119, v20, v198
v_dot2_f32_bf16 v199, v119, v21, v199
s_waitcnt vmcnt(23)
v_dot2_f32_bf16 v192, v120, v20, v192
v_dot2_f32_bf16 v193, v120, v21, v193
v_dot2_f32_bf16 v194, v121, v20, v194
v_dot2_f32_bf16 v195, v121, v21, v195
v_dot2_f32_bf16 v196, v122, v20, v196
v_dot2_f32_bf16 v197, v122, v21, v197
v_dot2_f32_bf16 v198, v123, v20, v198
v_dot2_f32_bf16 v199, v123, v21, v199
v_dot2_f32_bf16 v192, v124, v20, v192
v_dot2_f32_bf16 v193, v124, v21, v193
v_dot2_f32_bf16 v194, v125, v20, v194
v_dot2_f32_bf16 v195, v125, v21, v195
v_dot2_f32_bf16 v196, v126, v20, v196
v_dot2_f32_bf16 v197, v126, v21, v197
v_dot2_f32_bf16 v198, v127, v20, v198
v_dot2_f32_bf16 v199, v127, v21, v199
s_nop 2
v_mov_b32 v200, 0
v_mov_b32 v201, 0
v_mov_b32 v202, 0
v_mov_b32 v203, 0
v_mov_b32 v204, 0
v_mov_b32 v205, 0
v_mov_b32 v206, 0
v_mov_b32 v207, 0
s_waitcnt vmcnt(21)
v_dot2_f32_bf16 v200, v128, v20, v200
v_dot2_f32_bf16 v201, v128, v21, v201
v_dot2_f32_bf16 v202, v129, v20, v202
v_dot2_f32_bf16 v203, v129, v21, v203
v_dot2_f32_bf16 v204, v130, v20, v204
v_dot2_f32_bf16 v205, v130, v21, v205
v_dot2_f32_bf16 v206, v131, v20, v206
v_dot2_f32_bf16 v207, v131, v21, v207
v_dot2_f32_bf16 v200, v132, v20, v200
v_dot2_f32_bf16 v201, v132, v21, v201
v_dot2_f32_bf16 v202, v133, v20, v202
v_dot2_f32_bf16 v203, v133, v21, v203
v_dot2_f32_bf16 v204, v134, v20, v204
v_dot2_f32_bf16 v205, v134, v21, v205
v_dot2_f32_bf16 v206, v135, v20, v206
v_dot2_f32_bf16 v207, v135, v21, v207
s_waitcnt vmcnt(19)
v_dot2_f32_bf16 v200, v136, v20, v200
v_dot2_f32_bf16 v201, v136, v21, v201
v_dot2_f32_bf16 v202, v137, v20, v202
v_dot2_f32_bf16 v203, v137, v21, v203
v_dot2_f32_bf16 v204, v138, v20, v204
v_dot2_f32_bf16 v205, v138, v21, v205
v_dot2_f32_bf16 v206, v139, v20, v206
v_dot2_f32_bf16 v207, v139, v21, v207
v_dot2_f32_bf16 v200, v140, v20, v200
v_dot2_f32_bf16 v201, v140, v21, v201
v_dot2_f32_bf16 v202, v141, v20, v202
v_dot2_f32_bf16 v203, v141, v21, v203
v_dot2_f32_bf16 v204, v142, v20, v204
v_dot2_f32_bf16 v205, v142, v21, v205
v_dot2_f32_bf16 v206, v143, v20, v206
v_dot2_f32_bf16 v207, v143, v21, v207
s_waitcnt vmcnt(17)
v_dot2_f32_bf16 v200, v144, v20, v200
v_dot2_f32_bf16 v201, v144, v21, v201
v_dot2_f32_bf16 v202, v145, v20, v202
v_dot2_f32_bf16 v203, v145, v21, v203
v_dot2_f32_bf16 v204, v146, v20, v204
v_dot2_f32_bf16 v205, v146, v21, v205
v_dot2_f32_bf16 v206, v147, v20, v206
v_dot2_f32_bf16 v207, v147, v21, v207
v_dot2_f32_bf16 v200, v148, v20, v200
v_dot2_f32_bf16 v201, v148, v21, v201
v_dot2_f32_bf16 v202, v149, v20, v202
v_dot2_f32_bf16 v203, v149, v21, v203
v_dot2_f32_bf16 v204, v150, v20, v204
v_dot2_f32_bf16 v205, v150, v21, v205
v_dot2_f32_bf16 v206, v151, v20, v206
v_dot2_f32_bf16 v207, v151, v21, v207
s_waitcnt vmcnt(15)
v_dot2_f32_bf16 v200, v152, v20, v200
v_dot2_f32_bf16 v201, v152, v21, v201
v_dot2_f32_bf16 v202, v153, v20, v202
v_dot2_f32_bf16 v203, v153, v21, v203
v_dot2_f32_bf16 v204, v154, v20, v204
v_dot2_f32_bf16 v205, v154, v21, v205
v_dot2_f32_bf16 v206, v155, v20, v206
v_dot2_f32_bf16 v207, v155, v21, v207
v_dot2_f32_bf16 v200, v156, v20, v200
v_dot2_f32_bf16 v201, v156, v21, v201
v_dot2_f32_bf16 v202, v157, v20, v202
v_dot2_f32_bf16 v203, v157, v21, v203
v_dot2_f32_bf16 v204, v158, v20, v204
v_dot2_f32_bf16 v205, v158, v21, v205
v_dot2_f32_bf16 v206, v159, v20, v206
v_dot2_f32_bf16 v207, v159, v21, v207
s_waitcnt vmcnt(13)
v_dot2_f32_bf16 v200, v160, v20, v200
v_dot2_f32_bf16 v201, v160, v21, v201
v_dot2_f32_bf16 v202, v161, v20, v202
v_dot2_f32_bf16 v203, v161, v21, v203
v_dot2_f32_bf16 v204, v162, v20, v204
v_dot2_f32_bf16 v205, v162, v21, v205
v_dot2_f32_bf16 v206, v163, v20, v206
v_dot2_f32_bf16 v207, v163, v21, v207
v_dot2_f32_bf16 v200, v164, v20, v200
v_dot2_f32_bf16 v201, v164, v21, v201
v_dot2_f32_bf16 v202, v165, v20, v202
v_dot2_f32_bf16 v203, v165, v21, v203
v_dot2_f32_bf16 v204, v166, v20, v204
v_dot2_f32_bf16 v205, v166, v21, v205
v_dot2_f32_bf16 v206, v167, v20, v206
v_dot2_f32_bf16 v207, v167, v21, v207
s_waitcnt vmcnt(11)
v_dot2_f32_bf16 v200, v168, v20, v200
v_dot2_f32_bf16 v201, v168, v21, v201
v_dot2_f32_bf16 v202, v169, v20, v202
v_dot2_f32_bf16 v203, v169, v21, v203
v_dot2_f32_bf16 v204, v170, v20, v204
v_dot2_f32_bf16 v205, v170, v21, v205
v_dot2_f32_bf16 v206, v171, v20, v206
v_dot2_f32_bf16 v207, v171, v21, v207
v_dot2_f32_bf16 v200, v172, v20, v200
v_dot2_f32_bf16 v201, v172, v21, v201
v_dot2_f32_bf16 v202, v173, v20, v202
v_dot2_f32_bf16 v203, v173, v21, v203
v_dot2_f32_bf16 v204, v174, v20, v204
v_dot2_f32_bf16 v205, v174, v21, v205
v_dot2_f32_bf16 v206, v175, v20, v206
v_dot2_f32_bf16 v207, v175, v21, v207
s_waitcnt vmcnt(9)
v_dot2_f32_bf16 v200, v176, v20, v200
v_dot2_f32_bf16 v201, v176, v21, v201
v_dot2_f32_bf16 v202, v177, v20, v202
v_dot2_f32_bf16 v203, v177, v21, v203
v_dot2_f32_bf16 v204, v178, v20, v204
v_dot2_f32_bf16 v205, v178, v21, v205
v_dot2_f32_bf16 v206, v179, v20, v206
v_dot2_f32_bf16 v207, v179, v21, v207
v_dot2_f32_bf16 v200, v180, v20, v200
v_dot2_f32_bf16 v201, v180, v21, v201
v_dot2_f32_bf16 v202, v181, v20, v202
v_dot2_f32_bf16 v203, v181, v21, v203
v_dot2_f32_bf16 v204, v182, v20, v204
v_dot2_f32_bf16 v205, v182, v21, v205
v_dot2_f32_bf16 v206, v183, v20, v206
v_dot2_f32_bf16 v207, v183, v21, v207
s_waitcnt vmcnt(7)
v_dot2_f32_bf16 v200, v184, v20, v200
v_dot2_f32_bf16 v201, v184, v21, v201
v_dot2_f32_bf16 v202, v185, v20, v202
v_dot2_f32_bf16 v203, v185, v21, v203
v_dot2_f32_bf16 v204, v186, v20, v204
v_dot2_f32_bf16 v205, v186, v21, v205
v_dot2_f32_bf16 v206, v187, v20, v206
v_dot2_f32_bf16 v207, v187, v21, v207
v_dot2_f32_bf16 v200, v188, v20, v200
v_dot2_f32_bf16 v201, v188, v21, v201
v_dot2_f32_bf16 v202, v189, v20, v202
v_dot2_f32_bf16 v203, v189, v21, v203
v_dot2_f32_bf16 v204, v190, v20, v204
v_dot2_f32_bf16 v205, v190, v21, v205
v_dot2_f32_bf16 v206, v191, v20, v206
v_dot2_f32_bf16 v207, v191, v21, v207
s_nop 2
v_cvt_pk_bf16_f32 v12, v192, v193
v_cvt_pk_bf16_f32 v13, v194, v195
v_cndmask_b32 v12, 0, v12, s[72:73]
v_cndmask_b32 v13, 0, v13, s[72:73]
ds_write_b64 v24, v[12:13] offset:0
v_cvt_pk_bf16_f32 v12, v196, v197
v_cvt_pk_bf16_f32 v13, v198, v199
v_cndmask_b32 v12, 0, v12, s[74:75]
v_cndmask_b32 v13, 0, v13, s[74:75]
ds_write_b64 v25, v[12:13] offset:0
s_cmp_eq_u32 s3, 0
s_cbranch_scc0 L_o_b1l
v_cvt_pk_bf16_f32 v12, v200, v201
v_cvt_pk_bf16_f32 v13, v202, v203
v_cmp_eq_u32 vcc, 0, v3
s_and_saveexec_b64 s[40:41], vcc
ds_write_b64 v28, v[12:13] offset:16384
s_mov_b64 exec, s[40:41]
s_branch L_o_b1h
L_o_b1l:
v_cvt_pk_bf16_f32 v12, v200, v201
v_cvt_pk_bf16_f32 v13, v202, v203
v_cndmask_b32 v12, 0, v12, s[76:77]
v_cndmask_b32 v13, 0, v13, s[76:77]
ds_write_b64 v26, v[12:13] offset:0
L_o_b1h:
s_cmp_lt_u32 s3, 2
s_cbranch_scc0 L_o_z
v_cvt_pk_bf16_f32 v12, v204, v205
v_cvt_pk_bf16_f32 v13, v206, v207
v_cndmask_b32 v12, 0, v12, s[78:79]
v_cndmask_b32 v13, 0, v13, s[78:79]
ds_write_b64 v27, v[12:13] offset:0
s_branch L_o_wd
L_o_z:
v_cvt_pk_bf16_f32 v12, v204, v205
v_cvt_pk_bf16_f32 v13, v206, v207
s_cmp_eq_u32 s3, 3
s_cselect_b32 s15, 1, 4
v_cmp_eq_u32 s[42:43], s15, v3
v_cmp_eq_u32 vcc, s3, v3
s_nop 1
s_or_b64 vcc, vcc, s[42:43]
s_and_saveexec_b64 s[40:41], vcc
ds_write_b64 v28, v[12:13] offset:16384
s_mov_b64 exec, s[40:41]
L_o_wd:
s_waitcnt lgkmcnt(0)
s_barrier
ds_read_b128 a[32:35], v4 offset:0
ds_read_b128 a[36:39], v4 offset:3072
ds_read_b128 a[40:43], v4 offset:4096
ds_read_b128 a[44:47], v4 offset:6144
ds_read_b128 a[48:51], v4 offset:7168
ds_read_b128 a[52:55], v4 offset:10240
ds_read_b64 a[56:57], v4 offset:11264
ds_read_b128 a[60:63], v4 offset:13312
ds_read_b64 a[64:65], v4 offset:14336
v_lshlrev_b32 v8, 3, v2
ds_read_b64 v[64:65], v8 offset:16384
ds_read_b64 v[66:67], v8 offset:16416
ds_read_b64 v[68:69], v8 offset:16448
ds_read_b64 v[70:71], v8 offset:16480
ds_read_b64 v[72:73], v8 offset:16512
s_waitcnt lgkmcnt(0)
v_cndmask_b32 v64, 0, v64, s[62:63]
v_cndmask_b32 v65, 0, v65, s[62:63]
v_cndmask_b32 v66, 0, v66, s[64:65]
v_cndmask_b32 v67, 0, v67, s[64:65]
v_cndmask_b32 v68, 0, v68, s[66:67]
v_cndmask_b32 v69, 0, v69, s[66:67]
v_cndmask_b32 v70, 0, v70, s[68:69]
v_cndmask_b32 v71, 0, v71, s[68:69]
v_cndmask_b32 v72, 0, v72, s[70:71]
v_cndmask_b32 v73, 0, v73, s[70:71]
s_waitcnt vmcnt(1)
s_waitcnt vmcnt(0)
s_mov_b32 s93, 0x40000
L_ck_o:
v_xor_b32 v56, s90, v56
v_xor_b32 v57, s90, v57
v_xor_b32 v58, s90, v58
v_xor_b32 v59, s90, v59
v_or_b32 v56, v56, v57
v_or_b32 v58, v58, v59
v_or_b32 v56, v56, v58
v_cmp_eq_u32 vcc, 0, v56
s_sub_u32 s93, s93, 1
s_cmp_eq_u32 s93, 0
s_cbranch_scc1 L_cd_o
s_cmp_eq_u64 vcc, exec
s_cbranch_scc1 L_cd_o
s_sleep 8
s_mov_b32 s14, 28508160
buffer_load_dwordx4 v[56:59], v52, s[24:27], s14 offen sc1
s_waitcnt vmcnt(0)
s_branch L_ck_o
L_cd_o:
s_barrier
s_and_b32 s33, s11, 3
s_cmp_lt_u32 s10, 6
s_cbranch_scc0 L_nw3_wo_1
s_lshr_b32 s34, s10, 1
s_lshl_b32 s34, s34, 2
s_add_u32 s33, s33, s34
s_mul_i32 s33, s33, 184320
s_add_u32 s33, s33, 7905280
s_branch L_nw3_d_1
L_nw3_wo_1:
s_mul_i32 s33, s33, 204800
s_add_u32 s33, s33, 12328960
L_nw3_d_1:
s_lshl_b32 s34, s3, 12
s_add_u32 s33, s33, s34
s_lshl_b32 s51, s12, 7
s_lshl_b32 s14, s13, 2
s_add_u32 s51, s51, s14
s_add_u32 s51, s51, 28513312
v_mfma_f32_16x16x32_bf16 v[120:123], v[64:67], a[0:3], 0
v_mfma_f32_16x16x32_bf16 v[80:83], a[32:35], a[0:3], 0
v_mfma_f32_16x16x32_bf16 v[84:87], a[36:39], a[0:3], 0
v_mfma_f32_16x16x32_bf16 v[88:91], a[44:47], a[0:3], 0
v_mfma_f32_16x16x32_bf16 v[92:95], a[52:55], a[4:7], 0
v_mfma_f32_16x16x32_bf16 v[96:99], a[60:63], a[4:7], 0
v_mfma_f32_16x16x32_bf16 v[120:123], v[68:71], a[4:7], v[120:123]
v_mfma_f32_16x16x32_bf16 v[84:87], a[40:43], a[4:7], v[84:87]
v_mfma_f32_16x16x32_bf16 v[88:91], a[48:51], a[4:7], v[88:91]
v_mfma_f32_16x16x32_bf16 v[124:127], v[64:67], a[12:15], 0
v_mfma_f32_16x16x32_bf16 v[100:103], a[32:35], a[12:15], 0
v_mfma_f32_16x16x32_bf16 v[104:107], a[36:39], a[12:15], 0
v_mfma_f32_16x16x32_bf16 v[108:111], a[44:47], a[12:15], 0
v_mfma_f32_16x16x32_bf16 v[112:115], a[52:55], a[16:19], 0
v_mfma_f32_16x16x32_bf16 v[116:119], a[60:63], a[16:19], 0
v_mfma_f32_16x16x32_bf16 v[124:127], v[68:71], a[16:19], v[124:127]
v_mfma_f32_16x16x32_bf16 v[104:107], a[40:43], a[16:19], v[104:107]
v_mfma_f32_16x16x32_bf16 v[108:111], a[48:51], a[16:19], v[108:111]
s_nop 7
v_mfma_f32_16x16x16_bf16 v[120:123], v[72:73], a[8:9], v[120:123]
v_mfma_f32_16x16x16_bf16 v[92:95], a[56:57], a[8:9], v[92:95]
v_mfma_f32_16x16x16_bf16 v[96:99], a[64:65], a[8:9], v[96:99]
v_mfma_f32_16x16x16_bf16 v[124:127], v[72:73], a[20:21], v[124:127]
v_mfma_f32_16x16x16_bf16 v[112:115], a[56:57], a[20:21], v[112:115]
v_mfma_f32_16x16x16_bf16 v[116:119], a[64:65], a[20:21], v[116:119]
s_nop 7
v_add_f32 v120, 0x358637bd, v120
v_add_f32 v121, 0x358637bd, v121
v_add_f32 v122, 0x358637bd, v122
v_add_f32 v123, 0x358637bd, v123
v_rcp_f32 v120, v120
v_rcp_f32 v121, v121
v_rcp_f32 v122, v122
v_rcp_f32 v123, v123
s_nop 0
v_mov_b32 v150, v120
v_cndmask_b32 v152, v121, v120, s[80:81]
v_cndmask_b32 v154, v122, v121, s[82:83]
v_cndmask_b32 v156, v123, v122, s[84:85]
v_mov_b32 v158, v123
v_pk_mul_f32 v[80:81], v[80:81], v[150:151] op_sel_hi:[1,0]
v_pk_mul_f32 v[82:83], v[82:83], v[150:151] op_sel_hi:[1,0]
v_cvt_pk_bf16_f32 v128, v80, v81
v_cvt_pk_bf16_f32 v129, v82, v83
v_pk_mul_f32 v[84:85], v[84:85], v[152:153] op_sel_hi:[1,0]
v_pk_mul_f32 v[86:87], v[86:87], v[152:153] op_sel_hi:[1,0]
v_cvt_pk_bf16_f32 v130, v84, v85
v_cvt_pk_bf16_f32 v131, v86, v87
v_pk_mul_f32 v[88:89], v[88:89], v[154:155] op_sel_hi:[1,0]
v_pk_mul_f32 v[90:91], v[90:91], v[154:155] op_sel_hi:[1,0]
v_cvt_pk_bf16_f32 v132, v88, v89
v_cvt_pk_bf16_f32 v133, v90, v91
v_pk_mul_f32 v[92:93], v[92:93], v[156:157] op_sel_hi:[1,0]
v_pk_mul_f32 v[94:95], v[94:95], v[156:157] op_sel_hi:[1,0]
v_cvt_pk_bf16_f32 v134, v92, v93
v_cvt_pk_bf16_f32 v135, v94, v95
v_pk_mul_f32 v[96:97], v[96:97], v[158:159] op_sel_hi:[1,0]
v_pk_mul_f32 v[98:99], v[98:99], v[158:159] op_sel_hi:[1,0]
v_cvt_pk_bf16_f32 v136, v96, v97
v_cvt_pk_bf16_f32 v137, v98, v99
s_cmp_eq_u32 s50, 0
s_cbranch_scc0 L_o_0_odd
buffer_store_dwordx4 v[128:131], v4, s[24:27], s49 offen offset:0 sc1
buffer_store_dwordx4 v[132:135], v4, s[24:27], s49 offen offset:1024 sc1
buffer_store_dwordx2 v[136:137], v4, s[24:27], s49 offen offset:2048 sc1
s_branch L_o_0_std
L_o_0_odd:
buffer_store_dwordx2 v[128:129], v4, s[24:27], s49 offen offset:8 sc1
buffer_store_dwordx4 v[130:133], v4, s[24:27], s49 offen offset:1024 sc1
buffer_store_dwordx4 v[134:137], v4, s[24:27], s49 offen offset:2048 sc1
L_o_0_std:
v_add_f32 v124, 0x358637bd, v124
v_add_f32 v125, 0x358637bd, v125
v_add_f32 v126, 0x358637bd, v126
v_add_f32 v127, 0x358637bd, v127
v_rcp_f32 v124, v124
v_rcp_f32 v125, v125
v_rcp_f32 v126, v126
v_rcp_f32 v127, v127
s_nop 0
v_mov_b32 v150, v124
v_cndmask_b32 v152, v125, v124, s[80:81]
v_cndmask_b32 v154, v126, v125, s[82:83]
v_cndmask_b32 v156, v127, v126, s[84:85]
v_mov_b32 v158, v127
v_pk_mul_f32 v[100:101], v[100:101], v[150:151] op_sel_hi:[1,0]
v_pk_mul_f32 v[102:103], v[102:103], v[150:151] op_sel_hi:[1,0]
v_cvt_pk_bf16_f32 v138, v100, v101
v_cvt_pk_bf16_f32 v139, v102, v103
v_pk_mul_f32 v[104:105], v[104:105], v[152:153] op_sel_hi:[1,0]
v_pk_mul_f32 v[106:107], v[106:107], v[152:153] op_sel_hi:[1,0]
v_cvt_pk_bf16_f32 v140, v104, v105
v_cvt_pk_bf16_f32 v141, v106, v107
v_pk_mul_f32 v[108:109], v[108:109], v[154:155] op_sel_hi:[1,0]
v_pk_mul_f32 v[110:111], v[110:111], v[154:155] op_sel_hi:[1,0]
v_cvt_pk_bf16_f32 v142, v108, v109
v_cvt_pk_bf16_f32 v143, v110, v111
v_pk_mul_f32 v[112:113], v[112:113], v[156:157] op_sel_hi:[1,0]
v_pk_mul_f32 v[114:115], v[114:115], v[156:157] op_sel_hi:[1,0]
v_cvt_pk_bf16_f32 v144, v112, v113
v_cvt_pk_bf16_f32 v145, v114, v115
v_pk_mul_f32 v[116:117], v[116:117], v[158:159] op_sel_hi:[1,0]
v_pk_mul_f32 v[118:119], v[118:119], v[158:159] op_sel_hi:[1,0]
v_cvt_pk_bf16_f32 v146, v116, v117
v_cvt_pk_bf16_f32 v147, v118, v119
s_add_u32 s49, s49, 20480
s_cmp_eq_u32 s50, 0
s_cbranch_scc0 L_o_1_odd
buffer_store_dwordx4 v[138:141], v4, s[24:27], s49 offen offset:0 sc1
buffer_store_dwordx4 v[142:145], v4, s[24:27], s49 offen offset:1024 sc1
buffer_store_dwordx2 v[146:147], v4, s[24:27], s49 offen offset:2048 sc1
s_branch L_o_1_std
L_o_1_odd:
buffer_store_dwordx2 v[138:139], v4, s[24:27], s49 offen offset:8 sc1
buffer_store_dwordx4 v[140:143], v4, s[24:27], s49 offen offset:1024 sc1
buffer_store_dwordx4 v[144:147], v4, s[24:27], s49 offen offset:2048 sc1
L_o_1_std:
s_add_u32 m0, s34, 0
s_add_u32 s36, s33, 0
buffer_load_dwordx4 v4, s[24:27], s36 offen offset:0  lds
buffer_load_dwordx4 v4, s[24:27], s36 offen offset:1024  lds
buffer_load_dwordx4 v4, s[24:27], s36 offen offset:2048  lds
buffer_load_dwordx4 v4, s[24:27], s36 offen offset:3072  lds
s_add_u32 m0, s34, 16384
s_add_u32 s36, s33, 16384
buffer_load_dwordx4 v4, s[24:27], s36 offen offset:0  lds
buffer_load_dwordx4 v4, s[24:27], s36 offen offset:1024  lds
buffer_load_dwordx4 v4, s[24:27], s36 offen offset:2048  lds
buffer_load_dwordx4 v4, s[24:27], s36 offen offset:3072  lds
s_waitcnt vmcnt(8) lgkmcnt(0)
s_barrier
s_cmp_eq_u32 s3, 0
s_cbranch_scc0 L_pub_p2o
v_mov_b32 v60, s90
v_mov_b32 v61, 0
s_mov_b64 s[94:95], exec
s_mov_b64 exec, 1
buffer_store_dword v60, v61, s[24:27], s51 offen sc1
s_mov_b64 exec, s[94:95]
L_pub_p2o:
s_add_u32 m0, s34, 32768
s_add_u32 s36, s33, 32768
buffer_load_dwordx4 v4, s[24:27], s36 offen offset:0  lds
buffer_load_dwordx4 v4, s[24:27], s36 offen offset:1024  lds
buffer_load_dwordx4 v4, s[24:27], s36 offen offset:2048  lds
buffer_load_dwordx4 v4, s[24:27], s36 offen offset:3072  lds
s_add_u32 m0, s34, 49152
s_add_u32 s36, s33, 49152
buffer_load_dwordx4 v4, s[24:27], s36 offen offset:0  lds
buffer_load_dwordx4 v4, s[24:27], s36 offen offset:1024  lds
buffer_load_dwordx4 v4, s[24:27], s36 offen offset:2048  lds
buffer_load_dwordx4 v4, s[24:27], s36 offen offset:3072  lds
s_add_u32 m0, s34, 65536
s_add_u32 s36, s33, 65536
buffer_load_dwordx4 v4, s[24:27], s36 offen offset:0  lds
buffer_load_dwordx4 v4, s[24:27], s36 offen offset:1024  lds
buffer_load_dwordx4 v4, s[24:27], s36 offen offset:2048  lds
buffer_load_dwordx4 v4, s[24:27], s36 offen offset:3072  lds
s_add_u32 m0, s34, 81920
s_add_u32 s36, s33, 81920
buffer_load_dwordx4 v4, s[24:27], s36 offen offset:0  lds
buffer_load_dwordx4 v4, s[24:27], s36 offen offset:1024  lds
buffer_load_dwordx4 v4, s[24:27], s36 offen offset:2048  lds
buffer_load_dwordx4 v4, s[24:27], s36 offen offset:3072  lds
L_k2_kernel_fin:
L_code_p3:
s_load_dwordx2 s[8:9], s[0:1], 72
v_lshrrev_b32 v8, 6, v0
v_and_b32 v1, 63, v0
v_readfirstlane_b32 s3, v8
v_lshrrev_b32 v2, 4, v1
v_and_b32 v3, 15, v1
v_lshlrev_b32 v4, 4, v1
v_mov_b32 v5, v4
v_add_u32 v6, 0x10000, v4
v_add_u32 v7, 0x20000, v4
s_and_b32 s10, s2, 7
s_lshr_b32 s11, s2, 3
s_getpc_b64 s[96:97]
L_pfr_L_code_p4_1:
s_add_u32 s96, s96, L_code_p4 - L_pfr_L_code_p4_1
s_addc_u32 s97, s97, 0
v_lshrrev_b32 v62, 6, v0
v_and_b32 v61, 1, v0
v_mad_u32_u24 v62, v62, 2, v61
s_lshr_b32 s95, s2, 3
s_mul_i32 s95, s95, 8
v_add_u32 v62, s95, v62
v_min_u32 v62, (L_code_end - L_code_p4) >> 7, v62
v_lshlrev_b32 v62, 7, v62
global_load_dword v55, v62, s[96:97]
s_and_b32 s14, s10, 1
s_lshl_b32 s14, s14, 3
s_lshr_b32 s15, s11, 2
s_add_u32 s12, s14, s15
s_and_b32 s13, s11, 3
s_lshl_b32 s14, s12, 3
s_lshl_b32 s15, s3, 1
s_add_u32 s48, s14, s15
s_mul_i32 s32, s48, 20480
s_cmp_lt_u32 s10, 6
s_cbranch_scc0 L_k3_wo
s_lshr_b32 s14, s10, 1
s_lshl_b32 s14, s14, 2
s_add_u32 s13, s13, s14
s_mul_i32 s33, s13, 184320
s_lshl_b32 s34, s3, 12
s_add_u32 s33, s33, s34
s_add_u32 s16, s6, 13172736
s_addc_u32 s17, s7, 0
s_mov_b32 s18, 2621440
s_mov_b32 s19, 0x20000
s_add_u32 s20, s6, 7905280
s_addc_u32 s21, s7, 0
s_mov_b32 s22, 20615168
s_mov_b32 s23, 0x20000
s_mov_b32 s24, s6
s_mov_b32 s25, s7
s_mov_b32 s26, 28520448
s_mov_b32 s27, 0x20000
s_lshl_b32 s14, s12, 7
s_add_u32 s14, s14, 28513280
s_cmp_eq_u32 s3, 0
s_cbranch_scc0 L_pd_p3w
v_and_b32 v60, 63, v0
v_min_u32 v60, 7, v60
v_add_u32 v60, 0, v60
v_lshlrev_b32 v60, 2, v60
s_mov_b32 s93, 0x40000
L_pl_p3w:
buffer_load_dword v56, v60, s[24:27], s14 offen sc1
s_waitcnt vmcnt(0)
v_cmp_eq_u32 vcc, s90, v56
s_sub_u32 s93, s93, 1
s_cmp_eq_u32 s93, 0
s_cbranch_scc1 L_pd_p3w
s_cmp_eq_u64 vcc, exec
s_cbranch_scc1 L_pd_p3w
s_sleep 2
s_branch L_pl_p3w
L_pd_p3w:
s_waitcnt vmcnt(0)
s_barrier
v_lshlrev_b32 v8, 2, v0
s_mul_i32 s14, s13, 576
s_add_u32 s14, s14, 13148160
v_mov_b32 v9, 0x80000000
v_cmp_gt_u32 vcc, 144, v0
v_lshlrev_b32 v10, 3, v3
v_lshl_add_u32 v10, v2, 11, v10
v_cndmask_b32 v9, v9, v8, vcc
s_add_u32 s37, s32, 0
buffer_load_dwordx4 a[0:3], v4, s[16:19], s37 offen sc1
s_add_u32 s37, s32, 20480
buffer_load_dwordx4 a[4:7], v4, s[16:19], s37 offen sc1
s_add_u32 s37, s32, 1024
buffer_load_dwordx4 a[8:11], v4, s[16:19], s37 offen sc1
s_add_u32 s37, s32, 21504
buffer_load_dwordx4 a[12:15], v4, s[16:19], s37 offen sc1
s_add_u32 s37, s32, 2048
buffer_load_dwordx4 a[16:19], v4, s[16:19], s37 offen sc1
s_add_u32 s37, s32, 22528
buffer_load_dwordx4 a[20:23], v4, s[16:19], s37 offen sc1
s_add_u32 m0, s34, 98304
s_add_u32 s36, s33, 98304
buffer_load_dwordx4 v4, s[20:23], s36 offen offset:0 sc1 lds
buffer_load_dwordx4 v4, s[20:23], s36 offen offset:1024 sc1 lds
buffer_load_dwordx4 v4, s[20:23], s36 offen offset:2048 sc1 lds
buffer_load_dwordx4 v4, s[20:23], s36 offen offset:3072 sc1 lds
s_add_u32 m0, s34, 114688
s_add_u32 s36, s33, 114688
buffer_load_dwordx4 v4, s[20:23], s36 offen offset:0 sc1 lds
buffer_load_dwordx4 v4, s[20:23], s36 offen offset:1024 sc1 lds
buffer_load_dwordx4 v4, s[20:23], s36 offen offset:2048 sc1 lds
buffer_load_dwordx4 v4, s[20:23], s36 offen offset:3072 sc1 lds
s_add_u32 m0, s34, 131072
s_add_u32 s36, s33, 131072
buffer_load_dwordx4 v4, s[20:23], s36 offen offset:0 sc1 lds
buffer_load_dwordx4 v4, s[20:23], s36 offen offset:1024 sc1 lds
buffer_load_dwordx4 v4, s[20:23], s36 offen offset:2048 sc1 lds
buffer_load_dwordx4 v4, s[20:23], s36 offen offset:3072 sc1 lds
ds_read_b128 a[160:163], v5 offset:0
ds_read_b128 a[164:167], v5 offset:1024
ds_read_b128 a[168:171], v5 offset:2048
ds_read_b128 a[172:175], v5 offset:3072
ds_read_b128 a[176:179], v5 offset:4096
ds_read_b128 a[180:183], v5 offset:5120
ds_read_b128 a[184:187], v5 offset:6144
ds_read_b128 a[188:191], v5 offset:7168
ds_read_b128 a[192:195], v5 offset:8192
s_waitcnt vmcnt(16) lgkmcnt(8)
v_mfma_f32_16x16x32_bf16 v[64:67], a[160:163], a[0:3], 0
s_add_u32 s37, s32, 3072
buffer_load_dwordx4 a[24:27], v4, s[16:19], s37 offen sc1
v_mfma_f32_16x16x32_bf16 v[100:103], a[160:163], a[4:7], 0
ds_read_b128 a[160:163], v5 offset:9216
s_add_u32 s37, s32, 23552
buffer_load_dwordx4 a[28:31], v4, s[16:19], s37 offen sc1
s_waitcnt lgkmcnt(8)
v_mfma_f32_16x16x32_bf16 v[68:71], a[164:167], a[0:3], 0
v_mfma_f32_16x16x32_bf16 v[104:107], a[164:167], a[4:7], 0
ds_read_b128 a[164:167], v5 offset:10240
s_waitcnt lgkmcnt(8)
v_mfma_f32_16x16x32_bf16 v[72:75], a[168:171], a[0:3], 0
v_mfma_f32_16x16x32_bf16 v[108:111], a[168:171], a[4:7], 0
ds_read_b128 a[168:171], v5 offset:11264
s_waitcnt lgkmcnt(8)
v_mfma_f32_16x16x32_bf16 v[76:79], a[172:175], a[0:3], 0
v_mfma_f32_16x16x32_bf16 v[112:115], a[172:175], a[4:7], 0
ds_read_b128 a[172:175], v5 offset:12288
s_waitcnt lgkmcnt(8)
v_mfma_f32_16x16x32_bf16 v[80:83], a[176:179], a[0:3], 0
v_mfma_f32_16x16x32_bf16 v[116:119], a[176:179], a[4:7], 0
ds_read_b128 a[176:179], v5 offset:13312
s_waitcnt lgkmcnt(8)
v_mfma_f32_16x16x32_bf16 v[84:87], a[180:183], a[0:3], 0
v_mfma_f32_16x16x32_bf16 v[120:123], a[180:183], a[4:7], 0
ds_read_b128 a[180:183], v5 offset:14336
s_waitcnt lgkmcnt(8)
v_mfma_f32_16x16x32_bf16 v[88:91], a[184:187], a[0:3], 0
v_mfma_f32_16x16x32_bf16 v[124:127], a[184:187], a[4:7], 0
ds_read_b128 a[184:187], v5 offset:15360
s_waitcnt lgkmcnt(8)
v_mfma_f32_16x16x32_bf16 v[92:95], a[188:191], a[0:3], 0
v_mfma_f32_16x16x32_bf16 v[128:131], a[188:191], a[4:7], 0
ds_read_b128 a[188:191], v5 offset:16384
s_waitcnt lgkmcnt(8)
v_mfma_f32_16x16x32_bf16 v[96:99], a[192:195], a[0:3], 0
v_mfma_f32_16x16x32_bf16 v[132:135], a[192:195], a[4:7], 0
ds_read_b128 a[192:195], v5 offset:17408
s_waitcnt vmcnt(16) lgkmcnt(8)
v_mfma_f32_16x16x32_bf16 v[64:67], a[160:163], a[8:11], v[64:67]
s_add_u32 s37, s32, 4096
buffer_load_dwordx4 a[32:35], v4, s[16:19], s37 offen sc1
v_mfma_f32_16x16x32_bf16 v[100:103], a[160:163], a[12:15], v[100:103]
ds_read_b128 a[160:163], v5 offset:18432
s_add_u32 s37, s32, 24576
buffer_load_dwordx4 a[36:39], v4, s[16:19], s37 offen sc1
s_waitcnt lgkmcnt(8)
v_mfma_f32_16x16x32_bf16 v[68:71], a[164:167], a[8:11], v[68:71]
v_mfma_f32_16x16x32_bf16 v[104:107], a[164:167], a[12:15], v[104:107]
ds_read_b128 a[164:167], v5 offset:19456
s_waitcnt lgkmcnt(8)
v_mfma_f32_16x16x32_bf16 v[72:75], a[168:171], a[8:11], v[72:75]
v_mfma_f32_16x16x32_bf16 v[108:111], a[168:171], a[12:15], v[108:111]
ds_read_b128 a[168:171], v5 offset:20480
s_waitcnt lgkmcnt(8)
v_mfma_f32_16x16x32_bf16 v[76:79], a[172:175], a[8:11], v[76:79]
v_mfma_f32_16x16x32_bf16 v[112:115], a[172:175], a[12:15], v[112:115]
ds_read_b128 a[172:175], v5 offset:21504
s_waitcnt lgkmcnt(8)
v_mfma_f32_16x16x32_bf16 v[80:83], a[176:179], a[8:11], v[80:83]
v_mfma_f32_16x16x32_bf16 v[116:119], a[176:179], a[12:15], v[116:119]
ds_read_b128 a[176:179], v5 offset:22528
s_waitcnt lgkmcnt(8)
v_mfma_f32_16x16x32_bf16 v[84:87], a[180:183], a[8:11], v[84:87]
v_mfma_f32_16x16x32_bf16 v[120:123], a[180:183], a[12:15], v[120:123]
ds_read_b128 a[180:183], v5 offset:23552
s_waitcnt lgkmcnt(8)
v_mfma_f32_16x16x32_bf16 v[88:91], a[184:187], a[8:11], v[88:91]
v_mfma_f32_16x16x32_bf16 v[124:127], a[184:187], a[12:15], v[124:127]
ds_read_b128 a[184:187], v5 offset:24576
s_waitcnt lgkmcnt(8)
v_mfma_f32_16x16x32_bf16 v[92:95], a[188:191], a[8:11], v[92:95]
v_mfma_f32_16x16x32_bf16 v[128:131], a[188:191], a[12:15], v[128:131]
ds_read_b128 a[188:191], v5 offset:25600
s_waitcnt lgkmcnt(8)
v_mfma_f32_16x16x32_bf16 v[96:99], a[192:195], a[8:11], v[96:99]
v_mfma_f32_16x16x32_bf16 v[132:135], a[192:195], a[12:15], v[132:135]
ds_read_b128 a[192:195], v5 offset:26624
s_barrier
s_waitcnt vmcnt(16) lgkmcnt(8)
v_mfma_f32_16x16x32_bf16 v[64:67], a[160:163], a[16:19], v[64:67]
s_add_u32 s37, s32, 5120
buffer_load_dwordx4 a[40:43], v4, s[16:19], s37 offen sc1
v_mfma_f32_16x16x32_bf16 v[100:103], a[160:163], a[20:23], v[100:103]
ds_read_b128 a[160:163], v5 offset:27648
s_add_u32 s37, s32, 25600
buffer_load_dwordx4 a[44:47], v4, s[16:19], s37 offen sc1
s_waitcnt lgkmcnt(8)
v_mfma_f32_16x16x32_bf16 v[68:71], a[164:167], a[16:19], v[68:71]
s_add_u32 m0, s34, 0
s_add_u32 s36, s33, 147456
v_mfma_f32_16x16x32_bf16 v[104:107], a[164:167], a[20:23], v[104:107]
ds_read_b128 a[164:167], v5 offset:28672
buffer_load_dwordx4 v4, s[20:23], s36 offen offset:0 sc1 lds
s_waitcnt lgkmcnt(8)
v_mfma_f32_16x16x32_bf16 v[72:75], a[168:171], a[16:19], v[72:75]
buffer_load_dwordx4 v4, s[20:23], s36 offen offset:1024 sc1 lds
v_mfma_f32_16x16x32_bf16 v[108:111], a[168:171], a[20:23], v[108:111]
ds_read_b128 a[168:171], v5 offset:29696
buffer_load_dwordx4 v4, s[20:23], s36 offen offset:2048 sc1 lds
s_waitcnt lgkmcnt(8)
v_mfma_f32_16x16x32_bf16 v[76:79], a[172:175], a[16:19], v[76:79]
buffer_load_dwordx4 v4, s[20:23], s36 offen offset:3072 sc1 lds
v_mfma_f32_16x16x32_bf16 v[112:115], a[172:175], a[20:23], v[112:115]
ds_read_b128 a[172:175], v5 offset:30720
s_waitcnt lgkmcnt(8)
v_mfma_f32_16x16x32_bf16 v[80:83], a[176:179], a[16:19], v[80:83]
v_mfma_f32_16x16x32_bf16 v[116:119], a[176:179], a[20:23], v[116:119]
ds_read_b128 a[176:179], v5 offset:31744
s_waitcnt lgkmcnt(8)
v_mfma_f32_16x16x32_bf16 v[84:87], a[180:183], a[16:19], v[84:87]
v_mfma_f32_16x16x32_bf16 v[120:123], a[180:183], a[20:23], v[120:123]
ds_read_b128 a[180:183], v5 offset:32768
s_waitcnt lgkmcnt(8)
v_mfma_f32_16x16x32_bf16 v[88:91], a[184:187], a[16:19], v[88:91]
v_mfma_f32_16x16x32_bf16 v[124:127], a[184:187], a[20:23], v[124:127]
ds_read_b128 a[184:187], v5 offset:33792
s_waitcnt lgkmcnt(8)
v_mfma_f32_16x16x32_bf16 v[92:95], a[188:191], a[16:19], v[92:95]
v_mfma_f32_16x16x32_bf16 v[128:131], a[188:191], a[20:23], v[128:131]
ds_read_b128 a[188:191], v5 offset:34816
s_waitcnt lgkmcnt(8)
v_mfma_f32_16x16x32_bf16 v[96:99], a[192:195], a[16:19], v[96:99]
v_mfma_f32_16x16x32_bf16 v[132:135], a[192:195], a[20:23], v[132:135]
ds_read_b128 a[192:195], v5 offset:35840
s_waitcnt vmcnt(8) lgkmcnt(8)
v_mfma_f32_16x16x32_bf16 v[64:67], a[160:163], a[24:27], v[64:67]
s_add_u32 s37, s32, 6144
buffer_load_dwordx4 a[48:51], v4, s[16:19], s37 offen sc1
v_mfma_f32_16x16x32_bf16 v[100:103], a[160:163], a[28:31], v[100:103]
ds_read_b128 a[160:163], v5 offset:36864
s_add_u32 s37, s32, 26624
buffer_load_dwordx4 a[52:55], v4, s[16:19], s37 offen sc1
s_waitcnt lgkmcnt(8)
v_mfma_f32_16x16x32_bf16 v[68:71], a[164:167], a[24:27], v[68:71]
v_mfma_f32_16x16x32_bf16 v[104:107], a[164:167], a[28:31], v[104:107]
ds_read_b128 a[164:167], v5 offset:37888
s_waitcnt lgkmcnt(8)
v_mfma_f32_16x16x32_bf16 v[72:75], a[168:171], a[24:27], v[72:75]
v_mfma_f32_16x16x32_bf16 v[108:111], a[168:171], a[28:31], v[108:111]
ds_read_b128 a[168:171], v5 offset:38912
s_waitcnt lgkmcnt(8)
v_mfma_f32_16x16x32_bf16 v[76:79], a[172:175], a[24:27], v[76:79]
v_mfma_f32_16x16x32_bf16 v[112:115], a[172:175], a[28:31], v[112:115]
ds_read_b128 a[172:175], v5 offset:39936
s_waitcnt lgkmcnt(8)
v_mfma_f32_16x16x32_bf16 v[80:83], a[176:179], a[24:27], v[80:83]
v_mfma_f32_16x16x32_bf16 v[116:119], a[176:179], a[28:31], v[116:119]
ds_read_b128 a[176:179], v5 offset:40960
s_waitcnt lgkmcnt(8)
v_mfma_f32_16x16x32_bf16 v[84:87], a[180:183], a[24:27], v[84:87]
v_mfma_f32_16x16x32_bf16 v[120:123], a[180:183], a[28:31], v[120:123]
ds_read_b128 a[180:183], v5 offset:41984
s_waitcnt lgkmcnt(8)
v_mfma_f32_16x16x32_bf16 v[88:91], a[184:187], a[24:27], v[88:91]
v_mfma_f32_16x16x32_bf16 v[124:127], a[184:187], a[28:31], v[124:127]
ds_read_b128 a[184:187], v5 offset:43008
s_waitcnt lgkmcnt(8)
v_mfma_f32_16x16x32_bf16 v[92:95], a[188:191], a[24:27], v[92:95]
v_mfma_f32_16x16x32_bf16 v[128:131], a[188:191], a[28:31], v[128:131]
ds_read_b128 a[188:191], v5 offset:44032
s_waitcnt lgkmcnt(8)
v_mfma_f32_16x16x32_bf16 v[96:99], a[192:195], a[24:27], v[96:99]
v_mfma_f32_16x16x32_bf16 v[132:135], a[192:195], a[28:31], v[132:135]
ds_read_b128 a[192:195], v5 offset:45056
s_barrier
s_waitcnt vmcnt(8) lgkmcnt(8)
v_mfma_f32_16x16x32_bf16 v[64:67], a[160:163], a[32:35], v[64:67]
s_add_u32 s37, s32, 7168
buffer_load_dwordx4 a[56:59], v4, s[16:19], s37 offen sc1
v_mfma_f32_16x16x32_bf16 v[100:103], a[160:163], a[36:39], v[100:103]
ds_read_b128 a[160:163], v5 offset:46080
s_add_u32 s37, s32, 27648
buffer_load_dwordx4 a[60:63], v4, s[16:19], s37 offen sc1
s_waitcnt lgkmcnt(8)
v_mfma_f32_16x16x32_bf16 v[68:71], a[164:167], a[32:35], v[68:71]
s_add_u32 m0, s34, 16384
s_add_u32 s36, s33, 163840
v_mfma_f32_16x16x32_bf16 v[104:107], a[164:167], a[36:39], v[104:107]
ds_read_b128 a[164:167], v5 offset:47104
buffer_load_dwordx4 v4, s[20:23], s36 offen offset:0 sc1 lds
s_waitcnt lgkmcnt(8)
v_mfma_f32_16x16x32_bf16 v[72:75], a[168:171], a[32:35], v[72:75]
buffer_load_dwordx4 v4, s[20:23], s36 offen offset:1024 sc1 lds
v_mfma_f32_16x16x32_bf16 v[108:111], a[168:171], a[36:39], v[108:111]
ds_read_b128 a[168:171], v5 offset:48128
buffer_load_dwordx4 v4, s[20:23], s36 offen offset:2048 sc1 lds
s_waitcnt lgkmcnt(8)
v_mfma_f32_16x16x32_bf16 v[76:79], a[172:175], a[32:35], v[76:79]
buffer_load_dwordx4 v4, s[20:23], s36 offen offset:3072 sc1 lds
v_mfma_f32_16x16x32_bf16 v[112:115], a[172:175], a[36:39], v[112:115]
ds_read_b128 a[172:175], v5 offset:49152
s_add_u32 s15, s14, 0
buffer_load_dword v32, v9, s[24:27], s15 offen sc1
s_add_u32 s15, s14, 6912
buffer_load_dword v33, v9, s[24:27], s15 offen sc1
s_add_u32 s15, s14, 13824
buffer_load_dword v34, v9, s[24:27], s15 offen sc1
s_lshl_b32 s15, s12, 13
s_lshl_b32 s38, s3, 8
s_add_u32 s15, s15, s38
s_add_u32 s15, s15, 15794176
buffer_load_dwordx2 v[36:37], v10, s[24:27], s15 offen offset:0 sc1
buffer_load_dwordx2 v[38:39], v10, s[24:27], s15 offen offset:1024 sc1
buffer_load_dwordx2 v[40:41], v10, s[24:27], s15 offen offset:128 sc1
buffer_load_dwordx2 v[42:43], v10, s[24:27], s15 offen offset:1152 sc1
s_waitcnt lgkmcnt(8)
v_mfma_f32_16x16x32_bf16 v[80:83], a[176:179], a[32:35], v[80:83]
v_mfma_f32_16x16x32_bf16 v[116:119], a[176:179], a[36:39], v[116:119]
ds_read_b128 a[176:179], v5 offset:50176
s_waitcnt lgkmcnt(8)
v_mfma_f32_16x16x32_bf16 v[84:87], a[180:183], a[32:35], v[84:87]
v_mfma_f32_16x16x32_bf16 v[120:123], a[180:183], a[36:39], v[120:123]
ds_read_b128 a[180:183], v5 offset:51200
s_waitcnt lgkmcnt(8)
v_mfma_f32_16x16x32_bf16 v[88:91], a[184:187], a[32:35], v[88:91]
v_mfma_f32_16x16x32_bf16 v[124:127], a[184:187], a[36:39], v[124:127]
ds_read_b128 a[184:187], v5 offset:52224
s_waitcnt lgkmcnt(8)
v_mfma_f32_16x16x32_bf16 v[92:95], a[188:191], a[32:35], v[92:95]
v_mfma_f32_16x16x32_bf16 v[128:131], a[188:191], a[36:39], v[128:131]
ds_read_b128 a[188:191], v5 offset:53248
s_waitcnt lgkmcnt(8)
v_mfma_f32_16x16x32_bf16 v[96:99], a[192:195], a[32:35], v[96:99]
v_mfma_f32_16x16x32_bf16 v[132:135], a[192:195], a[36:39], v[132:135]
ds_read_b128 a[192:195], v5 offset:54272
s_waitcnt vmcnt(19) lgkmcnt(8)
v_mfma_f32_16x16x32_bf16 v[64:67], a[160:163], a[40:43], v[64:67]
s_add_u32 s37, s32, 8192
buffer_load_dwordx4 a[64:67], v4, s[16:19], s37 offen sc1
v_mfma_f32_16x16x32_bf16 v[100:103], a[160:163], a[44:47], v[100:103]
ds_read_b128 a[160:163], v5 offset:55296
s_add_u32 s37, s32, 28672
buffer_load_dwordx4 a[68:71], v4, s[16:19], s37 offen sc1
s_waitcnt lgkmcnt(8)
v_mfma_f32_16x16x32_bf16 v[68:71], a[164:167], a[40:43], v[68:71]
v_mfma_f32_16x16x32_bf16 v[104:107], a[164:167], a[44:47], v[104:107]
ds_read_b128 a[164:167], v5 offset:56320
s_waitcnt lgkmcnt(8)
v_mfma_f32_16x16x32_bf16 v[72:75], a[168:171], a[40:43], v[72:75]
v_mfma_f32_16x16x32_bf16 v[108:111], a[168:171], a[44:47], v[108:111]
ds_read_b128 a[168:171], v5 offset:57344
s_waitcnt lgkmcnt(8)
v_mfma_f32_16x16x32_bf16 v[76:79], a[172:175], a[40:43], v[76:79]
v_mfma_f32_16x16x32_bf16 v[112:115], a[172:175], a[44:47], v[112:115]
ds_read_b128 a[172:175], v5 offset:58368
s_waitcnt lgkmcnt(8)
v_mfma_f32_16x16x32_bf16 v[80:83], a[176:179], a[40:43], v[80:83]
v_mfma_f32_16x16x32_bf16 v[116:119], a[176:179], a[44:47], v[116:119]
ds_read_b128 a[176:179], v5 offset:59392
s_waitcnt lgkmcnt(8)
v_mfma_f32_16x16x32_bf16 v[84:87], a[180:183], a[40:43], v[84:87]
v_mfma_f32_16x16x32_bf16 v[120:123], a[180:183], a[44:47], v[120:123]
ds_read_b128 a[180:183], v5 offset:60416
s_waitcnt lgkmcnt(8)
v_mfma_f32_16x16x32_bf16 v[88:91], a[184:187], a[40:43], v[88:91]
v_mfma_f32_16x16x32_bf16 v[124:127], a[184:187], a[44:47], v[124:127]
ds_read_b128 a[184:187], v5 offset:61440
s_waitcnt lgkmcnt(8)
v_mfma_f32_16x16x32_bf16 v[92:95], a[188:191], a[40:43], v[92:95]
v_mfma_f32_16x16x32_bf16 v[128:131], a[188:191], a[44:47], v[128:131]
ds_read_b128 a[188:191], v5 offset:62464
s_waitcnt lgkmcnt(8)
v_mfma_f32_16x16x32_bf16 v[96:99], a[192:195], a[40:43], v[96:99]
v_mfma_f32_16x16x32_bf16 v[132:135], a[192:195], a[44:47], v[132:135]
ds_read_b128 a[192:195], v5 offset:63488
s_barrier
s_waitcnt vmcnt(15) lgkmcnt(8)
v_mfma_f32_16x16x32_bf16 v[64:67], a[160:163], a[48:51], v[64:67]
s_add_u32 s37, s32, 9216
buffer_load_dwordx4 a[72:75], v4, s[16:19], s37 offen sc1
v_mfma_f32_16x16x32_bf16 v[100:103], a[160:163], a[52:55], v[100:103]
ds_read_b128 a[160:163], v5 offset:64512
s_add_u32 s37, s32, 29696
buffer_load_dwordx4 a[76:79], v4, s[16:19], s37 offen sc1
s_waitcnt lgkmcnt(8)
v_mfma_f32_16x16x32_bf16 v[68:71], a[164:167], a[48:51], v[68:71]
s_add_u32 m0, s34, 32768
s_add_u32 s36, s33, 180224
v_mfma_f32_16x16x32_bf16 v[104:107], a[164:167], a[52:55], v[104:107]
ds_read_b128 a[164:167], v6 offset:0
buffer_load_dwordx4 v4, s[20:23], s36 offen offset:0 sc1 lds
s_waitcnt lgkmcnt(8)
v_mfma_f32_16x16x32_bf16 v[72:75], a[168:171], a[48:51], v[72:75]
buffer_load_dwordx4 v4, s[20:23], s36 offen offset:1024 sc1 lds
v_mfma_f32_16x16x32_bf16 v[108:111], a[168:171], a[52:55], v[108:111]
ds_read_b128 a[168:171], v6 offset:1024
buffer_load_dwordx4 v4, s[20:23], s36 offen offset:2048 sc1 lds
s_waitcnt lgkmcnt(8)
v_mfma_f32_16x16x32_bf16 v[76:79], a[172:175], a[48:51], v[76:79]
buffer_load_dwordx4 v4, s[20:23], s36 offen offset:3072 sc1 lds
v_mfma_f32_16x16x32_bf16 v[112:115], a[172:175], a[52:55], v[112:115]
ds_read_b128 a[172:175], v6 offset:2048
s_waitcnt lgkmcnt(8)
v_mfma_f32_16x16x32_bf16 v[80:83], a[176:179], a[48:51], v[80:83]
v_mfma_f32_16x16x32_bf16 v[116:119], a[176:179], a[52:55], v[116:119]
ds_read_b128 a[176:179], v6 offset:3072
s_waitcnt lgkmcnt(8)
v_mfma_f32_16x16x32_bf16 v[84:87], a[180:183], a[48:51], v[84:87]
v_mfma_f32_16x16x32_bf16 v[120:123], a[180:183], a[52:55], v[120:123]
ds_read_b128 a[180:183], v6 offset:4096
s_waitcnt lgkmcnt(8)
v_mfma_f32_16x16x32_bf16 v[88:91], a[184:187], a[48:51], v[88:91]
v_mfma_f32_16x16x32_bf16 v[124:127], a[184:187], a[52:55], v[124:127]
ds_read_b128 a[184:187], v6 offset:5120
s_waitcnt lgkmcnt(8)
v_mfma_f32_16x16x32_bf16 v[92:95], a[188:191], a[48:51], v[92:95]
v_mfma_f32_16x16x32_bf16 v[128:131], a[188:191], a[52:55], v[128:131]
ds_read_b128 a[188:191], v6 offset:6144
s_waitcnt lgkmcnt(8)
v_mfma_f32_16x16x32_bf16 v[96:99], a[192:195], a[48:51], v[96:99]
v_mfma_f32_16x16x32_bf16 v[132:135], a[192:195], a[52:55], v[132:135]
ds_read_b128 a[192:195], v6 offset:7168
s_waitcnt vmcnt(19) lgkmcnt(8)
v_mfma_f32_16x16x32_bf16 v[64:67], a[160:163], a[56:59], v[64:67]
s_add_u32 s37, s32, 10240
buffer_load_dwordx4 a[80:83], v4, s[16:19], s37 offen sc1
v_mfma_f32_16x16x32_bf16 v[100:103], a[160:163], a[60:63], v[100:103]
ds_read_b128 a[160:163], v6 offset:8192
s_add_u32 s37, s32, 30720
buffer_load_dwordx4 a[84:87], v4, s[16:19], s37 offen sc1
s_waitcnt lgkmcnt(8)
v_mfma_f32_16x16x32_bf16 v[68:71], a[164:167], a[56:59], v[68:71]
v_mfma_f32_16x16x32_bf16 v[104:107], a[164:167], a[60:63], v[104:107]
ds_read_b128 a[164:167], v6 offset:9216
s_waitcnt lgkmcnt(8)
v_mfma_f32_16x16x32_bf16 v[72:75], a[168:171], a[56:59], v[72:75]
v_mfma_f32_16x16x32_bf16 v[108:111], a[168:171], a[60:63], v[108:111]
ds_read_b128 a[168:171], v6 offset:10240
s_waitcnt lgkmcnt(8)
v_mfma_f32_16x16x32_bf16 v[76:79], a[172:175], a[56:59], v[76:79]
v_mfma_f32_16x16x32_bf16 v[112:115], a[172:175], a[60:63], v[112:115]
ds_read_b128 a[172:175], v6 offset:11264
s_waitcnt lgkmcnt(8)
v_mfma_f32_16x16x32_bf16 v[80:83], a[176:179], a[56:59], v[80:83]
v_mfma_f32_16x16x32_bf16 v[116:119], a[176:179], a[60:63], v[116:119]
ds_read_b128 a[176:179], v6 offset:12288
s_waitcnt lgkmcnt(8)
v_mfma_f32_16x16x32_bf16 v[84:87], a[180:183], a[56:59], v[84:87]
v_mfma_f32_16x16x32_bf16 v[120:123], a[180:183], a[60:63], v[120:123]
ds_read_b128 a[180:183], v6 offset:13312
s_waitcnt lgkmcnt(8)
v_mfma_f32_16x16x32_bf16 v[88:91], a[184:187], a[56:59], v[88:91]
v_mfma_f32_16x16x32_bf16 v[124:127], a[184:187], a[60:63], v[124:127]
ds_read_b128 a[184:187], v6 offset:14336
s_waitcnt lgkmcnt(8)
v_mfma_f32_16x16x32_bf16 v[92:95], a[188:191], a[56:59], v[92:95]
v_mfma_f32_16x16x32_bf16 v[128:131], a[188:191], a[60:63], v[128:131]
ds_read_b128 a[188:191], v6 offset:15360
s_waitcnt lgkmcnt(8)
v_mfma_f32_16x16x32_bf16 v[96:99], a[192:195], a[56:59], v[96:99]
v_mfma_f32_16x16x32_bf16 v[132:135], a[192:195], a[60:63], v[132:135]
ds_read_b128 a[192:195], v6 offset:16384
s_waitcnt vmcnt(8) lgkmcnt(8)
v_mfma_f32_16x16x32_bf16 v[64:67], a[160:163], a[64:67], v[64:67]
s_add_u32 s37, s32, 11264
buffer_load_dwordx4 a[88:91], v4, s[16:19], s37 offen sc1
v_mfma_f32_16x16x32_bf16 v[100:103], a[160:163], a[68:71], v[100:103]
ds_read_b128 a[160:163], v6 offset:17408
s_add_u32 s37, s32, 31744
buffer_load_dwordx4 a[92:95], v4, s[16:19], s37 offen sc1
s_waitcnt lgkmcnt(8)
v_mfma_f32_16x16x32_bf16 v[68:71], a[164:167], a[64:67], v[68:71]
v_mfma_f32_16x16x32_bf16 v[104:107], a[164:167], a[68:71], v[104:107]
ds_read_b128 a[164:167], v6 offset:18432
s_waitcnt lgkmcnt(8)
v_mfma_f32_16x16x32_bf16 v[72:75], a[168:171], a[64:67], v[72:75]
v_mfma_f32_16x16x32_bf16 v[108:111], a[168:171], a[68:71], v[108:111]
ds_read_b128 a[168:171], v6 offset:19456
s_waitcnt lgkmcnt(8)
v_mfma_f32_16x16x32_bf16 v[76:79], a[172:175], a[64:67], v[76:79]
v_mfma_f32_16x16x32_bf16 v[112:115], a[172:175], a[68:71], v[112:115]
ds_read_b128 a[172:175], v6 offset:20480
s_waitcnt lgkmcnt(8)
v_mfma_f32_16x16x32_bf16 v[80:83], a[176:179], a[64:67], v[80:83]
v_mfma_f32_16x16x32_bf16 v[116:119], a[176:179], a[68:71], v[116:119]
ds_read_b128 a[176:179], v6 offset:21504
s_waitcnt lgkmcnt(8)
v_mfma_f32_16x16x32_bf16 v[84:87], a[180:183], a[64:67], v[84:87]
v_mfma_f32_16x16x32_bf16 v[120:123], a[180:183], a[68:71], v[120:123]
ds_read_b128 a[180:183], v6 offset:22528
s_waitcnt lgkmcnt(8)
v_mfma_f32_16x16x32_bf16 v[88:91], a[184:187], a[64:67], v[88:91]
v_mfma_f32_16x16x32_bf16 v[124:127], a[184:187], a[68:71], v[124:127]
ds_read_b128 a[184:187], v6 offset:23552
s_waitcnt lgkmcnt(8)
v_mfma_f32_16x16x32_bf16 v[92:95], a[188:191], a[64:67], v[92:95]
v_mfma_f32_16x16x32_bf16 v[128:131], a[188:191], a[68:71], v[128:131]
ds_read_b128 a[188:191], v6 offset:24576
s_waitcnt lgkmcnt(8)
v_mfma_f32_16x16x32_bf16 v[96:99], a[192:195], a[64:67], v[96:99]
v_mfma_f32_16x16x32_bf16 v[132:135], a[192:195], a[68:71], v[132:135]
ds_read_b128 a[192:195], v6 offset:25600
s_waitcnt vmcnt(8) lgkmcnt(8)
v_mfma_f32_16x16x32_bf16 v[64:67], a[160:163], a[72:75], v[64:67]
s_add_u32 s37, s32, 12288
buffer_load_dwordx4 a[96:99], v4, s[16:19], s37 offen sc1
v_mfma_f32_16x16x32_bf16 v[100:103], a[160:163], a[76:79], v[100:103]
ds_read_b128 a[160:163], v6 offset:26624
s_add_u32 s37, s32, 32768
buffer_load_dwordx4 a[100:103], v4, s[16:19], s37 offen sc1
s_waitcnt lgkmcnt(8)
v_mfma_f32_16x16x32_bf16 v[68:71], a[164:167], a[72:75], v[68:71]
v_add_f32 v32, v32, v33
v_add_f32 v32, v32, v34
v_add_u32 v11, 147456, v8
v_cmp_gt_u32 vcc, 144, v0
s_and_saveexec_b64 s[40:41], vcc
ds_write_b32 v11, v32
s_mov_b64 exec, s[40:41]
v_mfma_f32_16x16x32_bf16 v[104:107], a[164:167], a[76:79], v[104:107]
ds_read_b128 a[164:167], v6 offset:27648
s_waitcnt lgkmcnt(9)
v_mfma_f32_16x16x32_bf16 v[72:75], a[168:171], a[72:75], v[72:75]
v_mfma_f32_16x16x32_bf16 v[108:111], a[168:171], a[76:79], v[108:111]
ds_read_b128 a[168:171], v6 offset:28672
s_waitcnt lgkmcnt(9)
v_mfma_f32_16x16x32_bf16 v[76:79], a[172:175], a[72:75], v[76:79]
v_mfma_f32_16x16x32_bf16 v[112:115], a[172:175], a[76:79], v[112:115]
ds_read_b128 a[172:175], v6 offset:29696
s_waitcnt lgkmcnt(9)
v_mfma_f32_16x16x32_bf16 v[80:83], a[176:179], a[72:75], v[80:83]
v_mfma_f32_16x16x32_bf16 v[116:119], a[176:179], a[76:79], v[116:119]
ds_read_b128 a[176:179], v6 offset:30720
s_waitcnt lgkmcnt(9)
v_mfma_f32_16x16x32_bf16 v[84:87], a[180:183], a[72:75], v[84:87]
v_mfma_f32_16x16x32_bf16 v[120:123], a[180:183], a[76:79], v[120:123]
ds_read_b128 a[180:183], v6 offset:31744
s_waitcnt lgkmcnt(9)
v_mfma_f32_16x16x32_bf16 v[88:91], a[184:187], a[72:75], v[88:91]
v_mfma_f32_16x16x32_bf16 v[124:127], a[184:187], a[76:79], v[124:127]
s_barrier
ds_read_b128 a[184:187], v6 offset:32768
s_waitcnt lgkmcnt(9)
v_mfma_f32_16x16x32_bf16 v[92:95], a[188:191], a[72:75], v[92:95]
v_mfma_f32_16x16x32_bf16 v[128:131], a[188:191], a[76:79], v[128:131]
ds_read_b128 a[188:191], v6 offset:33792
s_waitcnt lgkmcnt(9)
v_mfma_f32_16x16x32_bf16 v[96:99], a[192:195], a[72:75], v[96:99]
v_mfma_f32_16x16x32_bf16 v[132:135], a[192:195], a[76:79], v[132:135]
ds_read_b128 a[192:195], v6 offset:34816
s_waitcnt vmcnt(4) lgkmcnt(9)
v_mfma_f32_16x16x32_bf16 v[64:67], a[160:163], a[80:83], v[64:67]
s_add_u32 s37, s32, 13312
buffer_load_dwordx4 a[104:107], v4, s[16:19], s37 offen sc1
v_mfma_f32_16x16x32_bf16 v[100:103], a[160:163], a[84:87], v[100:103]
ds_read_b128 a[160:163], v6 offset:35840
s_add_u32 s37, s32, 33792
buffer_load_dwordx4 a[108:111], v4, s[16:19], s37 offen sc1
s_waitcnt lgkmcnt(8)
v_mfma_f32_16x16x32_bf16 v[68:71], a[164:167], a[80:83], v[68:71]
v_mfma_f32_16x16x32_bf16 v[104:107], a[164:167], a[84:87], v[104:107]
ds_read_b128 a[164:167], v6 offset:36864
s_waitcnt lgkmcnt(8)
v_mfma_f32_16x16x32_bf16 v[72:75], a[168:171], a[80:83], v[72:75]
v_mfma_f32_16x16x32_bf16 v[108:111], a[168:171], a[84:87], v[108:111]
ds_read_b128 a[168:171], v6 offset:37888
s_waitcnt lgkmcnt(8)
v_mfma_f32_16x16x32_bf16 v[76:79], a[172:175], a[80:83], v[76:79]
v_mfma_f32_16x16x32_bf16 v[112:115], a[172:175], a[84:87], v[112:115]
ds_read_b128 a[172:175], v6 offset:38912
s_waitcnt lgkmcnt(8)
v_mfma_f32_16x16x32_bf16 v[80:83], a[176:179], a[80:83], v[80:83]
v_mfma_f32_16x16x32_bf16 v[116:119], a[176:179], a[84:87], v[116:119]
ds_read_b128 a[176:179], v6 offset:39936
s_waitcnt lgkmcnt(8)
v_mfma_f32_16x16x32_bf16 v[84:87], a[180:183], a[80:83], v[84:87]
v_mfma_f32_16x16x32_bf16 v[120:123], a[180:183], a[84:87], v[120:123]
ds_read_b128 a[180:183], v6 offset:40960
s_waitcnt lgkmcnt(8)
v_mfma_f32_16x16x32_bf16 v[88:91], a[184:187], a[80:83], v[88:91]
v_mfma_f32_16x16x32_bf16 v[124:127], a[184:187], a[84:87], v[124:127]
ds_read_b128 a[184:187], v6 offset:41984
s_waitcnt lgkmcnt(8)
v_mfma_f32_16x16x32_bf16 v[92:95], a[188:191], a[80:83], v[92:95]
v_mfma_f32_16x16x32_bf16 v[128:131], a[188:191], a[84:87], v[128:131]
ds_read_b128 a[188:191], v6 offset:43008
s_waitcnt lgkmcnt(8)
v_mfma_f32_16x16x32_bf16 v[96:99], a[192:195], a[80:83], v[96:99]
v_mfma_f32_16x16x32_bf16 v[132:135], a[192:195], a[84:87], v[132:135]
ds_read_b128 a[192:195], v6 offset:44032
s_waitcnt vmcnt(4) lgkmcnt(8)
v_mfma_f32_16x16x32_bf16 v[64:67], a[160:163], a[88:91], v[64:67]
s_add_u32 s37, s32, 14336
buffer_load_dwordx4 a[112:115], v4, s[16:19], s37 offen sc1
v_mfma_f32_16x16x32_bf16 v[100:103], a[160:163], a[92:95], v[100:103]
ds_read_b128 a[160:163], v6 offset:45056
s_add_u32 s37, s32, 34816
buffer_load_dwordx4 a[116:119], v4, s[16:19], s37 offen sc1
s_waitcnt lgkmcnt(8)
v_mfma_f32_16x16x32_bf16 v[68:71], a[164:167], a[88:91], v[68:71]
v_add_f32 v36, v36, v38
v_mfma_f32_16x16x32_bf16 v[104:107], a[164:167], a[92:95], v[104:107]
ds_read_b128 a[164:167], v6 offset:46080
v_add_f32 v37, v37, v39
s_waitcnt lgkmcnt(8)
v_mfma_f32_16x16x32_bf16 v[72:75], a[168:171], a[88:91], v[72:75]
v_mov_b32 v38, v36
v_mfma_f32_16x16x32_bf16 v[108:111], a[168:171], a[92:95], v[108:111]
ds_read_b128 a[168:171], v6 offset:47104
v_mov_b32 v39, v37
s_nop 1
v_permlane32_swap_b32 v36, v38
s_waitcnt lgkmcnt(8)
v_mfma_f32_16x16x32_bf16 v[76:79], a[172:175], a[88:91], v[76:79]
v_permlane32_swap_b32 v37, v39
s_nop 1
v_add_f32 v36, v36, v38
v_mfma_f32_16x16x32_bf16 v[112:115], a[172:175], a[92:95], v[112:115]
ds_read_b128 a[172:175], v6 offset:48128
v_add_f32 v37, v37, v39
s_waitcnt lgkmcnt(8)
v_mfma_f32_16x16x32_bf16 v[80:83], a[176:179], a[88:91], v[80:83]
v_mov_b32 v38, v36
v_mfma_f32_16x16x32_bf16 v[116:119], a[176:179], a[92:95], v[116:119]
s_barrier
ds_read_b128 a[176:179], v6 offset:49152
v_mov_b32 v39, v37
s_nop 1
v_permlane16_swap_b32 v36, v38
s_waitcnt lgkmcnt(8)
v_mfma_f32_16x16x32_bf16 v[84:87], a[180:183], a[88:91], v[84:87]
v_permlane16_swap_b32 v37, v39
s_nop 1
v_add_f32 v36, v36, v38
v_mfma_f32_16x16x32_bf16 v[120:123], a[180:183], a[92:95], v[120:123]
ds_read_b128 a[180:183], v6 offset:50176
v_add_f32 v37, v37, v39
s_waitcnt lgkmcnt(8)
v_mfma_f32_16x16x32_bf16 v[88:91], a[184:187], a[88:91], v[88:91]
v_mul_f32 v176, 0xbacccccd, v36
v_mfma_f32_16x16x32_bf16 v[124:127], a[184:187], a[92:95], v[124:127]
ds_read_b128 a[184:187], v6 offset:51200
v_mul_f32 v37, 0x3acccccd, v37
s_waitcnt lgkmcnt(8)
v_mfma_f32_16x16x32_bf16 v[92:95], a[188:191], a[88:91], v[92:95]
v_fma_f32 v37, -v176, v176, v37
v_mfma_f32_16x16x32_bf16 v[128:131], a[188:191], a[92:95], v[128:131]
ds_read_b128 a[188:191], v6 offset:52224
s_waitcnt lgkmcnt(8)
v_mfma_f32_16x16x32_bf16 v[96:99], a[192:195], a[88:91], v[96:99]
v_mfma_f32_16x16x32_bf16 v[132:135], a[192:195], a[92:95], v[132:135]
ds_read_b128 a[192:195], v6 offset:53248
s_waitcnt vmcnt(4) lgkmcnt(8)
v_mfma_f32_16x16x32_bf16 v[64:67], a[160:163], a[96:99], v[64:67]
s_add_u32 s37, s32, 15360
buffer_load_dwordx4 a[120:123], v4, s[16:19], s37 offen sc1
v_mfma_f32_16x16x32_bf16 v[100:103], a[160:163], a[100:103], v[100:103]
ds_read_b128 a[160:163], v6 offset:54272
s_add_u32 s37, s32, 35840
buffer_load_dwordx4 a[124:127], v4, s[16:19], s37 offen sc1
s_waitcnt lgkmcnt(8)
v_mfma_f32_16x16x32_bf16 v[68:71], a[164:167], a[96:99], v[68:71]
v_max_f32 v37, 0, v37
v_mfma_f32_16x16x32_bf16 v[104:107], a[164:167], a[100:103], v[104:107]
ds_read_b128 a[164:167], v6 offset:55296
v_add_f32 v37, 0x3727c5ac, v37
s_waitcnt lgkmcnt(8)
v_mfma_f32_16x16x32_bf16 v[72:75], a[168:171], a[96:99], v[72:75]
v_rsq_f32 v178, v37
v_mov_b32 v177, v176
v_mov_b32 v179, v178
v_mfma_f32_16x16x32_bf16 v[108:111], a[168:171], a[100:103], v[108:111]
ds_read_b128 a[168:171], v6 offset:56320
v_add_f32 v40, v40, v42
s_waitcnt lgkmcnt(8)
v_mfma_f32_16x16x32_bf16 v[76:79], a[172:175], a[96:99], v[76:79]
v_add_f32 v41, v41, v43
v_mfma_f32_16x16x32_bf16 v[112:115], a[172:175], a[100:103], v[112:115]
ds_read_b128 a[172:175], v6 offset:57344
v_mov_b32 v42, v40
s_waitcnt lgkmcnt(8)
v_mfma_f32_16x16x32_bf16 v[80:83], a[176:179], a[96:99], v[80:83]
v_mov_b32 v43, v41
s_nop 1
v_permlane32_swap_b32 v40, v42
v_mfma_f32_16x16x32_bf16 v[116:119], a[176:179], a[100:103], v[116:119]
ds_read_b128 a[176:179], v6 offset:58368
v_permlane32_swap_b32 v41, v43
s_nop 1
v_add_f32 v40, v40, v42
s_waitcnt lgkmcnt(8)
v_mfma_f32_16x16x32_bf16 v[84:87], a[180:183], a[96:99], v[84:87]
v_add_f32 v41, v41, v43
v_mfma_f32_16x16x32_bf16 v[120:123], a[180:183], a[100:103], v[120:123]
ds_read_b128 a[180:183], v6 offset:59392
v_mov_b32 v42, v40
s_waitcnt lgkmcnt(8)
v_mfma_f32_16x16x32_bf16 v[88:91], a[184:187], a[96:99], v[88:91]
v_mov_b32 v43, v41
s_nop 1
v_permlane16_swap_b32 v40, v42
v_mfma_f32_16x16x32_bf16 v[124:127], a[184:187], a[100:103], v[124:127]
ds_read_b128 a[184:187], v6 offset:60416
v_permlane16_swap_b32 v41, v43
s_nop 1
v_add_f32 v40, v40, v42
s_waitcnt lgkmcnt(8)
v_mfma_f32_16x16x32_bf16 v[92:95], a[188:191], a[96:99], v[92:95]
v_add_f32 v41, v41, v43
v_mfma_f32_16x16x32_bf16 v[128:131], a[188:191], a[100:103], v[128:131]
ds_read_b128 a[188:191], v6 offset:61440
s_waitcnt lgkmcnt(8)
v_mfma_f32_16x16x32_bf16 v[96:99], a[192:195], a[96:99], v[96:99]
v_mfma_f32_16x16x32_bf16 v[132:135], a[192:195], a[100:103], v[132:135]
ds_read_b128 a[192:195], v6 offset:62464
s_waitcnt vmcnt(4) lgkmcnt(8)
v_mfma_f32_16x16x32_bf16 v[64:67], a[160:163], a[104:107], v[64:67]
s_add_u32 s37, s32, 16384
buffer_load_dwordx4 a[128:131], v4, s[16:19], s37 offen sc1
v_mfma_f32_16x16x32_bf16 v[100:103], a[160:163], a[108:111], v[100:103]
ds_read_b128 a[160:163], v6 offset:63488
s_add_u32 s37, s32, 36864
buffer_load_dwordx4 a[132:135], v4, s[16:19], s37 offen sc1
s_waitcnt lgkmcnt(8)
v_mfma_f32_16x16x32_bf16 v[68:71], a[164:167], a[104:107], v[68:71]
v_mul_f32 v180, 0xbacccccd, v40
v_mfma_f32_16x16x32_bf16 v[104:107], a[164:167], a[108:111], v[104:107]
ds_read_b128 a[164:167], v6 offset:64512
v_mul_f32 v41, 0x3acccccd, v41
s_waitcnt lgkmcnt(8)
v_mfma_f32_16x16x32_bf16 v[72:75], a[168:171], a[104:107], v[72:75]
v_fma_f32 v41, -v180, v180, v41
v_mfma_f32_16x16x32_bf16 v[108:111], a[168:171], a[108:111], v[108:111]
s_barrier
ds_read_b128 a[168:171], v7 offset:0
v_max_f32 v41, 0, v41
s_waitcnt lgkmcnt(8)
v_mfma_f32_16x16x32_bf16 v[76:79], a[172:175], a[104:107], v[76:79]
v_add_f32 v41, 0x3727c5ac, v41
v_mfma_f32_16x16x32_bf16 v[112:115], a[172:175], a[108:111], v[112:115]
ds_read_b128 a[172:175], v7 offset:1024
v_rsq_f32 v182, v41
v_mov_b32 v181, v180
v_mov_b32 v183, v182
s_waitcnt lgkmcnt(8)
v_mfma_f32_16x16x32_bf16 v[80:83], a[176:179], a[104:107], v[80:83]
v_mov_b32 v184, 0xc0135761
v_mfma_f32_16x16x32_bf16 v[116:119], a[176:179], a[108:111], v[116:119]
ds_read_b128 a[176:179], v7 offset:2048
v_mov_b32 v185, 0xc0135761
s_waitcnt lgkmcnt(8)
v_mfma_f32_16x16x32_bf16 v[84:87], a[180:183], a[104:107], v[84:87]
v_mov_b32 v186, 0xbdd2d3e8
v_mfma_f32_16x16x32_bf16 v[120:123], a[180:183], a[108:111], v[120:123]
ds_read_b128 a[180:183], v7 offset:3072
v_mov_b32 v187, 0xbdd2d3e8
s_waitcnt lgkmcnt(8)
v_mfma_f32_16x16x32_bf16 v[88:91], a[184:187], a[104:107], v[88:91]
s_mul_i32 s14, s13, 9
s_and_b32 s50, s14, 1
s_lshr_b32 s14, s14, 1
v_mfma_f32_16x16x32_bf16 v[124:127], a[184:187], a[108:111], v[124:127]
ds_read_b128 a[184:187], v7 offset:4096
s_lshr_b32 s15, s48, 2
s_mul_i32 s15, s15, 54
s_add_u32 s14, s14, s15
s_waitcnt lgkmcnt(8)
v_mfma_f32_16x16x32_bf16 v[92:95], a[188:191], a[104:107], v[92:95]
s_lshl_b32 s14, s14, 2
s_and_b32 s15, s48, 3
s_add_u32 s14, s14, s15
v_mfma_f32_16x16x32_bf16 v[128:131], a[188:191], a[108:111], v[128:131]
ds_read_b128 a[188:191], v7 offset:5120
s_lshl_b32 s14, s14, 10
s_add_u32 s49, s14, 18546688
s_waitcnt lgkmcnt(8)
v_mfma_f32_16x16x32_bf16 v[96:99], a[192:195], a[104:107], v[96:99]
v_mfma_f32_16x16x32_bf16 v[132:135], a[192:195], a[108:111], v[132:135]
ds_read_b128 a[192:195], v7 offset:6144
s_waitcnt vmcnt(4) lgkmcnt(8)
v_mfma_f32_16x16x32_bf16 v[64:67], a[160:163], a[112:115], v[64:67]
s_add_u32 s37, s32, 17408
buffer_load_dwordx4 a[136:139], v4, s[16:19], s37 offen sc1
v_mfma_f32_16x16x32_bf16 v[100:103], a[160:163], a[116:119], v[100:103]
ds_read_b128 a[160:163], v7 offset:7168
s_add_u32 s37, s32, 37888
buffer_load_dwordx4 a[140:143], v4, s[16:19], s37 offen sc1
s_waitcnt lgkmcnt(8)
v_mfma_f32_16x16x32_bf16 v[68:71], a[164:167], a[112:115], v[68:71]
v_mfma_f32_16x16x32_bf16 v[104:107], a[164:167], a[116:119], v[104:107]
ds_read_b128 a[164:167], v7 offset:8192
s_waitcnt lgkmcnt(8)
v_mfma_f32_16x16x32_bf16 v[72:75], a[168:171], a[112:115], v[72:75]
v_mfma_f32_16x16x32_bf16 v[108:111], a[168:171], a[116:119], v[108:111]
ds_read_b128 a[168:171], v7 offset:9216
s_waitcnt lgkmcnt(8)
v_mfma_f32_16x16x32_bf16 v[76:79], a[172:175], a[112:115], v[76:79]
v_mfma_f32_16x16x32_bf16 v[112:115], a[172:175], a[116:119], v[112:115]
ds_read_b128 a[172:175], v7 offset:10240
s_waitcnt lgkmcnt(8)
v_mfma_f32_16x16x32_bf16 v[80:83], a[176:179], a[112:115], v[80:83]
v_mfma_f32_16x16x32_bf16 v[116:119], a[176:179], a[116:119], v[116:119]
ds_read_b128 a[176:179], v7 offset:11264
s_waitcnt lgkmcnt(8)
v_mfma_f32_16x16x32_bf16 v[84:87], a[180:183], a[112:115], v[84:87]
v_mfma_f32_16x16x32_bf16 v[120:123], a[180:183], a[116:119], v[120:123]
ds_read_b128 a[180:183], v7 offset:12288
s_waitcnt lgkmcnt(8)
v_mfma_f32_16x16x32_bf16 v[88:91], a[184:187], a[112:115], v[88:91]
v_mfma_f32_16x16x32_bf16 v[124:127], a[184:187], a[116:119], v[124:127]
ds_read_b128 a[184:187], v7 offset:13312
s_waitcnt lgkmcnt(8)
v_mfma_f32_16x16x32_bf16 v[92:95], a[188:191], a[112:115], v[92:95]
v_mfma_f32_16x16x32_bf16 v[128:131], a[188:191], a[116:119], v[128:131]
ds_read_b128 a[188:191], v7 offset:14336
s_waitcnt lgkmcnt(8)
v_mfma_f32_16x16x32_bf16 v[96:99], a[192:195], a[112:115], v[96:99]
v_mfma_f32_16x16x32_bf16 v[132:135], a[192:195], a[116:119], v[132:135]
ds_read_b128 a[192:195], v7 offset:15360
s_waitcnt vmcnt(4) lgkmcnt(8)
v_mfma_f32_16x16x32_bf16 v[64:67], a[160:163], a[120:123], v[64:67]
s_add_u32 s37, s32, 18432
buffer_load_dwordx4 a[144:147], v4, s[16:19], s37 offen sc1
v_mfma_f32_16x16x32_bf16 v[100:103], a[160:163], a[124:127], v[100:103]
s_barrier
ds_read_b128 a[160:163], v5 offset:0
s_add_u32 s37, s32, 38912
buffer_load_dwordx4 a[148:151], v4, s[16:19], s37 offen sc1
s_waitcnt lgkmcnt(8)
v_mfma_f32_16x16x32_bf16 v[68:71], a[164:167], a[120:123], v[68:71]
v_mfma_f32_16x16x32_bf16 v[104:107], a[164:167], a[124:127], v[104:107]
ds_read_b128 a[164:167], v5 offset:1024
s_waitcnt lgkmcnt(8)
v_mfma_f32_16x16x32_bf16 v[72:75], a[168:171], a[120:123], v[72:75]
v_mfma_f32_16x16x32_bf16 v[108:111], a[168:171], a[124:127], v[108:111]
ds_read_b128 a[168:171], v5 offset:2048
s_waitcnt lgkmcnt(8)
v_mfma_f32_16x16x32_bf16 v[76:79], a[172:175], a[120:123], v[76:79]
v_mfma_f32_16x16x32_bf16 v[112:115], a[172:175], a[124:127], v[112:115]
ds_read_b128 a[172:175], v5 offset:3072
s_waitcnt lgkmcnt(8)
v_mfma_f32_16x16x32_bf16 v[80:83], a[176:179], a[120:123], v[80:83]
v_mfma_f32_16x16x32_bf16 v[116:119], a[176:179], a[124:127], v[116:119]
ds_read_b128 a[176:179], v5 offset:4096
s_waitcnt lgkmcnt(8)
v_mfma_f32_16x16x32_bf16 v[84:87], a[180:183], a[120:123], v[84:87]
v_mfma_f32_16x16x32_bf16 v[120:123], a[180:183], a[124:127], v[120:123]
ds_read_b128 a[180:183], v5 offset:5120
s_waitcnt lgkmcnt(8)
v_mfma_f32_16x16x32_bf16 v[88:91], a[184:187], a[120:123], v[88:91]
v_mfma_f32_16x16x32_bf16 v[124:127], a[184:187], a[124:127], v[124:127]
ds_read_b128 a[184:187], v5 offset:6144
s_waitcnt lgkmcnt(8)
v_mfma_f32_16x16x32_bf16 v[92:95], a[188:191], a[120:123], v[92:95]
v_mfma_f32_16x16x32_bf16 v[128:131], a[188:191], a[124:127], v[128:131]
ds_read_b128 a[188:191], v5 offset:7168
s_waitcnt lgkmcnt(8)
v_mfma_f32_16x16x32_bf16 v[96:99], a[192:195], a[120:123], v[96:99]
v_mfma_f32_16x16x32_bf16 v[132:135], a[192:195], a[124:127], v[132:135]
ds_read_b128 a[192:195], v5 offset:8192
s_waitcnt vmcnt(4) lgkmcnt(8)
v_mfma_f32_16x16x32_bf16 v[64:67], a[160:163], a[128:131], v[64:67]
s_add_u32 s37, s32, 19456
buffer_load_dwordx4 a[152:155], v4, s[16:19], s37 offen sc1
v_mfma_f32_16x16x32_bf16 v[100:103], a[160:163], a[132:135], v[100:103]
ds_read_b128 a[160:163], v5 offset:9216
s_add_u32 s37, s32, 39936
buffer_load_dwordx4 a[156:159], v4, s[16:19], s37 offen sc1
s_waitcnt lgkmcnt(8)
v_mfma_f32_16x16x32_bf16 v[68:71], a[164:167], a[128:131], v[68:71]
v_lshlrev_b32 v11, 4, v2
v_add_u32 v11, 147456, v11
v_mfma_f32_16x16x32_bf16 v[104:107], a[164:167], a[132:135], v[104:107]
ds_read_b128 a[164:167], v5 offset:10240
ds_read_b128 v[140:143], v11 offset:0
s_waitcnt lgkmcnt(9)
v_mfma_f32_16x16x32_bf16 v[72:75], a[168:171], a[128:131], v[72:75]
ds_read_b128 v[144:147], v11 offset:64
v_mfma_f32_16x16x32_bf16 v[108:111], a[168:171], a[132:135], v[108:111]
ds_read_b128 a[168:171], v5 offset:11264
ds_read_b128 v[148:151], v11 offset:128
s_waitcnt lgkmcnt(11)
v_mfma_f32_16x16x32_bf16 v[76:79], a[172:175], a[128:131], v[76:79]
v_mfma_f32_16x16x32_bf16 v[112:115], a[172:175], a[132:135], v[112:115]
ds_read_b128 a[172:175], v5 offset:12288
s_waitcnt lgkmcnt(11)
v_mfma_f32_16x16x32_bf16 v[80:83], a[176:179], a[128:131], v[80:83]
v_mfma_f32_16x16x32_bf16 v[116:119], a[176:179], a[132:135], v[116:119]
ds_read_b128 a[176:179], v5 offset:13312
s_waitcnt lgkmcnt(11)
v_mfma_f32_16x16x32_bf16 v[84:87], a[180:183], a[128:131], v[84:87]
v_mfma_f32_16x16x32_bf16 v[120:123], a[180:183], a[132:135], v[120:123]
ds_read_b128 a[180:183], v5 offset:14336
s_waitcnt lgkmcnt(11)
v_mfma_f32_16x16x32_bf16 v[88:91], a[184:187], a[128:131], v[88:91]
v_mfma_f32_16x16x32_bf16 v[124:127], a[184:187], a[132:135], v[124:127]
ds_read_b128 a[184:187], v5 offset:15360
s_waitcnt lgkmcnt(11)
v_mfma_f32_16x16x32_bf16 v[92:95], a[188:191], a[128:131], v[92:95]
v_mfma_f32_16x16x32_bf16 v[128:131], a[188:191], a[132:135], v[128:131]
s_barrier
ds_read_b128 a[188:191], v5 offset:16384
s_waitcnt lgkmcnt(11)
v_mfma_f32_16x16x32_bf16 v[96:99], a[192:195], a[128:131], v[96:99]
v_mfma_f32_16x16x32_bf16 v[132:135], a[192:195], a[132:135], v[132:135]
ds_read_b128 a[192:195], v5 offset:17408
s_waitcnt vmcnt(4) lgkmcnt(11)
v_mfma_f32_16x16x32_bf16 v[64:67], a[160:163], a[136:139], v[64:67]
ds_read_b128 v[152:155], v11 offset:192
v_mfma_f32_16x16x32_bf16 v[100:103], a[160:163], a[140:143], v[100:103]
ds_read_b128 a[160:163], v5 offset:18432
ds_read_b128 v[156:159], v11 offset:256
s_waitcnt lgkmcnt(13)
v_mfma_f32_16x16x32_bf16 v[68:71], a[164:167], a[136:139], v[68:71]
ds_read_b128 v[160:163], v11 offset:320
v_mfma_f32_16x16x32_bf16 v[104:107], a[164:167], a[140:143], v[104:107]
ds_read_b128 a[164:167], v5 offset:19456
s_waitcnt lgkmcnt(12)
v_mfma_f32_16x16x32_bf16 v[72:75], a[168:171], a[136:139], v[72:75]
v_mfma_f32_16x16x32_bf16 v[108:111], a[168:171], a[140:143], v[108:111]
ds_read_b128 a[168:171], v5 offset:20480
s_waitcnt lgkmcnt(11)
v_mfma_f32_16x16x32_bf16 v[76:79], a[172:175], a[136:139], v[76:79]
v_mfma_f32_16x16x32_bf16 v[112:115], a[172:175], a[140:143], v[112:115]
ds_read_b128 a[172:175], v5 offset:21504
s_waitcnt lgkmcnt(11)
v_mfma_f32_16x16x32_bf16 v[80:83], a[176:179], a[136:139], v[80:83]
v_mfma_f32_16x16x32_bf16 v[116:119], a[176:179], a[140:143], v[116:119]
ds_read_b128 a[176:179], v5 offset:22528
s_waitcnt lgkmcnt(11)
v_mfma_f32_16x16x32_bf16 v[84:87], a[180:183], a[136:139], v[84:87]
v_mfma_f32_16x16x32_bf16 v[120:123], a[180:183], a[140:143], v[120:123]
ds_read_b128 a[180:183], v5 offset:23552
s_waitcnt lgkmcnt(11)
v_mfma_f32_16x16x32_bf16 v[88:91], a[184:187], a[136:139], v[88:91]
v_mfma_f32_16x16x32_bf16 v[124:127], a[184:187], a[140:143], v[124:127]
ds_read_b128 a[184:187], v5 offset:24576
s_waitcnt lgkmcnt(11)
v_mfma_f32_16x16x32_bf16 v[92:95], a[188:191], a[136:139], v[92:95]
v_mfma_f32_16x16x32_bf16 v[128:131], a[188:191], a[140:143], v[128:131]
ds_read_b128 a[188:191], v5 offset:25600
s_waitcnt lgkmcnt(11)
v_mfma_f32_16x16x32_bf16 v[96:99], a[192:195], a[136:139], v[96:99]
v_mfma_f32_16x16x32_bf16 v[132:135], a[192:195], a[140:143], v[132:135]
ds_read_b128 a[192:195], v5 offset:26624
s_waitcnt vmcnt(2) lgkmcnt(10)
v_mfma_f32_16x16x32_bf16 v[64:67], a[160:163], a[144:147], v[64:67]
ds_read_b128 v[164:167], v11 offset:384
v_mfma_f32_16x16x32_bf16 v[100:103], a[160:163], a[148:151], v[100:103]
ds_read_b128 a[160:163], v5 offset:27648
ds_read_b128 v[168:171], v11 offset:448
s_waitcnt lgkmcnt(10)
v_mfma_f32_16x16x32_bf16 v[68:71], a[164:167], a[144:147], v[68:71]
ds_read_b128 v[172:175], v11 offset:512
v_mfma_f32_16x16x32_bf16 v[104:107], a[164:167], a[148:151], v[104:107]
ds_read_b128 a[164:167], v5 offset:28672
s_waitcnt lgkmcnt(11)
v_mfma_f32_16x16x32_bf16 v[72:75], a[168:171], a[144:147], v[72:75]
v_mfma_f32_16x16x32_bf16 v[108:111], a[168:171], a[148:151], v[108:111]
ds_read_b128 a[168:171], v5 offset:29696
s_waitcnt lgkmcnt(11)
v_mfma_f32_16x16x32_bf16 v[76:79], a[172:175], a[144:147], v[76:79]
v_mfma_f32_16x16x32_bf16 v[112:115], a[172:175], a[148:151], v[112:115]
ds_read_b128 a[172:175], v5 offset:30720
s_waitcnt lgkmcnt(11)
v_mfma_f32_16x16x32_bf16 v[80:83], a[176:179], a[144:147], v[80:83]
v_mfma_f32_16x16x32_bf16 v[116:119], a[176:179], a[148:151], v[116:119]
ds_read_b128 a[176:179], v5 offset:31744
s_waitcnt lgkmcnt(11)
v_mfma_f32_16x16x32_bf16 v[84:87], a[180:183], a[144:147], v[84:87]
v_mfma_f32_16x16x32_bf16 v[120:123], a[180:183], a[148:151], v[120:123]
s_barrier
ds_read_b128 a[180:183], v5 offset:32768
s_waitcnt lgkmcnt(11)
v_mfma_f32_16x16x32_bf16 v[88:91], a[184:187], a[144:147], v[88:91]
v_mfma_f32_16x16x32_bf16 v[124:127], a[184:187], a[148:151], v[124:127]
ds_read_b128 a[184:187], v5 offset:33792
s_waitcnt lgkmcnt(11)
v_mfma_f32_16x16x32_bf16 v[92:95], a[188:191], a[144:147], v[92:95]
v_mfma_f32_16x16x32_bf16 v[128:131], a[188:191], a[148:151], v[128:131]
ds_read_b128 a[188:191], v5 offset:34816
s_waitcnt lgkmcnt(11)
v_mfma_f32_16x16x32_bf16 v[96:99], a[192:195], a[144:147], v[96:99]
v_mfma_f32_16x16x32_bf16 v[132:135], a[192:195], a[148:151], v[132:135]
ds_read_b128 a[192:195], v5 offset:35840
s_waitcnt vmcnt(0) lgkmcnt(10)
v_mfma_f32_16x16x32_bf16 v[64:67], a[160:163], a[152:155], v[64:67]
v_mfma_f32_16x16x32_bf16 v[100:103], a[160:163], a[156:159], v[100:103]
s_waitcnt lgkmcnt(7)
v_mfma_f32_16x16x32_bf16 v[68:71], a[164:167], a[152:155], v[68:71]
v_mfma_f32_16x16x32_bf16 v[104:107], a[164:167], a[156:159], v[104:107]
s_waitcnt lgkmcnt(6)
v_mfma_f32_16x16x32_bf16 v[72:75], a[168:171], a[152:155], v[72:75]
v_mfma_f32_16x16x32_bf16 v[108:111], a[168:171], a[156:159], v[108:111]
s_waitcnt lgkmcnt(5)
v_mfma_f32_16x16x32_bf16 v[76:79], a[172:175], a[152:155], v[76:79]
v_mfma_f32_16x16x32_bf16 v[112:115], a[172:175], a[156:159], v[112:115]
s_waitcnt lgkmcnt(4)
v_mfma_f32_16x16x32_bf16 v[80:83], a[176:179], a[152:155], v[80:83]
v_mfma_f32_16x16x32_bf16 v[116:119], a[176:179], a[156:159], v[116:119]
s_waitcnt lgkmcnt(3)
v_mfma_f32_16x16x32_bf16 v[84:87], a[180:183], a[152:155], v[84:87]
v_mfma_f32_16x16x32_bf16 v[120:123], a[180:183], a[156:159], v[120:123]
s_waitcnt lgkmcnt(2)
v_mfma_f32_16x16x32_bf16 v[88:91], a[184:187], a[152:155], v[88:91]
v_mfma_f32_16x16x32_bf16 v[124:127], a[184:187], a[156:159], v[124:127]
s_waitcnt lgkmcnt(1)
v_mfma_f32_16x16x32_bf16 v[92:95], a[188:191], a[152:155], v[92:95]
v_mfma_f32_16x16x32_bf16 v[128:131], a[188:191], a[156:159], v[128:131]
s_waitcnt lgkmcnt(0)
v_mfma_f32_16x16x32_bf16 v[96:99], a[192:195], a[152:155], v[96:99]
v_mfma_f32_16x16x32_bf16 v[132:135], a[192:195], a[156:159], v[132:135]
s_barrier
s_and_b32 s33, s10, 1
s_lshl_b32 s33, s33, 2
s_and_b32 s34, s11, 3
s_add_u32 s33, s33, s34
s_mul_i32 s33, s33, 276480
s_add_u32 s33, s33, 10117120
s_lshl_b32 s34, s3, 12
s_add_u32 s33, s33, s34
s_lshl_b32 s51, s12, 7
s_lshl_b32 s15, s13, 2
s_add_u32 s51, s51, s15
s_add_u32 s51, s51, 28515328
s_nop 4
v_pk_fma_f32 v[64:65], v[140:141], v[176:177], v[64:65]
v_pk_fma_f32 v[66:67], v[142:143], v[176:177], v[66:67]
v_pk_fma_f32 v[68:69], v[144:145], v[176:177], v[68:69]
v_pk_fma_f32 v[70:71], v[146:147], v[176:177], v[70:71]
v_pk_mul_f32 v[64:65], v[64:65], v[178:179]
v_pk_mul_f32 v[66:67], v[66:67], v[178:179]
v_pk_mul_f32 v[68:69], v[68:69], v[178:179]
v_pk_mul_f32 v[70:71], v[70:71], v[178:179]
v_pk_mul_f32 v[188:189], v[64:65], v[64:65]
v_pk_mul_f32 v[190:191], v[66:67], v[66:67]
v_pk_mul_f32 v[192:193], v[68:69], v[68:69]
v_pk_mul_f32 v[194:195], v[70:71], v[70:71]
v_pk_fma_f32 v[188:189], v[188:189], v[186:187], v[184:185]
v_pk_fma_f32 v[190:191], v[190:191], v[186:187], v[184:185]
v_pk_fma_f32 v[192:193], v[192:193], v[186:187], v[184:185]
v_pk_fma_f32 v[194:195], v[194:195], v[186:187], v[184:185]
v_pk_mul_f32 v[188:189], v[188:189], v[64:65]
v_pk_mul_f32 v[190:191], v[190:191], v[66:67]
v_pk_mul_f32 v[192:193], v[192:193], v[68:69]
v_pk_mul_f32 v[194:195], v[194:195], v[70:71]
v_exp_f32 v188, v188
v_exp_f32 v189, v189
v_exp_f32 v190, v190
v_exp_f32 v191, v191
v_exp_f32 v192, v192
v_exp_f32 v193, v193
v_exp_f32 v194, v194
v_exp_f32 v195, v195
v_pk_add_f32 v[188:189], v[188:189], 1.0 op_sel_hi:[1,0]
v_pk_add_f32 v[190:191], v[190:191], 1.0 op_sel_hi:[1,0]
v_pk_add_f32 v[192:193], v[192:193], 1.0 op_sel_hi:[1,0]
v_pk_add_f32 v[194:195], v[194:195], 1.0 op_sel_hi:[1,0]
v_rcp_f32 v188, v188
v_rcp_f32 v189, v189
v_rcp_f32 v190, v190
v_rcp_f32 v191, v191
v_rcp_f32 v192, v192
v_rcp_f32 v193, v193
v_rcp_f32 v194, v194
v_rcp_f32 v195, v195
v_pk_mul_f32 v[64:65], v[64:65], v[188:189]
v_pk_mul_f32 v[66:67], v[66:67], v[190:191]
v_pk_mul_f32 v[68:69], v[68:69], v[192:193]
v_pk_mul_f32 v[70:71], v[70:71], v[194:195]
v_cvt_pk_bf16_f32 v196, v64, v65
v_cvt_pk_bf16_f32 v197, v66, v67
v_cvt_pk_bf16_f32 v198, v68, v69
v_cvt_pk_bf16_f32 v199, v70, v71
v_pk_fma_f32 v[72:73], v[148:149], v[176:177], v[72:73]
v_pk_fma_f32 v[74:75], v[150:151], v[176:177], v[74:75]
v_pk_fma_f32 v[76:77], v[152:153], v[176:177], v[76:77]
v_pk_fma_f32 v[78:79], v[154:155], v[176:177], v[78:79]
v_pk_mul_f32 v[72:73], v[72:73], v[178:179]
v_pk_mul_f32 v[74:75], v[74:75], v[178:179]
v_pk_mul_f32 v[76:77], v[76:77], v[178:179]
v_pk_mul_f32 v[78:79], v[78:79], v[178:179]
v_pk_mul_f32 v[188:189], v[72:73], v[72:73]
v_pk_mul_f32 v[190:191], v[74:75], v[74:75]
v_pk_mul_f32 v[192:193], v[76:77], v[76:77]
v_pk_mul_f32 v[194:195], v[78:79], v[78:79]
v_pk_fma_f32 v[188:189], v[188:189], v[186:187], v[184:185]
v_pk_fma_f32 v[190:191], v[190:191], v[186:187], v[184:185]
v_pk_fma_f32 v[192:193], v[192:193], v[186:187], v[184:185]
v_pk_fma_f32 v[194:195], v[194:195], v[186:187], v[184:185]
v_pk_mul_f32 v[188:189], v[188:189], v[72:73]
v_pk_mul_f32 v[190:191], v[190:191], v[74:75]
v_pk_mul_f32 v[192:193], v[192:193], v[76:77]
v_pk_mul_f32 v[194:195], v[194:195], v[78:79]
v_exp_f32 v188, v188
v_exp_f32 v189, v189
v_exp_f32 v190, v190
v_exp_f32 v191, v191
v_exp_f32 v192, v192
v_exp_f32 v193, v193
v_exp_f32 v194, v194
v_exp_f32 v195, v195
v_pk_add_f32 v[188:189], v[188:189], 1.0 op_sel_hi:[1,0]
v_pk_add_f32 v[190:191], v[190:191], 1.0 op_sel_hi:[1,0]
v_pk_add_f32 v[192:193], v[192:193], 1.0 op_sel_hi:[1,0]
v_pk_add_f32 v[194:195], v[194:195], 1.0 op_sel_hi:[1,0]
v_rcp_f32 v188, v188
v_rcp_f32 v189, v189
v_rcp_f32 v190, v190
v_rcp_f32 v191, v191
v_rcp_f32 v192, v192
v_rcp_f32 v193, v193
v_rcp_f32 v194, v194
v_rcp_f32 v195, v195
v_pk_mul_f32 v[72:73], v[72:73], v[188:189]
v_pk_mul_f32 v[74:75], v[74:75], v[190:191]
v_pk_mul_f32 v[76:77], v[76:77], v[192:193]
v_pk_mul_f32 v[78:79], v[78:79], v[194:195]
v_cvt_pk_bf16_f32 v200, v72, v73
v_cvt_pk_bf16_f32 v201, v74, v75
v_cvt_pk_bf16_f32 v202, v76, v77
v_cvt_pk_bf16_f32 v203, v78, v79
s_add_u32 m0, s34, 0
s_add_u32 s36, s33, 0
buffer_load_dwordx4 v4, s[24:27], s36 offen offset:0  lds
buffer_load_dwordx4 v4, s[24:27], s36 offen offset:1024  lds
buffer_load_dwordx4 v4, s[24:27], s36 offen offset:2048  lds
buffer_load_dwordx4 v4, s[24:27], s36 offen offset:3072  lds
v_pk_fma_f32 v[80:81], v[156:157], v[176:177], v[80:81]
v_pk_fma_f32 v[82:83], v[158:159], v[176:177], v[82:83]
v_pk_fma_f32 v[84:85], v[160:161], v[176:177], v[84:85]
v_pk_fma_f32 v[86:87], v[162:163], v[176:177], v[86:87]
v_pk_mul_f32 v[80:81], v[80:81], v[178:179]
v_pk_mul_f32 v[82:83], v[82:83], v[178:179]
v_pk_mul_f32 v[84:85], v[84:85], v[178:179]
v_pk_mul_f32 v[86:87], v[86:87], v[178:179]
v_pk_mul_f32 v[188:189], v[80:81], v[80:81]
v_pk_mul_f32 v[190:191], v[82:83], v[82:83]
v_pk_mul_f32 v[192:193], v[84:85], v[84:85]
v_pk_mul_f32 v[194:195], v[86:87], v[86:87]
v_pk_fma_f32 v[188:189], v[188:189], v[186:187], v[184:185]
v_pk_fma_f32 v[190:191], v[190:191], v[186:187], v[184:185]
v_pk_fma_f32 v[192:193], v[192:193], v[186:187], v[184:185]
v_pk_fma_f32 v[194:195], v[194:195], v[186:187], v[184:185]
v_pk_mul_f32 v[188:189], v[188:189], v[80:81]
v_pk_mul_f32 v[190:191], v[190:191], v[82:83]
v_pk_mul_f32 v[192:193], v[192:193], v[84:85]
v_pk_mul_f32 v[194:195], v[194:195], v[86:87]
v_exp_f32 v188, v188
v_exp_f32 v189, v189
v_exp_f32 v190, v190
v_exp_f32 v191, v191
v_exp_f32 v192, v192
v_exp_f32 v193, v193
v_exp_f32 v194, v194
v_exp_f32 v195, v195
v_pk_add_f32 v[188:189], v[188:189], 1.0 op_sel_hi:[1,0]
v_pk_add_f32 v[190:191], v[190:191], 1.0 op_sel_hi:[1,0]
v_pk_add_f32 v[192:193], v[192:193], 1.0 op_sel_hi:[1,0]
v_pk_add_f32 v[194:195], v[194:195], 1.0 op_sel_hi:[1,0]
v_rcp_f32 v188, v188
v_rcp_f32 v189, v189
v_rcp_f32 v190, v190
v_rcp_f32 v191, v191
v_rcp_f32 v192, v192
v_rcp_f32 v193, v193
v_rcp_f32 v194, v194
v_rcp_f32 v195, v195
v_pk_mul_f32 v[80:81], v[80:81], v[188:189]
v_pk_mul_f32 v[82:83], v[82:83], v[190:191]
v_pk_mul_f32 v[84:85], v[84:85], v[192:193]
v_pk_mul_f32 v[86:87], v[86:87], v[194:195]
v_cvt_pk_bf16_f32 v204, v80, v81
v_cvt_pk_bf16_f32 v205, v82, v83
v_cvt_pk_bf16_f32 v206, v84, v85
v_cvt_pk_bf16_f32 v207, v86, v87
v_pk_fma_f32 v[88:89], v[164:165], v[176:177], v[88:89]
v_pk_fma_f32 v[90:91], v[166:167], v[176:177], v[90:91]
v_pk_fma_f32 v[92:93], v[168:169], v[176:177], v[92:93]
v_pk_fma_f32 v[94:95], v[170:171], v[176:177], v[94:95]
v_pk_mul_f32 v[88:89], v[88:89], v[178:179]
v_pk_mul_f32 v[90:91], v[90:91], v[178:179]
v_pk_mul_f32 v[92:93], v[92:93], v[178:179]
v_pk_mul_f32 v[94:95], v[94:95], v[178:179]
v_pk_mul_f32 v[188:189], v[88:89], v[88:89]
v_pk_mul_f32 v[190:191], v[90:91], v[90:91]
v_pk_mul_f32 v[192:193], v[92:93], v[92:93]
v_pk_mul_f32 v[194:195], v[94:95], v[94:95]
v_pk_fma_f32 v[188:189], v[188:189], v[186:187], v[184:185]
v_pk_fma_f32 v[190:191], v[190:191], v[186:187], v[184:185]
v_pk_fma_f32 v[192:193], v[192:193], v[186:187], v[184:185]
v_pk_fma_f32 v[194:195], v[194:195], v[186:187], v[184:185]
v_pk_mul_f32 v[188:189], v[188:189], v[88:89]
v_pk_mul_f32 v[190:191], v[190:191], v[90:91]
v_pk_mul_f32 v[192:193], v[192:193], v[92:93]
v_pk_mul_f32 v[194:195], v[194:195], v[94:95]
v_exp_f32 v188, v188
v_exp_f32 v189, v189
v_exp_f32 v190, v190
v_exp_f32 v191, v191
v_exp_f32 v192, v192
v_exp_f32 v193, v193
v_exp_f32 v194, v194
v_exp_f32 v195, v195
v_pk_add_f32 v[188:189], v[188:189], 1.0 op_sel_hi:[1,0]
v_pk_add_f32 v[190:191], v[190:191], 1.0 op_sel_hi:[1,0]
v_pk_add_f32 v[192:193], v[192:193], 1.0 op_sel_hi:[1,0]
v_pk_add_f32 v[194:195], v[194:195], 1.0 op_sel_hi:[1,0]
v_rcp_f32 v188, v188
v_rcp_f32 v189, v189
v_rcp_f32 v190, v190
v_rcp_f32 v191, v191
v_rcp_f32 v192, v192
v_rcp_f32 v193, v193
v_rcp_f32 v194, v194
v_rcp_f32 v195, v195
v_pk_mul_f32 v[88:89], v[88:89], v[188:189]
v_pk_mul_f32 v[90:91], v[90:91], v[190:191]
v_pk_mul_f32 v[92:93], v[92:93], v[192:193]
v_pk_mul_f32 v[94:95], v[94:95], v[194:195]
v_cvt_pk_bf16_f32 v208, v88, v89
v_cvt_pk_bf16_f32 v209, v90, v91
v_cvt_pk_bf16_f32 v210, v92, v93
v_cvt_pk_bf16_f32 v211, v94, v95
s_add_u32 m0, s34, 16384
s_add_u32 s36, s33, 16384
buffer_load_dwordx4 v4, s[24:27], s36 offen offset:0  lds
buffer_load_dwordx4 v4, s[24:27], s36 offen offset:1024  lds
buffer_load_dwordx4 v4, s[24:27], s36 offen offset:2048  lds
buffer_load_dwordx4 v4, s[24:27], s36 offen offset:3072  lds
v_pk_fma_f32 v[96:97], v[172:173], v[176:177], v[96:97]
v_pk_fma_f32 v[98:99], v[174:175], v[176:177], v[98:99]
v_pk_mul_f32 v[96:97], v[96:97], v[178:179]
v_pk_mul_f32 v[98:99], v[98:99], v[178:179]
v_pk_mul_f32 v[188:189], v[96:97], v[96:97]
v_pk_mul_f32 v[190:191], v[98:99], v[98:99]
v_pk_fma_f32 v[188:189], v[188:189], v[186:187], v[184:185]
v_pk_fma_f32 v[190:191], v[190:191], v[186:187], v[184:185]
v_pk_mul_f32 v[188:189], v[188:189], v[96:97]
v_pk_mul_f32 v[190:191], v[190:191], v[98:99]
v_exp_f32 v188, v188
v_exp_f32 v189, v189
v_exp_f32 v190, v190
v_exp_f32 v191, v191
v_pk_add_f32 v[188:189], v[188:189], 1.0 op_sel_hi:[1,0]
v_pk_add_f32 v[190:191], v[190:191], 1.0 op_sel_hi:[1,0]
v_rcp_f32 v188, v188
v_rcp_f32 v189, v189
v_rcp_f32 v190, v190
v_rcp_f32 v191, v191
v_pk_mul_f32 v[96:97], v[96:97], v[188:189]
v_pk_mul_f32 v[98:99], v[98:99], v[190:191]
v_cvt_pk_bf16_f32 v212, v96, v97
v_cvt_pk_bf16_f32 v213, v98, v99
s_cmp_eq_u32 s50, 0
s_cbranch_scc0 L_hh_0_odd
buffer_store_dwordx4 v[196:199], v4, s[24:27], s49 offen offset:0 sc1
s_add_u32 s39, s49, 4096
buffer_store_dwordx4 v[200:203], v4, s[24:27], s39 offen offset:0 sc1
s_add_u32 s39, s49, 8192
buffer_store_dwordx4 v[204:207], v4, s[24:27], s39 offen offset:0 sc1
s_add_u32 s39, s49, 12288
buffer_store_dwordx4 v[208:211], v4, s[24:27], s39 offen offset:0 sc1
s_add_u32 s39, s49, 16384
buffer_store_dwordx2 v[212:213], v4, s[24:27], s39 offen offset:0 sc1
s_branch L_hh_0_std
L_hh_0_odd:
buffer_store_dwordx2 v[196:197], v4, s[24:27], s49 offen offset:8 sc1
s_add_u32 s39, s49, 4096
buffer_store_dwordx4 v[198:201], v4, s[24:27], s39 offen offset:0 sc1
s_add_u32 s39, s49, 8192
buffer_store_dwordx4 v[202:205], v4, s[24:27], s39 offen offset:0 sc1
s_add_u32 s39, s49, 12288
buffer_store_dwordx4 v[206:209], v4, s[24:27], s39 offen offset:0 sc1
s_add_u32 s39, s49, 16384
buffer_store_dwordx4 v[210:213], v4, s[24:27], s39 offen offset:0 sc1
L_hh_0_std:
v_pk_fma_f32 v[100:101], v[140:141], v[180:181], v[100:101]
v_pk_fma_f32 v[102:103], v[142:143], v[180:181], v[102:103]
v_pk_fma_f32 v[104:105], v[144:145], v[180:181], v[104:105]
v_pk_fma_f32 v[106:107], v[146:147], v[180:181], v[106:107]
v_pk_mul_f32 v[100:101], v[100:101], v[182:183]
v_pk_mul_f32 v[102:103], v[102:103], v[182:183]
v_pk_mul_f32 v[104:105], v[104:105], v[182:183]
v_pk_mul_f32 v[106:107], v[106:107], v[182:183]
v_pk_mul_f32 v[188:189], v[100:101], v[100:101]
v_pk_mul_f32 v[190:191], v[102:103], v[102:103]
v_pk_mul_f32 v[192:193], v[104:105], v[104:105]
v_pk_mul_f32 v[194:195], v[106:107], v[106:107]
v_pk_fma_f32 v[188:189], v[188:189], v[186:187], v[184:185]
v_pk_fma_f32 v[190:191], v[190:191], v[186:187], v[184:185]
v_pk_fma_f32 v[192:193], v[192:193], v[186:187], v[184:185]
v_pk_fma_f32 v[194:195], v[194:195], v[186:187], v[184:185]
v_pk_mul_f32 v[188:189], v[188:189], v[100:101]
v_pk_mul_f32 v[190:191], v[190:191], v[102:103]
v_pk_mul_f32 v[192:193], v[192:193], v[104:105]
v_pk_mul_f32 v[194:195], v[194:195], v[106:107]
v_exp_f32 v188, v188
v_exp_f32 v189, v189
v_exp_f32 v190, v190
v_exp_f32 v191, v191
v_exp_f32 v192, v192
v_exp_f32 v193, v193
v_exp_f32 v194, v194
v_exp_f32 v195, v195
v_pk_add_f32 v[188:189], v[188:189], 1.0 op_sel_hi:[1,0]
v_pk_add_f32 v[190:191], v[190:191], 1.0 op_sel_hi:[1,0]
v_pk_add_f32 v[192:193], v[192:193], 1.0 op_sel_hi:[1,0]
v_pk_add_f32 v[194:195], v[194:195], 1.0 op_sel_hi:[1,0]
v_rcp_f32 v188, v188
v_rcp_f32 v189, v189
v_rcp_f32 v190, v190
v_rcp_f32 v191, v191
v_rcp_f32 v192, v192
v_rcp_f32 v193, v193
v_rcp_f32 v194, v194
v_rcp_f32 v195, v195
v_pk_mul_f32 v[100:101], v[100:101], v[188:189]
v_pk_mul_f32 v[102:103], v[102:103], v[190:191]
v_pk_mul_f32 v[104:105], v[104:105], v[192:193]
v_pk_mul_f32 v[106:107], v[106:107], v[194:195]
v_cvt_pk_bf16_f32 v214, v100, v101
v_cvt_pk_bf16_f32 v215, v102, v103
v_cvt_pk_bf16_f32 v216, v104, v105
v_cvt_pk_bf16_f32 v217, v106, v107
v_pk_fma_f32 v[108:109], v[148:149], v[180:181], v[108:109]
v_pk_fma_f32 v[110:111], v[150:151], v[180:181], v[110:111]
v_pk_fma_f32 v[112:113], v[152:153], v[180:181], v[112:113]
v_pk_fma_f32 v[114:115], v[154:155], v[180:181], v[114:115]
v_pk_mul_f32 v[108:109], v[108:109], v[182:183]
v_pk_mul_f32 v[110:111], v[110:111], v[182:183]
v_pk_mul_f32 v[112:113], v[112:113], v[182:183]
v_pk_mul_f32 v[114:115], v[114:115], v[182:183]
v_pk_mul_f32 v[188:189], v[108:109], v[108:109]
v_pk_mul_f32 v[190:191], v[110:111], v[110:111]
v_pk_mul_f32 v[192:193], v[112:113], v[112:113]
v_pk_mul_f32 v[194:195], v[114:115], v[114:115]
v_pk_fma_f32 v[188:189], v[188:189], v[186:187], v[184:185]
v_pk_fma_f32 v[190:191], v[190:191], v[186:187], v[184:185]
v_pk_fma_f32 v[192:193], v[192:193], v[186:187], v[184:185]
v_pk_fma_f32 v[194:195], v[194:195], v[186:187], v[184:185]
v_pk_mul_f32 v[188:189], v[188:189], v[108:109]
v_pk_mul_f32 v[190:191], v[190:191], v[110:111]
v_pk_mul_f32 v[192:193], v[192:193], v[112:113]
v_pk_mul_f32 v[194:195], v[194:195], v[114:115]
v_exp_f32 v188, v188
v_exp_f32 v189, v189
v_exp_f32 v190, v190
v_exp_f32 v191, v191
v_exp_f32 v192, v192
v_exp_f32 v193, v193
v_exp_f32 v194, v194
v_exp_f32 v195, v195
v_pk_add_f32 v[188:189], v[188:189], 1.0 op_sel_hi:[1,0]
v_pk_add_f32 v[190:191], v[190:191], 1.0 op_sel_hi:[1,0]
v_pk_add_f32 v[192:193], v[192:193], 1.0 op_sel_hi:[1,0]
v_pk_add_f32 v[194:195], v[194:195], 1.0 op_sel_hi:[1,0]
v_rcp_f32 v188, v188
v_rcp_f32 v189, v189
v_rcp_f32 v190, v190
v_rcp_f32 v191, v191
v_rcp_f32 v192, v192
v_rcp_f32 v193, v193
v_rcp_f32 v194, v194
v_rcp_f32 v195, v195
v_pk_mul_f32 v[108:109], v[108:109], v[188:189]
v_pk_mul_f32 v[110:111], v[110:111], v[190:191]
v_pk_mul_f32 v[112:113], v[112:113], v[192:193]
v_pk_mul_f32 v[114:115], v[114:115], v[194:195]
v_cvt_pk_bf16_f32 v218, v108, v109
v_cvt_pk_bf16_f32 v219, v110, v111
v_cvt_pk_bf16_f32 v220, v112, v113
v_cvt_pk_bf16_f32 v221, v114, v115
v_pk_fma_f32 v[116:117], v[156:157], v[180:181], v[116:117]
v_pk_fma_f32 v[118:119], v[158:159], v[180:181], v[118:119]
v_pk_fma_f32 v[120:121], v[160:161], v[180:181], v[120:121]
v_pk_fma_f32 v[122:123], v[162:163], v[180:181], v[122:123]
v_pk_mul_f32 v[116:117], v[116:117], v[182:183]
v_pk_mul_f32 v[118:119], v[118:119], v[182:183]
v_pk_mul_f32 v[120:121], v[120:121], v[182:183]
v_pk_mul_f32 v[122:123], v[122:123], v[182:183]
v_pk_mul_f32 v[188:189], v[116:117], v[116:117]
v_pk_mul_f32 v[190:191], v[118:119], v[118:119]
v_pk_mul_f32 v[192:193], v[120:121], v[120:121]
v_pk_mul_f32 v[194:195], v[122:123], v[122:123]
v_pk_fma_f32 v[188:189], v[188:189], v[186:187], v[184:185]
v_pk_fma_f32 v[190:191], v[190:191], v[186:187], v[184:185]
v_pk_fma_f32 v[192:193], v[192:193], v[186:187], v[184:185]
v_pk_fma_f32 v[194:195], v[194:195], v[186:187], v[184:185]
v_pk_mul_f32 v[188:189], v[188:189], v[116:117]
v_pk_mul_f32 v[190:191], v[190:191], v[118:119]
v_pk_mul_f32 v[192:193], v[192:193], v[120:121]
v_pk_mul_f32 v[194:195], v[194:195], v[122:123]
v_exp_f32 v188, v188
v_exp_f32 v189, v189
v_exp_f32 v190, v190
v_exp_f32 v191, v191
v_exp_f32 v192, v192
v_exp_f32 v193, v193
v_exp_f32 v194, v194
v_exp_f32 v195, v195
v_pk_add_f32 v[188:189], v[188:189], 1.0 op_sel_hi:[1,0]
v_pk_add_f32 v[190:191], v[190:191], 1.0 op_sel_hi:[1,0]
v_pk_add_f32 v[192:193], v[192:193], 1.0 op_sel_hi:[1,0]
v_pk_add_f32 v[194:195], v[194:195], 1.0 op_sel_hi:[1,0]
v_rcp_f32 v188, v188
v_rcp_f32 v189, v189
v_rcp_f32 v190, v190
v_rcp_f32 v191, v191
v_rcp_f32 v192, v192
v_rcp_f32 v193, v193
v_rcp_f32 v194, v194
v_rcp_f32 v195, v195
v_pk_mul_f32 v[116:117], v[116:117], v[188:189]
v_pk_mul_f32 v[118:119], v[118:119], v[190:191]
v_pk_mul_f32 v[120:121], v[120:121], v[192:193]
v_pk_mul_f32 v[122:123], v[122:123], v[194:195]
v_cvt_pk_bf16_f32 v222, v116, v117
v_cvt_pk_bf16_f32 v223, v118, v119
v_cvt_pk_bf16_f32 v224, v120, v121
v_cvt_pk_bf16_f32 v225, v122, v123
v_pk_fma_f32 v[124:125], v[164:165], v[180:181], v[124:125]
v_pk_fma_f32 v[126:127], v[166:167], v[180:181], v[126:127]
v_pk_fma_f32 v[128:129], v[168:169], v[180:181], v[128:129]
v_pk_fma_f32 v[130:131], v[170:171], v[180:181], v[130:131]
v_pk_mul_f32 v[124:125], v[124:125], v[182:183]
v_pk_mul_f32 v[126:127], v[126:127], v[182:183]
v_pk_mul_f32 v[128:129], v[128:129], v[182:183]
v_pk_mul_f32 v[130:131], v[130:131], v[182:183]
v_pk_mul_f32 v[188:189], v[124:125], v[124:125]
v_pk_mul_f32 v[190:191], v[126:127], v[126:127]
v_pk_mul_f32 v[192:193], v[128:129], v[128:129]
v_pk_mul_f32 v[194:195], v[130:131], v[130:131]
v_pk_fma_f32 v[188:189], v[188:189], v[186:187], v[184:185]
v_pk_fma_f32 v[190:191], v[190:191], v[186:187], v[184:185]
v_pk_fma_f32 v[192:193], v[192:193], v[186:187], v[184:185]
v_pk_fma_f32 v[194:195], v[194:195], v[186:187], v[184:185]
v_pk_mul_f32 v[188:189], v[188:189], v[124:125]
v_pk_mul_f32 v[190:191], v[190:191], v[126:127]
v_pk_mul_f32 v[192:193], v[192:193], v[128:129]
v_pk_mul_f32 v[194:195], v[194:195], v[130:131]
v_exp_f32 v188, v188
v_exp_f32 v189, v189
v_exp_f32 v190, v190
v_exp_f32 v191, v191
v_exp_f32 v192, v192
v_exp_f32 v193, v193
v_exp_f32 v194, v194
v_exp_f32 v195, v195
v_pk_add_f32 v[188:189], v[188:189], 1.0 op_sel_hi:[1,0]
v_pk_add_f32 v[190:191], v[190:191], 1.0 op_sel_hi:[1,0]
v_pk_add_f32 v[192:193], v[192:193], 1.0 op_sel_hi:[1,0]
v_pk_add_f32 v[194:195], v[194:195], 1.0 op_sel_hi:[1,0]
v_rcp_f32 v188, v188
v_rcp_f32 v189, v189
v_rcp_f32 v190, v190
v_rcp_f32 v191, v191
v_rcp_f32 v192, v192
v_rcp_f32 v193, v193
v_rcp_f32 v194, v194
v_rcp_f32 v195, v195
v_pk_mul_f32 v[124:125], v[124:125], v[188:189]
v_pk_mul_f32 v[126:127], v[126:127], v[190:191]
v_pk_mul_f32 v[128:129], v[128:129], v[192:193]
v_pk_mul_f32 v[130:131], v[130:131], v[194:195]
v_cvt_pk_bf16_f32 v226, v124, v125
v_cvt_pk_bf16_f32 v227, v126, v127
v_cvt_pk_bf16_f32 v228, v128, v129
v_cvt_pk_bf16_f32 v229, v130, v131
v_pk_fma_f32 v[132:133], v[172:173], v[180:181], v[132:133]
v_pk_fma_f32 v[134:135], v[174:175], v[180:181], v[134:135]
v_pk_mul_f32 v[132:133], v[132:133], v[182:183]
v_pk_mul_f32 v[134:135], v[134:135], v[182:183]
v_pk_mul_f32 v[188:189], v[132:133], v[132:133]
v_pk_mul_f32 v[190:191], v[134:135], v[134:135]
v_pk_fma_f32 v[188:189], v[188:189], v[186:187], v[184:185]
v_pk_fma_f32 v[190:191], v[190:191], v[186:187], v[184:185]
v_pk_mul_f32 v[188:189], v[188:189], v[132:133]
v_pk_mul_f32 v[190:191], v[190:191], v[134:135]
v_exp_f32 v188, v188
v_exp_f32 v189, v189
v_exp_f32 v190, v190
v_exp_f32 v191, v191
v_pk_add_f32 v[188:189], v[188:189], 1.0 op_sel_hi:[1,0]
v_pk_add_f32 v[190:191], v[190:191], 1.0 op_sel_hi:[1,0]
v_rcp_f32 v188, v188
v_rcp_f32 v189, v189
v_rcp_f32 v190, v190
v_rcp_f32 v191, v191
v_pk_mul_f32 v[132:133], v[132:133], v[188:189]
v_pk_mul_f32 v[134:135], v[134:135], v[190:191]
v_cvt_pk_bf16_f32 v230, v132, v133
v_cvt_pk_bf16_f32 v231, v134, v135
s_add_u32 s49, s49, 1024
s_cmp_eq_u32 s50, 0
s_cbranch_scc0 L_hh_1_odd
buffer_store_dwordx4 v[214:217], v4, s[24:27], s49 offen offset:0 sc1
s_add_u32 s39, s49, 4096
buffer_store_dwordx4 v[218:221], v4, s[24:27], s39 offen offset:0 sc1
s_add_u32 s39, s49, 8192
buffer_store_dwordx4 v[222:225], v4, s[24:27], s39 offen offset:0 sc1
s_add_u32 s39, s49, 12288
buffer_store_dwordx4 v[226:229], v4, s[24:27], s39 offen offset:0 sc1
s_add_u32 s39, s49, 16384
buffer_store_dwordx2 v[230:231], v4, s[24:27], s39 offen offset:0 sc1
s_branch L_hh_1_std
L_hh_1_odd:
buffer_store_dwordx2 v[214:215], v4, s[24:27], s49 offen offset:8 sc1
s_add_u32 s39, s49, 4096
buffer_store_dwordx4 v[216:219], v4, s[24:27], s39 offen offset:0 sc1
s_add_u32 s39, s49, 8192
buffer_store_dwordx4 v[220:223], v4, s[24:27], s39 offen offset:0 sc1
s_add_u32 s39, s49, 12288
buffer_store_dwordx4 v[224:227], v4, s[24:27], s39 offen offset:0 sc1
s_add_u32 s39, s49, 16384
buffer_store_dwordx4 v[228:231], v4, s[24:27], s39 offen offset:0 sc1
L_hh_1_std:
s_add_u32 m0, s34, 32768
s_add_u32 s36, s33, 32768
buffer_load_dwordx4 v4, s[24:27], s36 offen offset:0  lds
buffer_load_dwordx4 v4, s[24:27], s36 offen offset:1024  lds
buffer_load_dwordx4 v4, s[24:27], s36 offen offset:2048  lds
buffer_load_dwordx4 v4, s[24:27], s36 offen offset:3072  lds
s_add_u32 m0, s34, 49152
s_add_u32 s36, s33, 49152
buffer_load_dwordx4 v4, s[24:27], s36 offen offset:0  lds
buffer_load_dwordx4 v4, s[24:27], s36 offen offset:1024  lds
buffer_load_dwordx4 v4, s[24:27], s36 offen offset:2048  lds
buffer_load_dwordx4 v4, s[24:27], s36 offen offset:3072  lds
s_waitcnt vmcnt(8) lgkmcnt(0)
s_barrier
s_cmp_eq_u32 s3, 0
s_cbranch_scc0 L_pub_p3w
v_mov_b32 v60, s90
v_mov_b32 v61, 0
s_mov_b64 s[94:95], exec
s_mov_b64 exec, 1
buffer_store_dword v60, v61, s[24:27], s51 offen sc1
s_mov_b64 exec, s[94:95]
L_pub_p3w:
s_add_u32 m0, s34, 65536
s_add_u32 s36, s33, 65536
buffer_load_dwordx4 v4, s[24:27], s36 offen offset:0  lds
buffer_load_dwordx4 v4, s[24:27], s36 offen offset:1024  lds
buffer_load_dwordx4 v4, s[24:27], s36 offen offset:2048  lds
buffer_load_dwordx4 v4, s[24:27], s36 offen offset:3072  lds
s_add_u32 m0, s34, 81920
s_add_u32 s36, s33, 81920
buffer_load_dwordx4 v4, s[24:27], s36 offen offset:0  lds
buffer_load_dwordx4 v4, s[24:27], s36 offen offset:1024  lds
buffer_load_dwordx4 v4, s[24:27], s36 offen offset:2048  lds
buffer_load_dwordx4 v4, s[24:27], s36 offen offset:3072  lds
s_add_u32 m0, s34, 98304
s_add_u32 s36, s33, 98304
buffer_load_dwordx4 v4, s[24:27], s36 offen offset:0  lds
buffer_load_dwordx4 v4, s[24:27], s36 offen offset:1024  lds
buffer_load_dwordx4 v4, s[24:27], s36 offen offset:2048  lds
buffer_load_dwordx4 v4, s[24:27], s36 offen offset:3072  lds
s_add_u32 m0, s34, 114688
s_add_u32 s36, s33, 114688
buffer_load_dwordx4 v4, s[24:27], s36 offen offset:0  lds
buffer_load_dwordx4 v4, s[24:27], s36 offen offset:1024  lds
buffer_load_dwordx4 v4, s[24:27], s36 offen offset:2048  lds
buffer_load_dwordx4 v4, s[24:27], s36 offen offset:3072  lds
s_add_u32 m0, s34, 131072
s_add_u32 s36, s33, 131072
buffer_load_dwordx4 v4, s[24:27], s36 offen offset:0  lds
buffer_load_dwordx4 v4, s[24:27], s36 offen offset:1024  lds
buffer_load_dwordx4 v4, s[24:27], s36 offen offset:2048  lds
buffer_load_dwordx4 v4, s[24:27], s36 offen offset:3072  lds
s_branch L_k3_kernel_fin
L_k3_wo:
s_mul_i32 s33, s13, 204800
s_lshl_b32 s34, s3, 12
s_add_u32 s33, s33, s34
s_add_u32 s16, s6, 15925248
s_addc_u32 s17, s7, 0
s_mov_b32 s18, 2621440
s_mov_b32 s19, 0x20000
s_add_u32 s20, s6, 12328960
s_addc_u32 s21, s7, 0
s_mov_b32 s22, 16191488
s_mov_b32 s23, 0x20000
s_mov_b32 s24, s6
s_mov_b32 s25, s7
s_mov_b32 s26, 28520448
s_mov_b32 s27, 0x20000
s_lshl_b32 s14, s12, 7
s_add_u32 s14, s14, 28513280
s_cmp_eq_u32 s3, 0
s_cbranch_scc0 L_pd_p3o
v_and_b32 v60, 63, v0
v_min_u32 v60, 7, v60
v_add_u32 v60, 8, v60
v_lshlrev_b32 v60, 2, v60
s_mov_b32 s93, 0x40000
L_pl_p3o:
buffer_load_dword v56, v60, s[24:27], s14 offen sc1
s_waitcnt vmcnt(0)
v_cmp_eq_u32 vcc, s90, v56
s_sub_u32 s93, s93, 1
s_cmp_eq_u32 s93, 0
s_cbranch_scc1 L_pd_p3o
s_cmp_eq_u64 vcc, exec
s_cbranch_scc1 L_pd_p3o
s_sleep 2
s_branch L_pl_p3o
L_pd_p3o:
s_waitcnt vmcnt(0)
s_barrier
s_add_u32 s37, s32, 0
buffer_load_dwordx4 a[0:3], v4, s[16:19], s37 offen sc1
s_add_u32 s37, s32, 20480
buffer_load_dwordx4 a[4:7], v4, s[16:19], s37 offen sc1
s_add_u32 s37, s32, 1024
buffer_load_dwordx4 a[8:11], v4, s[16:19], s37 offen sc1
s_add_u32 s37, s32, 21504
buffer_load_dwordx4 a[12:15], v4, s[16:19], s37 offen sc1
s_add_u32 s37, s32, 2048
buffer_load_dwordx4 a[16:19], v4, s[16:19], s37 offen sc1
s_add_u32 s37, s32, 22528
buffer_load_dwordx4 a[20:23], v4, s[16:19], s37 offen sc1
s_add_u32 m0, s34, 98304
s_add_u32 s36, s33, 98304
buffer_load_dwordx4 v4, s[20:23], s36 offen offset:0 sc1 lds
buffer_load_dwordx4 v4, s[20:23], s36 offen offset:1024 sc1 lds
buffer_load_dwordx4 v4, s[20:23], s36 offen offset:2048 sc1 lds
buffer_load_dwordx4 v4, s[20:23], s36 offen offset:3072 sc1 lds
s_add_u32 m0, s34, 114688
s_add_u32 s36, s33, 114688
buffer_load_dwordx4 v4, s[20:23], s36 offen offset:0 sc1 lds
buffer_load_dwordx4 v4, s[20:23], s36 offen offset:1024 sc1 lds
buffer_load_dwordx4 v4, s[20:23], s36 offen offset:2048 sc1 lds
buffer_load_dwordx4 v4, s[20:23], s36 offen offset:3072 sc1 lds
s_add_u32 m0, s34, 131072
s_add_u32 s36, s33, 131072
buffer_load_dwordx4 v4, s[20:23], s36 offen offset:0 sc1 lds
buffer_load_dwordx4 v4, s[20:23], s36 offen offset:1024 sc1 lds
buffer_load_dwordx4 v4, s[20:23], s36 offen offset:2048 sc1 lds
buffer_load_dwordx4 v4, s[20:23], s36 offen offset:3072 sc1 lds
s_add_u32 m0, s34, 147456
s_add_u32 s36, s33, 147456
buffer_load_dwordx4 v4, s[20:23], s36 offen offset:0 sc1 lds
buffer_load_dwordx4 v4, s[20:23], s36 offen offset:1024 sc1 lds
buffer_load_dwordx4 v4, s[20:23], s36 offen offset:2048 sc1 lds
buffer_load_dwordx4 v4, s[20:23], s36 offen offset:3072 sc1 lds
ds_read_b128 a[160:163], v5 offset:0
ds_read_b128 a[164:167], v5 offset:1024
ds_read_b128 a[168:171], v5 offset:2048
ds_read_b128 a[172:175], v5 offset:3072
ds_read_b128 a[176:179], v5 offset:4096
ds_read_b128 a[180:183], v5 offset:5120
ds_read_b128 a[184:187], v5 offset:6144
ds_read_b128 a[188:191], v5 offset:7168
ds_read_b128 a[192:195], v5 offset:8192
ds_read_b128 a[196:199], v5 offset:9216
s_waitcnt vmcnt(20) lgkmcnt(9)
v_mfma_f32_16x16x32_bf16 v[64:67], a[160:163], a[0:3], 0
s_add_u32 s37, s32, 3072
buffer_load_dwordx4 a[24:27], v4, s[16:19], s37 offen sc1
v_mfma_f32_16x16x32_bf16 v[104:107], a[160:163], a[4:7], 0
ds_read_b128 a[160:163], v5 offset:10240
s_add_u32 s37, s32, 23552
buffer_load_dwordx4 a[28:31], v4, s[16:19], s37 offen sc1
s_waitcnt lgkmcnt(9)
v_mfma_f32_16x16x32_bf16 v[68:71], a[164:167], a[0:3], 0
v_mfma_f32_16x16x32_bf16 v[108:111], a[164:167], a[4:7], 0
ds_read_b128 a[164:167], v5 offset:11264
s_waitcnt lgkmcnt(9)
v_mfma_f32_16x16x32_bf16 v[72:75], a[168:171], a[0:3], 0
v_mfma_f32_16x16x32_bf16 v[112:115], a[168:171], a[4:7], 0
ds_read_b128 a[168:171], v5 offset:12288
s_waitcnt lgkmcnt(9)
v_mfma_f32_16x16x32_bf16 v[76:79], a[172:175], a[0:3], 0
v_mfma_f32_16x16x32_bf16 v[116:119], a[172:175], a[4:7], 0
ds_read_b128 a[172:175], v5 offset:13312
s_waitcnt lgkmcnt(9)
v_mfma_f32_16x16x32_bf16 v[80:83], a[176:179], a[0:3], 0
v_mfma_f32_16x16x32_bf16 v[120:123], a[176:179], a[4:7], 0
ds_read_b128 a[176:179], v5 offset:14336
s_waitcnt lgkmcnt(9)
v_mfma_f32_16x16x32_bf16 v[84:87], a[180:183], a[0:3], 0
v_mfma_f32_16x16x32_bf16 v[124:127], a[180:183], a[4:7], 0
ds_read_b128 a[180:183], v5 offset:15360
s_waitcnt lgkmcnt(9)
v_mfma_f32_16x16x32_bf16 v[88:91], a[184:187], a[0:3], 0
v_mfma_f32_16x16x32_bf16 v[128:131], a[184:187], a[4:7], 0
ds_read_b128 a[184:187], v5 offset:16384
s_waitcnt lgkmcnt(9)
v_mfma_f32_16x16x32_bf16 v[92:95], a[188:191], a[0:3], 0
v_mfma_f32_16x16x32_bf16 v[132:135], a[188:191], a[4:7], 0
ds_read_b128 a[188:191], v5 offset:17408
s_waitcnt lgkmcnt(9)
v_mfma_f32_16x16x32_bf16 v[96:99], a[192:195], a[0:3], 0
v_mfma_f32_16x16x32_bf16 v[136:139], a[192:195], a[4:7], 0
ds_read_b128 a[192:195], v5 offset:18432
s_waitcnt lgkmcnt(9)
v_mfma_f32_16x16x32_bf16 v[100:103], a[196:199], a[0:3], 0
v_mfma_f32_16x16x32_bf16 v[140:143], a[196:199], a[4:7], 0
ds_read_b128 a[196:199], v5 offset:19456
s_waitcnt vmcnt(20) lgkmcnt(9)
v_mfma_f32_16x16x32_bf16 v[64:67], a[160:163], a[8:11], v[64:67]
s_add_u32 s37, s32, 4096
buffer_load_dwordx4 a[32:35], v4, s[16:19], s37 offen sc1
v_mfma_f32_16x16x32_bf16 v[104:107], a[160:163], a[12:15], v[104:107]
ds_read_b128 a[160:163], v5 offset:20480
s_add_u32 s37, s32, 24576
buffer_load_dwordx4 a[36:39], v4, s[16:19], s37 offen sc1
s_waitcnt lgkmcnt(9)
v_mfma_f32_16x16x32_bf16 v[68:71], a[164:167], a[8:11], v[68:71]
v_mfma_f32_16x16x32_bf16 v[108:111], a[164:167], a[12:15], v[108:111]
ds_read_b128 a[164:167], v5 offset:21504
s_waitcnt lgkmcnt(9)
v_mfma_f32_16x16x32_bf16 v[72:75], a[168:171], a[8:11], v[72:75]
v_mfma_f32_16x16x32_bf16 v[112:115], a[168:171], a[12:15], v[112:115]
ds_read_b128 a[168:171], v5 offset:22528
s_waitcnt lgkmcnt(9)
v_mfma_f32_16x16x32_bf16 v[76:79], a[172:175], a[8:11], v[76:79]
v_mfma_f32_16x16x32_bf16 v[116:119], a[172:175], a[12:15], v[116:119]
ds_read_b128 a[172:175], v5 offset:23552
s_waitcnt lgkmcnt(9)
v_mfma_f32_16x16x32_bf16 v[80:83], a[176:179], a[8:11], v[80:83]
v_mfma_f32_16x16x32_bf16 v[120:123], a[176:179], a[12:15], v[120:123]
ds_read_b128 a[176:179], v5 offset:24576
s_waitcnt lgkmcnt(9)
v_mfma_f32_16x16x32_bf16 v[84:87], a[180:183], a[8:11], v[84:87]
v_mfma_f32_16x16x32_bf16 v[124:127], a[180:183], a[12:15], v[124:127]
ds_read_b128 a[180:183], v5 offset:25600
s_waitcnt lgkmcnt(9)
v_mfma_f32_16x16x32_bf16 v[88:91], a[184:187], a[8:11], v[88:91]
v_mfma_f32_16x16x32_bf16 v[128:131], a[184:187], a[12:15], v[128:131]
ds_read_b128 a[184:187], v5 offset:26624
s_waitcnt lgkmcnt(9)
v_mfma_f32_16x16x32_bf16 v[92:95], a[188:191], a[8:11], v[92:95]
v_mfma_f32_16x16x32_bf16 v[132:135], a[188:191], a[12:15], v[132:135]
ds_read_b128 a[188:191], v5 offset:27648
s_waitcnt lgkmcnt(9)
v_mfma_f32_16x16x32_bf16 v[96:99], a[192:195], a[8:11], v[96:99]
v_mfma_f32_16x16x32_bf16 v[136:139], a[192:195], a[12:15], v[136:139]
ds_read_b128 a[192:195], v5 offset:28672
s_waitcnt lgkmcnt(9)
v_mfma_f32_16x16x32_bf16 v[100:103], a[196:199], a[8:11], v[100:103]
v_mfma_f32_16x16x32_bf16 v[140:143], a[196:199], a[12:15], v[140:143]
ds_read_b128 a[196:199], v5 offset:29696
s_barrier
s_waitcnt vmcnt(20) lgkmcnt(9)
v_mfma_f32_16x16x32_bf16 v[64:67], a[160:163], a[16:19], v[64:67]
s_add_u32 s37, s32, 5120
buffer_load_dwordx4 a[40:43], v4, s[16:19], s37 offen sc1
v_mfma_f32_16x16x32_bf16 v[104:107], a[160:163], a[20:23], v[104:107]
ds_read_b128 a[160:163], v5 offset:30720
s_add_u32 s37, s32, 25600
buffer_load_dwordx4 a[44:47], v4, s[16:19], s37 offen sc1
s_waitcnt lgkmcnt(9)
v_mfma_f32_16x16x32_bf16 v[68:71], a[164:167], a[16:19], v[68:71]
s_add_u32 m0, s34, 0
s_add_u32 s36, s33, 163840
v_mfma_f32_16x16x32_bf16 v[108:111], a[164:167], a[20:23], v[108:111]
ds_read_b128 a[164:167], v5 offset:31744
buffer_load_dwordx4 v4, s[20:23], s36 offen offset:0 sc1 lds
s_waitcnt lgkmcnt(9)
v_mfma_f32_16x16x32_bf16 v[72:75], a[168:171], a[16:19], v[72:75]
buffer_load_dwordx4 v4, s[20:23], s36 offen offset:1024 sc1 lds
v_mfma_f32_16x16x32_bf16 v[112:115], a[168:171], a[20:23], v[112:115]
ds_read_b128 a[168:171], v5 offset:32768
buffer_load_dwordx4 v4, s[20:23], s36 offen offset:2048 sc1 lds
s_waitcnt lgkmcnt(9)
v_mfma_f32_16x16x32_bf16 v[76:79], a[172:175], a[16:19], v[76:79]
buffer_load_dwordx4 v4, s[20:23], s36 offen offset:3072 sc1 lds
v_mfma_f32_16x16x32_bf16 v[116:119], a[172:175], a[20:23], v[116:119]
ds_read_b128 a[172:175], v5 offset:33792
s_waitcnt lgkmcnt(9)
v_mfma_f32_16x16x32_bf16 v[80:83], a[176:179], a[16:19], v[80:83]
v_mfma_f32_16x16x32_bf16 v[120:123], a[176:179], a[20:23], v[120:123]
ds_read_b128 a[176:179], v5 offset:34816
s_waitcnt lgkmcnt(9)
v_mfma_f32_16x16x32_bf16 v[84:87], a[180:183], a[16:19], v[84:87]
v_mfma_f32_16x16x32_bf16 v[124:127], a[180:183], a[20:23], v[124:127]
ds_read_b128 a[180:183], v5 offset:35840
s_waitcnt lgkmcnt(9)
v_mfma_f32_16x16x32_bf16 v[88:91], a[184:187], a[16:19], v[88:91]
v_mfma_f32_16x16x32_bf16 v[128:131], a[184:187], a[20:23], v[128:131]
ds_read_b128 a[184:187], v5 offset:36864
s_waitcnt lgkmcnt(9)
v_mfma_f32_16x16x32_bf16 v[92:95], a[188:191], a[16:19], v[92:95]
v_mfma_f32_16x16x32_bf16 v[132:135], a[188:191], a[20:23], v[132:135]
ds_read_b128 a[188:191], v5 offset:37888
s_waitcnt lgkmcnt(9)
v_mfma_f32_16x16x32_bf16 v[96:99], a[192:195], a[16:19], v[96:99]
v_mfma_f32_16x16x32_bf16 v[136:139], a[192:195], a[20:23], v[136:139]
ds_read_b128 a[192:195], v5 offset:38912
s_waitcnt lgkmcnt(9)
v_mfma_f32_16x16x32_bf16 v[100:103], a[196:199], a[16:19], v[100:103]
v_mfma_f32_16x16x32_bf16 v[140:143], a[196:199], a[20:23], v[140:143]
ds_read_b128 a[196:199], v5 offset:39936
s_waitcnt vmcnt(8) lgkmcnt(9)
v_mfma_f32_16x16x32_bf16 v[64:67], a[160:163], a[24:27], v[64:67]
s_add_u32 s37, s32, 6144
buffer_load_dwordx4 a[48:51], v4, s[16:19], s37 offen sc1
v_mfma_f32_16x16x32_bf16 v[104:107], a[160:163], a[28:31], v[104:107]
ds_read_b128 a[160:163], v5 offset:40960
s_add_u32 s37, s32, 26624
buffer_load_dwordx4 a[52:55], v4, s[16:19], s37 offen sc1
s_waitcnt lgkmcnt(9)
v_mfma_f32_16x16x32_bf16 v[68:71], a[164:167], a[24:27], v[68:71]
v_mfma_f32_16x16x32_bf16 v[108:111], a[164:167], a[28:31], v[108:111]
ds_read_b128 a[164:167], v5 offset:41984
s_waitcnt lgkmcnt(9)
v_mfma_f32_16x16x32_bf16 v[72:75], a[168:171], a[24:27], v[72:75]
v_mfma_f32_16x16x32_bf16 v[112:115], a[168:171], a[28:31], v[112:115]
ds_read_b128 a[168:171], v5 offset:43008
s_waitcnt lgkmcnt(9)
v_mfma_f32_16x16x32_bf16 v[76:79], a[172:175], a[24:27], v[76:79]
v_mfma_f32_16x16x32_bf16 v[116:119], a[172:175], a[28:31], v[116:119]
ds_read_b128 a[172:175], v5 offset:44032
s_waitcnt lgkmcnt(9)
v_mfma_f32_16x16x32_bf16 v[80:83], a[176:179], a[24:27], v[80:83]
v_mfma_f32_16x16x32_bf16 v[120:123], a[176:179], a[28:31], v[120:123]
ds_read_b128 a[176:179], v5 offset:45056
s_waitcnt lgkmcnt(9)
v_mfma_f32_16x16x32_bf16 v[84:87], a[180:183], a[24:27], v[84:87]
v_mfma_f32_16x16x32_bf16 v[124:127], a[180:183], a[28:31], v[124:127]
ds_read_b128 a[180:183], v5 offset:46080
s_waitcnt lgkmcnt(9)
v_mfma_f32_16x16x32_bf16 v[88:91], a[184:187], a[24:27], v[88:91]
v_mfma_f32_16x16x32_bf16 v[128:131], a[184:187], a[28:31], v[128:131]
ds_read_b128 a[184:187], v5 offset:47104
s_waitcnt lgkmcnt(9)
v_mfma_f32_16x16x32_bf16 v[92:95], a[188:191], a[24:27], v[92:95]
v_mfma_f32_16x16x32_bf16 v[132:135], a[188:191], a[28:31], v[132:135]
ds_read_b128 a[188:191], v5 offset:48128
s_waitcnt lgkmcnt(9)
v_mfma_f32_16x16x32_bf16 v[96:99], a[192:195], a[24:27], v[96:99]
v_mfma_f32_16x16x32_bf16 v[136:139], a[192:195], a[28:31], v[136:139]
ds_read_b128 a[192:195], v5 offset:49152
s_waitcnt lgkmcnt(9)
v_mfma_f32_16x16x32_bf16 v[100:103], a[196:199], a[24:27], v[100:103]
v_mfma_f32_16x16x32_bf16 v[140:143], a[196:199], a[28:31], v[140:143]
ds_read_b128 a[196:199], v5 offset:50176
s_barrier
s_waitcnt vmcnt(8) lgkmcnt(9)
v_mfma_f32_16x16x32_bf16 v[64:67], a[160:163], a[32:35], v[64:67]
s_add_u32 s37, s32, 7168
buffer_load_dwordx4 a[56:59], v4, s[16:19], s37 offen sc1
v_mfma_f32_16x16x32_bf16 v[104:107], a[160:163], a[36:39], v[104:107]
ds_read_b128 a[160:163], v5 offset:51200
s_add_u32 s37, s32, 27648
buffer_load_dwordx4 a[60:63], v4, s[16:19], s37 offen sc1
s_waitcnt lgkmcnt(9)
v_mfma_f32_16x16x32_bf16 v[68:71], a[164:167], a[32:35], v[68:71]
s_add_u32 m0, s34, 16384
s_add_u32 s36, s33, 180224
v_mfma_f32_16x16x32_bf16 v[108:111], a[164:167], a[36:39], v[108:111]
ds_read_b128 a[164:167], v5 offset:52224
buffer_load_dwordx4 v4, s[20:23], s36 offen offset:0 sc1 lds
s_waitcnt lgkmcnt(9)
v_mfma_f32_16x16x32_bf16 v[72:75], a[168:171], a[32:35], v[72:75]
buffer_load_dwordx4 v4, s[20:23], s36 offen offset:1024 sc1 lds
v_mfma_f32_16x16x32_bf16 v[112:115], a[168:171], a[36:39], v[112:115]
ds_read_b128 a[168:171], v5 offset:53248
buffer_load_dwordx4 v4, s[20:23], s36 offen offset:2048 sc1 lds
s_waitcnt lgkmcnt(9)
v_mfma_f32_16x16x32_bf16 v[76:79], a[172:175], a[32:35], v[76:79]
buffer_load_dwordx4 v4, s[20:23], s36 offen offset:3072 sc1 lds
v_mfma_f32_16x16x32_bf16 v[116:119], a[172:175], a[36:39], v[116:119]
ds_read_b128 a[172:175], v5 offset:54272
s_waitcnt lgkmcnt(9)
v_mfma_f32_16x16x32_bf16 v[80:83], a[176:179], a[32:35], v[80:83]
v_mfma_f32_16x16x32_bf16 v[120:123], a[176:179], a[36:39], v[120:123]
ds_read_b128 a[176:179], v5 offset:55296
s_waitcnt lgkmcnt(9)
v_mfma_f32_16x16x32_bf16 v[84:87], a[180:183], a[32:35], v[84:87]
v_mfma_f32_16x16x32_bf16 v[124:127], a[180:183], a[36:39], v[124:127]
ds_read_b128 a[180:183], v5 offset:56320
s_waitcnt lgkmcnt(9)
v_mfma_f32_16x16x32_bf16 v[88:91], a[184:187], a[32:35], v[88:91]
v_mfma_f32_16x16x32_bf16 v[128:131], a[184:187], a[36:39], v[128:131]
ds_read_b128 a[184:187], v5 offset:57344
s_waitcnt lgkmcnt(9)
v_mfma_f32_16x16x32_bf16 v[92:95], a[188:191], a[32:35], v[92:95]
v_mfma_f32_16x16x32_bf16 v[132:135], a[188:191], a[36:39], v[132:135]
ds_read_b128 a[188:191], v5 offset:58368
s_waitcnt lgkmcnt(9)
v_mfma_f32_16x16x32_bf16 v[96:99], a[192:195], a[32:35], v[96:99]
v_mfma_f32_16x16x32_bf16 v[136:139], a[192:195], a[36:39], v[136:139]
ds_read_b128 a[192:195], v5 offset:59392
s_waitcnt lgkmcnt(9)
v_mfma_f32_16x16x32_bf16 v[100:103], a[196:199], a[32:35], v[100:103]
v_mfma_f32_16x16x32_bf16 v[140:143], a[196:199], a[36:39], v[140:143]
ds_read_b128 a[196:199], v5 offset:60416
s_barrier
s_waitcnt vmcnt(12) lgkmcnt(9)
v_mfma_f32_16x16x32_bf16 v[64:67], a[160:163], a[40:43], v[64:67]
s_add_u32 s37, s32, 8192
buffer_load_dwordx4 a[64:67], v4, s[16:19], s37 offen sc1
v_mfma_f32_16x16x32_bf16 v[104:107], a[160:163], a[44:47], v[104:107]
ds_read_b128 a[160:163], v5 offset:61440
s_add_u32 s37, s32, 28672
buffer_load_dwordx4 a[68:71], v4, s[16:19], s37 offen sc1
s_waitcnt lgkmcnt(9)
v_mfma_f32_16x16x32_bf16 v[68:71], a[164:167], a[40:43], v[68:71]
s_add_u32 m0, s34, 32768
s_add_u32 s36, s33, 196608
v_mfma_f32_16x16x32_bf16 v[108:111], a[164:167], a[44:47], v[108:111]
ds_read_b128 a[164:167], v5 offset:62464
buffer_load_dwordx4 v4, s[20:23], s36 offen offset:0 sc1 lds
s_waitcnt lgkmcnt(9)
v_mfma_f32_16x16x32_bf16 v[72:75], a[168:171], a[40:43], v[72:75]
buffer_load_dwordx4 v4, s[20:23], s36 offen offset:1024 sc1 lds
v_mfma_f32_16x16x32_bf16 v[112:115], a[168:171], a[44:47], v[112:115]
ds_read_b128 a[168:171], v5 offset:63488
buffer_load_dwordx4 v4, s[20:23], s36 offen offset:2048 sc1 lds
s_waitcnt lgkmcnt(9)
v_mfma_f32_16x16x32_bf16 v[76:79], a[172:175], a[40:43], v[76:79]
buffer_load_dwordx4 v4, s[20:23], s36 offen offset:3072 sc1 lds
v_mfma_f32_16x16x32_bf16 v[116:119], a[172:175], a[44:47], v[116:119]
ds_read_b128 a[172:175], v5 offset:64512
s_waitcnt lgkmcnt(9)
v_mfma_f32_16x16x32_bf16 v[80:83], a[176:179], a[40:43], v[80:83]
v_mfma_f32_16x16x32_bf16 v[120:123], a[176:179], a[44:47], v[120:123]
ds_read_b128 a[176:179], v6 offset:0
s_waitcnt lgkmcnt(9)
v_mfma_f32_16x16x32_bf16 v[84:87], a[180:183], a[40:43], v[84:87]
v_mfma_f32_16x16x32_bf16 v[124:127], a[180:183], a[44:47], v[124:127]
ds_read_b128 a[180:183], v6 offset:1024
s_waitcnt lgkmcnt(9)
v_mfma_f32_16x16x32_bf16 v[88:91], a[184:187], a[40:43], v[88:91]
v_mfma_f32_16x16x32_bf16 v[128:131], a[184:187], a[44:47], v[128:131]
ds_read_b128 a[184:187], v6 offset:2048
s_waitcnt lgkmcnt(9)
v_mfma_f32_16x16x32_bf16 v[92:95], a[188:191], a[40:43], v[92:95]
v_mfma_f32_16x16x32_bf16 v[132:135], a[188:191], a[44:47], v[132:135]
ds_read_b128 a[188:191], v6 offset:3072
s_waitcnt lgkmcnt(9)
v_mfma_f32_16x16x32_bf16 v[96:99], a[192:195], a[40:43], v[96:99]
v_mfma_f32_16x16x32_bf16 v[136:139], a[192:195], a[44:47], v[136:139]
ds_read_b128 a[192:195], v6 offset:4096
s_waitcnt lgkmcnt(9)
v_mfma_f32_16x16x32_bf16 v[100:103], a[196:199], a[40:43], v[100:103]
v_mfma_f32_16x16x32_bf16 v[140:143], a[196:199], a[44:47], v[140:143]
ds_read_b128 a[196:199], v6 offset:5120
s_waitcnt vmcnt(12) lgkmcnt(9)
v_mfma_f32_16x16x32_bf16 v[64:67], a[160:163], a[48:51], v[64:67]
s_add_u32 s37, s32, 9216
buffer_load_dwordx4 a[72:75], v4, s[16:19], s37 offen sc1
v_mfma_f32_16x16x32_bf16 v[104:107], a[160:163], a[52:55], v[104:107]
ds_read_b128 a[160:163], v6 offset:6144
s_add_u32 s37, s32, 29696
buffer_load_dwordx4 a[76:79], v4, s[16:19], s37 offen sc1
s_waitcnt lgkmcnt(9)
v_mfma_f32_16x16x32_bf16 v[68:71], a[164:167], a[48:51], v[68:71]
v_mfma_f32_16x16x32_bf16 v[108:111], a[164:167], a[52:55], v[108:111]
ds_read_b128 a[164:167], v6 offset:7168
s_waitcnt lgkmcnt(9)
v_mfma_f32_16x16x32_bf16 v[72:75], a[168:171], a[48:51], v[72:75]
v_mfma_f32_16x16x32_bf16 v[112:115], a[168:171], a[52:55], v[112:115]
ds_read_b128 a[168:171], v6 offset:8192
s_waitcnt lgkmcnt(9)
v_mfma_f32_16x16x32_bf16 v[76:79], a[172:175], a[48:51], v[76:79]
v_mfma_f32_16x16x32_bf16 v[116:119], a[172:175], a[52:55], v[116:119]
ds_read_b128 a[172:175], v6 offset:9216
s_waitcnt lgkmcnt(9)
v_mfma_f32_16x16x32_bf16 v[80:83], a[176:179], a[48:51], v[80:83]
v_mfma_f32_16x16x32_bf16 v[120:123], a[176:179], a[52:55], v[120:123]
ds_read_b128 a[176:179], v6 offset:10240
s_waitcnt lgkmcnt(9)
v_mfma_f32_16x16x32_bf16 v[84:87], a[180:183], a[48:51], v[84:87]
v_mfma_f32_16x16x32_bf16 v[124:127], a[180:183], a[52:55], v[124:127]
ds_read_b128 a[180:183], v6 offset:11264
s_waitcnt lgkmcnt(9)
v_mfma_f32_16x16x32_bf16 v[88:91], a[184:187], a[48:51], v[88:91]
v_mfma_f32_16x16x32_bf16 v[128:131], a[184:187], a[52:55], v[128:131]
ds_read_b128 a[184:187], v6 offset:12288
s_waitcnt lgkmcnt(9)
v_mfma_f32_16x16x32_bf16 v[92:95], a[188:191], a[48:51], v[92:95]
v_mfma_f32_16x16x32_bf16 v[132:135], a[188:191], a[52:55], v[132:135]
ds_read_b128 a[188:191], v6 offset:13312
s_waitcnt lgkmcnt(9)
v_mfma_f32_16x16x32_bf16 v[96:99], a[192:195], a[48:51], v[96:99]
v_mfma_f32_16x16x32_bf16 v[136:139], a[192:195], a[52:55], v[136:139]
ds_read_b128 a[192:195], v6 offset:14336
s_waitcnt lgkmcnt(9)
v_mfma_f32_16x16x32_bf16 v[100:103], a[196:199], a[48:51], v[100:103]
v_mfma_f32_16x16x32_bf16 v[140:143], a[196:199], a[52:55], v[140:143]
ds_read_b128 a[196:199], v6 offset:15360
s_waitcnt vmcnt(12) lgkmcnt(9)
v_mfma_f32_16x16x32_bf16 v[64:67], a[160:163], a[56:59], v[64:67]
s_add_u32 s37, s32, 10240
buffer_load_dwordx4 a[80:83], v4, s[16:19], s37 offen sc1
v_mfma_f32_16x16x32_bf16 v[104:107], a[160:163], a[60:63], v[104:107]
ds_read_b128 a[160:163], v6 offset:16384
s_add_u32 s37, s32, 30720
buffer_load_dwordx4 a[84:87], v4, s[16:19], s37 offen sc1
s_waitcnt lgkmcnt(9)
v_mfma_f32_16x16x32_bf16 v[68:71], a[164:167], a[56:59], v[68:71]
v_mfma_f32_16x16x32_bf16 v[108:111], a[164:167], a[60:63], v[108:111]
ds_read_b128 a[164:167], v6 offset:17408
s_waitcnt lgkmcnt(9)
v_mfma_f32_16x16x32_bf16 v[72:75], a[168:171], a[56:59], v[72:75]
v_mfma_f32_16x16x32_bf16 v[112:115], a[168:171], a[60:63], v[112:115]
ds_read_b128 a[168:171], v6 offset:18432
s_waitcnt lgkmcnt(9)
v_mfma_f32_16x16x32_bf16 v[76:79], a[172:175], a[56:59], v[76:79]
v_mfma_f32_16x16x32_bf16 v[116:119], a[172:175], a[60:63], v[116:119]
ds_read_b128 a[172:175], v6 offset:19456
s_waitcnt lgkmcnt(9)
v_mfma_f32_16x16x32_bf16 v[80:83], a[176:179], a[56:59], v[80:83]
v_mfma_f32_16x16x32_bf16 v[120:123], a[176:179], a[60:63], v[120:123]
ds_read_b128 a[176:179], v6 offset:20480
s_waitcnt lgkmcnt(9)
v_mfma_f32_16x16x32_bf16 v[84:87], a[180:183], a[56:59], v[84:87]
v_mfma_f32_16x16x32_bf16 v[124:127], a[180:183], a[60:63], v[124:127]
ds_read_b128 a[180:183], v6 offset:21504
s_waitcnt lgkmcnt(9)
v_mfma_f32_16x16x32_bf16 v[88:91], a[184:187], a[56:59], v[88:91]
v_mfma_f32_16x16x32_bf16 v[128:131], a[184:187], a[60:63], v[128:131]
ds_read_b128 a[184:187], v6 offset:22528
s_waitcnt lgkmcnt(9)
v_mfma_f32_16x16x32_bf16 v[92:95], a[188:191], a[56:59], v[92:95]
v_mfma_f32_16x16x32_bf16 v[132:135], a[188:191], a[60:63], v[132:135]
ds_read_b128 a[188:191], v6 offset:23552
s_waitcnt lgkmcnt(9)
v_mfma_f32_16x16x32_bf16 v[96:99], a[192:195], a[56:59], v[96:99]
v_mfma_f32_16x16x32_bf16 v[136:139], a[192:195], a[60:63], v[136:139]
ds_read_b128 a[192:195], v6 offset:24576
s_waitcnt lgkmcnt(9)
v_mfma_f32_16x16x32_bf16 v[100:103], a[196:199], a[56:59], v[100:103]
v_mfma_f32_16x16x32_bf16 v[140:143], a[196:199], a[60:63], v[140:143]
ds_read_b128 a[196:199], v6 offset:25600
s_waitcnt vmcnt(8) lgkmcnt(9)
v_mfma_f32_16x16x32_bf16 v[64:67], a[160:163], a[64:67], v[64:67]
s_add_u32 s37, s32, 11264
buffer_load_dwordx4 a[88:91], v4, s[16:19], s37 offen sc1
v_mfma_f32_16x16x32_bf16 v[104:107], a[160:163], a[68:71], v[104:107]
ds_read_b128 a[160:163], v6 offset:26624
s_add_u32 s37, s32, 31744
buffer_load_dwordx4 a[92:95], v4, s[16:19], s37 offen sc1
s_waitcnt lgkmcnt(9)
v_mfma_f32_16x16x32_bf16 v[68:71], a[164:167], a[64:67], v[68:71]
v_mfma_f32_16x16x32_bf16 v[108:111], a[164:167], a[68:71], v[108:111]
ds_read_b128 a[164:167], v6 offset:27648
s_waitcnt lgkmcnt(9)
v_mfma_f32_16x16x32_bf16 v[72:75], a[168:171], a[64:67], v[72:75]
v_mfma_f32_16x16x32_bf16 v[112:115], a[168:171], a[68:71], v[112:115]
ds_read_b128 a[168:171], v6 offset:28672
s_waitcnt lgkmcnt(9)
v_mfma_f32_16x16x32_bf16 v[76:79], a[172:175], a[64:67], v[76:79]
v_mfma_f32_16x16x32_bf16 v[116:119], a[172:175], a[68:71], v[116:119]
ds_read_b128 a[172:175], v6 offset:29696
s_waitcnt lgkmcnt(9)
v_mfma_f32_16x16x32_bf16 v[80:83], a[176:179], a[64:67], v[80:83]
v_mfma_f32_16x16x32_bf16 v[120:123], a[176:179], a[68:71], v[120:123]
ds_read_b128 a[176:179], v6 offset:30720
s_waitcnt lgkmcnt(9)
v_mfma_f32_16x16x32_bf16 v[84:87], a[180:183], a[64:67], v[84:87]
v_mfma_f32_16x16x32_bf16 v[124:127], a[180:183], a[68:71], v[124:127]
ds_read_b128 a[180:183], v6 offset:31744
s_waitcnt lgkmcnt(9)
v_mfma_f32_16x16x32_bf16 v[88:91], a[184:187], a[64:67], v[88:91]
v_mfma_f32_16x16x32_bf16 v[128:131], a[184:187], a[68:71], v[128:131]
s_barrier
ds_read_b128 a[184:187], v6 offset:32768
s_waitcnt lgkmcnt(9)
v_mfma_f32_16x16x32_bf16 v[92:95], a[188:191], a[64:67], v[92:95]
v_mfma_f32_16x16x32_bf16 v[132:135], a[188:191], a[68:71], v[132:135]
ds_read_b128 a[188:191], v6 offset:33792
s_waitcnt lgkmcnt(9)
v_mfma_f32_16x16x32_bf16 v[96:99], a[192:195], a[64:67], v[96:99]
v_mfma_f32_16x16x32_bf16 v[136:139], a[192:195], a[68:71], v[136:139]
ds_read_b128 a[192:195], v6 offset:34816
s_waitcnt lgkmcnt(9)
v_mfma_f32_16x16x32_bf16 v[100:103], a[196:199], a[64:67], v[100:103]
v_mfma_f32_16x16x32_bf16 v[140:143], a[196:199], a[68:71], v[140:143]
ds_read_b128 a[196:199], v6 offset:35840
s_waitcnt vmcnt(4) lgkmcnt(9)
v_mfma_f32_16x16x32_bf16 v[64:67], a[160:163], a[72:75], v[64:67]
s_add_u32 s37, s32, 12288
buffer_load_dwordx4 a[96:99], v4, s[16:19], s37 offen sc1
v_mfma_f32_16x16x32_bf16 v[104:107], a[160:163], a[76:79], v[104:107]
ds_read_b128 a[160:163], v6 offset:36864
s_add_u32 s37, s32, 32768
buffer_load_dwordx4 a[100:103], v4, s[16:19], s37 offen sc1
s_waitcnt lgkmcnt(9)
v_mfma_f32_16x16x32_bf16 v[68:71], a[164:167], a[72:75], v[68:71]
v_mfma_f32_16x16x32_bf16 v[108:111], a[164:167], a[76:79], v[108:111]
ds_read_b128 a[164:167], v6 offset:37888
s_waitcnt lgkmcnt(9)
v_mfma_f32_16x16x32_bf16 v[72:75], a[168:171], a[72:75], v[72:75]
v_mfma_f32_16x16x32_bf16 v[112:115], a[168:171], a[76:79], v[112:115]
ds_read_b128 a[168:171], v6 offset:38912
s_waitcnt lgkmcnt(9)
v_mfma_f32_16x16x32_bf16 v[76:79], a[172:175], a[72:75], v[76:79]
v_mfma_f32_16x16x32_bf16 v[116:119], a[172:175], a[76:79], v[116:119]
ds_read_b128 a[172:175], v6 offset:39936
s_waitcnt lgkmcnt(9)
v_mfma_f32_16x16x32_bf16 v[80:83], a[176:179], a[72:75], v[80:83]
v_mfma_f32_16x16x32_bf16 v[120:123], a[176:179], a[76:79], v[120:123]
ds_read_b128 a[176:179], v6 offset:40960
s_waitcnt lgkmcnt(9)
v_mfma_f32_16x16x32_bf16 v[84:87], a[180:183], a[72:75], v[84:87]
v_mfma_f32_16x16x32_bf16 v[124:127], a[180:183], a[76:79], v[124:127]
ds_read_b128 a[180:183], v6 offset:41984
s_waitcnt lgkmcnt(9)
v_mfma_f32_16x16x32_bf16 v[88:91], a[184:187], a[72:75], v[88:91]
v_mfma_f32_16x16x32_bf16 v[128:131], a[184:187], a[76:79], v[128:131]
ds_read_b128 a[184:187], v6 offset:43008
s_waitcnt lgkmcnt(9)
v_mfma_f32_16x16x32_bf16 v[92:95], a[188:191], a[72:75], v[92:95]
v_mfma_f32_16x16x32_bf16 v[132:135], a[188:191], a[76:79], v[132:135]
ds_read_b128 a[188:191], v6 offset:44032
s_waitcnt lgkmcnt(9)
v_mfma_f32_16x16x32_bf16 v[96:99], a[192:195], a[72:75], v[96:99]
v_mfma_f32_16x16x32_bf16 v[136:139], a[192:195], a[76:79], v[136:139]
ds_read_b128 a[192:195], v6 offset:45056
s_waitcnt lgkmcnt(9)
v_mfma_f32_16x16x32_bf16 v[100:103], a[196:199], a[72:75], v[100:103]
v_mfma_f32_16x16x32_bf16 v[140:143], a[196:199], a[76:79], v[140:143]
ds_read_b128 a[196:199], v6 offset:46080
s_waitcnt vmcnt(4) lgkmcnt(9)
v_mfma_f32_16x16x32_bf16 v[64:67], a[160:163], a[80:83], v[64:67]
s_add_u32 s37, s32, 13312
buffer_load_dwordx4 a[104:107], v4, s[16:19], s37 offen sc1
v_mfma_f32_16x16x32_bf16 v[104:107], a[160:163], a[84:87], v[104:107]
ds_read_b128 a[160:163], v6 offset:47104
s_add_u32 s37, s32, 33792
buffer_load_dwordx4 a[108:111], v4, s[16:19], s37 offen sc1
s_waitcnt lgkmcnt(9)
v_mfma_f32_16x16x32_bf16 v[68:71], a[164:167], a[80:83], v[68:71]
v_mfma_f32_16x16x32_bf16 v[108:111], a[164:167], a[84:87], v[108:111]
ds_read_b128 a[164:167], v6 offset:48128
s_waitcnt lgkmcnt(9)
v_mfma_f32_16x16x32_bf16 v[72:75], a[168:171], a[80:83], v[72:75]
v_mfma_f32_16x16x32_bf16 v[112:115], a[168:171], a[84:87], v[112:115]
s_barrier
ds_read_b128 a[168:171], v6 offset:49152
s_waitcnt lgkmcnt(9)
v_mfma_f32_16x16x32_bf16 v[76:79], a[172:175], a[80:83], v[76:79]
v_mfma_f32_16x16x32_bf16 v[116:119], a[172:175], a[84:87], v[116:119]
ds_read_b128 a[172:175], v6 offset:50176
s_waitcnt lgkmcnt(9)
v_mfma_f32_16x16x32_bf16 v[80:83], a[176:179], a[80:83], v[80:83]
v_mfma_f32_16x16x32_bf16 v[120:123], a[176:179], a[84:87], v[120:123]
ds_read_b128 a[176:179], v6 offset:51200
s_waitcnt lgkmcnt(9)
v_mfma_f32_16x16x32_bf16 v[84:87], a[180:183], a[80:83], v[84:87]
v_mfma_f32_16x16x32_bf16 v[124:127], a[180:183], a[84:87], v[124:127]
ds_read_b128 a[180:183], v6 offset:52224
s_waitcnt lgkmcnt(9)
v_mfma_f32_16x16x32_bf16 v[88:91], a[184:187], a[80:83], v[88:91]
v_mfma_f32_16x16x32_bf16 v[128:131], a[184:187], a[84:87], v[128:131]
ds_read_b128 a[184:187], v6 offset:53248
s_waitcnt lgkmcnt(9)
v_mfma_f32_16x16x32_bf16 v[92:95], a[188:191], a[80:83], v[92:95]
v_mfma_f32_16x16x32_bf16 v[132:135], a[188:191], a[84:87], v[132:135]
ds_read_b128 a[188:191], v6 offset:54272
s_waitcnt lgkmcnt(9)
v_mfma_f32_16x16x32_bf16 v[96:99], a[192:195], a[80:83], v[96:99]
v_mfma_f32_16x16x32_bf16 v[136:139], a[192:195], a[84:87], v[136:139]
ds_read_b128 a[192:195], v6 offset:55296
s_waitcnt lgkmcnt(9)
v_mfma_f32_16x16x32_bf16 v[100:103], a[196:199], a[80:83], v[100:103]
v_mfma_f32_16x16x32_bf16 v[140:143], a[196:199], a[84:87], v[140:143]
ds_read_b128 a[196:199], v6 offset:56320
s_waitcnt vmcnt(4) lgkmcnt(9)
v_mfma_f32_16x16x32_bf16 v[64:67], a[160:163], a[88:91], v[64:67]
s_add_u32 s37, s32, 14336
buffer_load_dwordx4 a[112:115], v4, s[16:19], s37 offen sc1
v_mfma_f32_16x16x32_bf16 v[104:107], a[160:163], a[92:95], v[104:107]
ds_read_b128 a[160:163], v6 offset:57344
s_add_u32 s37, s32, 34816
buffer_load_dwordx4 a[116:119], v4, s[16:19], s37 offen sc1
s_waitcnt lgkmcnt(9)
v_mfma_f32_16x16x32_bf16 v[68:71], a[164:167], a[88:91], v[68:71]
v_mfma_f32_16x16x32_bf16 v[108:111], a[164:167], a[92:95], v[108:111]
ds_read_b128 a[164:167], v6 offset:58368
s_waitcnt lgkmcnt(9)
v_mfma_f32_16x16x32_bf16 v[72:75], a[168:171], a[88:91], v[72:75]
v_mfma_f32_16x16x32_bf16 v[112:115], a[168:171], a[92:95], v[112:115]
ds_read_b128 a[168:171], v6 offset:59392
s_waitcnt lgkmcnt(9)
v_mfma_f32_16x16x32_bf16 v[76:79], a[172:175], a[88:91], v[76:79]
v_mfma_f32_16x16x32_bf16 v[116:119], a[172:175], a[92:95], v[116:119]
ds_read_b128 a[172:175], v6 offset:60416
s_waitcnt lgkmcnt(9)
v_mfma_f32_16x16x32_bf16 v[80:83], a[176:179], a[88:91], v[80:83]
v_mfma_f32_16x16x32_bf16 v[120:123], a[176:179], a[92:95], v[120:123]
ds_read_b128 a[176:179], v6 offset:61440
s_waitcnt lgkmcnt(9)
v_mfma_f32_16x16x32_bf16 v[84:87], a[180:183], a[88:91], v[84:87]
v_mfma_f32_16x16x32_bf16 v[124:127], a[180:183], a[92:95], v[124:127]
ds_read_b128 a[180:183], v6 offset:62464
s_waitcnt lgkmcnt(9)
v_mfma_f32_16x16x32_bf16 v[88:91], a[184:187], a[88:91], v[88:91]
v_mfma_f32_16x16x32_bf16 v[128:131], a[184:187], a[92:95], v[128:131]
ds_read_b128 a[184:187], v6 offset:63488
s_waitcnt lgkmcnt(9)
v_mfma_f32_16x16x32_bf16 v[92:95], a[188:191], a[88:91], v[92:95]
v_mfma_f32_16x16x32_bf16 v[132:135], a[188:191], a[92:95], v[132:135]
ds_read_b128 a[188:191], v6 offset:64512
s_waitcnt lgkmcnt(9)
v_mfma_f32_16x16x32_bf16 v[96:99], a[192:195], a[88:91], v[96:99]
v_mfma_f32_16x16x32_bf16 v[136:139], a[192:195], a[92:95], v[136:139]
s_barrier
ds_read_b128 a[192:195], v7 offset:0
s_waitcnt lgkmcnt(9)
v_mfma_f32_16x16x32_bf16 v[100:103], a[196:199], a[88:91], v[100:103]
v_mfma_f32_16x16x32_bf16 v[140:143], a[196:199], a[92:95], v[140:143]
ds_read_b128 a[196:199], v7 offset:1024
s_waitcnt vmcnt(4) lgkmcnt(9)
v_mfma_f32_16x16x32_bf16 v[64:67], a[160:163], a[96:99], v[64:67]
s_add_u32 s37, s32, 15360
buffer_load_dwordx4 a[120:123], v4, s[16:19], s37 offen sc1
v_mfma_f32_16x16x32_bf16 v[104:107], a[160:163], a[100:103], v[104:107]
ds_read_b128 a[160:163], v7 offset:2048
s_add_u32 s37, s32, 35840
buffer_load_dwordx4 a[124:127], v4, s[16:19], s37 offen sc1
s_waitcnt lgkmcnt(9)
v_mfma_f32_16x16x32_bf16 v[68:71], a[164:167], a[96:99], v[68:71]
v_mfma_f32_16x16x32_bf16 v[108:111], a[164:167], a[100:103], v[108:111]
ds_read_b128 a[164:167], v7 offset:3072
s_waitcnt lgkmcnt(9)
v_mfma_f32_16x16x32_bf16 v[72:75], a[168:171], a[96:99], v[72:75]
v_mfma_f32_16x16x32_bf16 v[112:115], a[168:171], a[100:103], v[112:115]
ds_read_b128 a[168:171], v7 offset:4096
s_waitcnt lgkmcnt(9)
v_mfma_f32_16x16x32_bf16 v[76:79], a[172:175], a[96:99], v[76:79]
v_mfma_f32_16x16x32_bf16 v[116:119], a[172:175], a[100:103], v[116:119]
ds_read_b128 a[172:175], v7 offset:5120
s_waitcnt lgkmcnt(9)
v_mfma_f32_16x16x32_bf16 v[80:83], a[176:179], a[96:99], v[80:83]
v_mfma_f32_16x16x32_bf16 v[120:123], a[176:179], a[100:103], v[120:123]
ds_read_b128 a[176:179], v7 offset:6144
s_waitcnt lgkmcnt(9)
v_mfma_f32_16x16x32_bf16 v[84:87], a[180:183], a[96:99], v[84:87]
v_mfma_f32_16x16x32_bf16 v[124:127], a[180:183], a[100:103], v[124:127]
ds_read_b128 a[180:183], v7 offset:7168
s_waitcnt lgkmcnt(9)
v_mfma_f32_16x16x32_bf16 v[88:91], a[184:187], a[96:99], v[88:91]
v_mfma_f32_16x16x32_bf16 v[128:131], a[184:187], a[100:103], v[128:131]
ds_read_b128 a[184:187], v7 offset:8192
s_waitcnt lgkmcnt(9)
v_mfma_f32_16x16x32_bf16 v[92:95], a[188:191], a[96:99], v[92:95]
v_mfma_f32_16x16x32_bf16 v[132:135], a[188:191], a[100:103], v[132:135]
ds_read_b128 a[188:191], v7 offset:9216
s_waitcnt lgkmcnt(9)
v_mfma_f32_16x16x32_bf16 v[96:99], a[192:195], a[96:99], v[96:99]
v_mfma_f32_16x16x32_bf16 v[136:139], a[192:195], a[100:103], v[136:139]
ds_read_b128 a[192:195], v7 offset:10240
s_waitcnt lgkmcnt(9)
v_mfma_f32_16x16x32_bf16 v[100:103], a[196:199], a[96:99], v[100:103]
v_mfma_f32_16x16x32_bf16 v[140:143], a[196:199], a[100:103], v[140:143]
ds_read_b128 a[196:199], v7 offset:11264
s_waitcnt vmcnt(4) lgkmcnt(9)
v_mfma_f32_16x16x32_bf16 v[64:67], a[160:163], a[104:107], v[64:67]
s_add_u32 s37, s32, 16384
buffer_load_dwordx4 a[128:131], v4, s[16:19], s37 offen sc1
v_mfma_f32_16x16x32_bf16 v[104:107], a[160:163], a[108:111], v[104:107]
ds_read_b128 a[160:163], v7 offset:12288
s_add_u32 s37, s32, 36864
buffer_load_dwordx4 a[132:135], v4, s[16:19], s37 offen sc1
s_waitcnt lgkmcnt(9)
v_mfma_f32_16x16x32_bf16 v[68:71], a[164:167], a[104:107], v[68:71]
v_mfma_f32_16x16x32_bf16 v[108:111], a[164:167], a[108:111], v[108:111]
ds_read_b128 a[164:167], v7 offset:13312
s_waitcnt lgkmcnt(9)
v_mfma_f32_16x16x32_bf16 v[72:75], a[168:171], a[104:107], v[72:75]
v_mfma_f32_16x16x32_bf16 v[112:115], a[168:171], a[108:111], v[112:115]
ds_read_b128 a[168:171], v7 offset:14336
s_waitcnt lgkmcnt(9)
v_mfma_f32_16x16x32_bf16 v[76:79], a[172:175], a[104:107], v[76:79]
v_mfma_f32_16x16x32_bf16 v[116:119], a[172:175], a[108:111], v[116:119]
ds_read_b128 a[172:175], v7 offset:15360
s_waitcnt lgkmcnt(9)
v_mfma_f32_16x16x32_bf16 v[80:83], a[176:179], a[104:107], v[80:83]
v_mfma_f32_16x16x32_bf16 v[120:123], a[176:179], a[108:111], v[120:123]
s_barrier
ds_read_b128 a[176:179], v7 offset:16384
s_waitcnt lgkmcnt(9)
v_mfma_f32_16x16x32_bf16 v[84:87], a[180:183], a[104:107], v[84:87]
v_mfma_f32_16x16x32_bf16 v[124:127], a[180:183], a[108:111], v[124:127]
ds_read_b128 a[180:183], v7 offset:17408
s_waitcnt lgkmcnt(9)
v_mfma_f32_16x16x32_bf16 v[88:91], a[184:187], a[104:107], v[88:91]
v_mfma_f32_16x16x32_bf16 v[128:131], a[184:187], a[108:111], v[128:131]
ds_read_b128 a[184:187], v7 offset:18432
s_waitcnt lgkmcnt(9)
v_mfma_f32_16x16x32_bf16 v[92:95], a[188:191], a[104:107], v[92:95]
v_mfma_f32_16x16x32_bf16 v[132:135], a[188:191], a[108:111], v[132:135]
ds_read_b128 a[188:191], v7 offset:19456
s_waitcnt lgkmcnt(9)
v_mfma_f32_16x16x32_bf16 v[96:99], a[192:195], a[104:107], v[96:99]
v_mfma_f32_16x16x32_bf16 v[136:139], a[192:195], a[108:111], v[136:139]
ds_read_b128 a[192:195], v7 offset:20480
s_waitcnt lgkmcnt(9)
v_mfma_f32_16x16x32_bf16 v[100:103], a[196:199], a[104:107], v[100:103]
v_mfma_f32_16x16x32_bf16 v[140:143], a[196:199], a[108:111], v[140:143]
ds_read_b128 a[196:199], v7 offset:21504
s_waitcnt vmcnt(4) lgkmcnt(9)
v_mfma_f32_16x16x32_bf16 v[64:67], a[160:163], a[112:115], v[64:67]
s_add_u32 s37, s32, 17408
buffer_load_dwordx4 a[136:139], v4, s[16:19], s37 offen sc1
v_mfma_f32_16x16x32_bf16 v[104:107], a[160:163], a[116:119], v[104:107]
ds_read_b128 a[160:163], v7 offset:22528
s_add_u32 s37, s32, 37888
buffer_load_dwordx4 a[140:143], v4, s[16:19], s37 offen sc1
s_waitcnt lgkmcnt(9)
v_mfma_f32_16x16x32_bf16 v[68:71], a[164:167], a[112:115], v[68:71]
v_mfma_f32_16x16x32_bf16 v[108:111], a[164:167], a[116:119], v[108:111]
ds_read_b128 a[164:167], v7 offset:23552
s_waitcnt lgkmcnt(9)
v_mfma_f32_16x16x32_bf16 v[72:75], a[168:171], a[112:115], v[72:75]
v_mfma_f32_16x16x32_bf16 v[112:115], a[168:171], a[116:119], v[112:115]
ds_read_b128 a[168:171], v7 offset:24576
s_waitcnt lgkmcnt(9)
v_mfma_f32_16x16x32_bf16 v[76:79], a[172:175], a[112:115], v[76:79]
v_mfma_f32_16x16x32_bf16 v[116:119], a[172:175], a[116:119], v[116:119]
ds_read_b128 a[172:175], v7 offset:25600
s_waitcnt lgkmcnt(9)
v_mfma_f32_16x16x32_bf16 v[80:83], a[176:179], a[112:115], v[80:83]
v_mfma_f32_16x16x32_bf16 v[120:123], a[176:179], a[116:119], v[120:123]
ds_read_b128 a[176:179], v7 offset:26624
s_waitcnt lgkmcnt(9)
v_mfma_f32_16x16x32_bf16 v[84:87], a[180:183], a[112:115], v[84:87]
v_mfma_f32_16x16x32_bf16 v[124:127], a[180:183], a[116:119], v[124:127]
ds_read_b128 a[180:183], v7 offset:27648
s_waitcnt lgkmcnt(9)
v_mfma_f32_16x16x32_bf16 v[88:91], a[184:187], a[112:115], v[88:91]
v_mfma_f32_16x16x32_bf16 v[128:131], a[184:187], a[116:119], v[128:131]
ds_read_b128 a[184:187], v7 offset:28672
s_waitcnt lgkmcnt(9)
v_mfma_f32_16x16x32_bf16 v[92:95], a[188:191], a[112:115], v[92:95]
v_mfma_f32_16x16x32_bf16 v[132:135], a[188:191], a[116:119], v[132:135]
ds_read_b128 a[188:191], v7 offset:29696
s_waitcnt lgkmcnt(9)
v_mfma_f32_16x16x32_bf16 v[96:99], a[192:195], a[112:115], v[96:99]
v_mfma_f32_16x16x32_bf16 v[136:139], a[192:195], a[116:119], v[136:139]
ds_read_b128 a[192:195], v7 offset:30720
s_waitcnt lgkmcnt(9)
v_mfma_f32_16x16x32_bf16 v[100:103], a[196:199], a[112:115], v[100:103]
v_mfma_f32_16x16x32_bf16 v[140:143], a[196:199], a[116:119], v[140:143]
ds_read_b128 a[196:199], v7 offset:31744
s_waitcnt vmcnt(4) lgkmcnt(9)
v_mfma_f32_16x16x32_bf16 v[64:67], a[160:163], a[120:123], v[64:67]
s_add_u32 s37, s32, 18432
buffer_load_dwordx4 a[144:147], v4, s[16:19], s37 offen sc1
v_mfma_f32_16x16x32_bf16 v[104:107], a[160:163], a[124:127], v[104:107]
s_barrier
ds_read_b128 a[160:163], v5 offset:0
s_add_u32 s37, s32, 38912
buffer_load_dwordx4 a[148:151], v4, s[16:19], s37 offen sc1
s_waitcnt lgkmcnt(9)
v_mfma_f32_16x16x32_bf16 v[68:71], a[164:167], a[120:123], v[68:71]
v_mfma_f32_16x16x32_bf16 v[108:111], a[164:167], a[124:127], v[108:111]
ds_read_b128 a[164:167], v5 offset:1024
s_waitcnt lgkmcnt(9)
v_mfma_f32_16x16x32_bf16 v[72:75], a[168:171], a[120:123], v[72:75]
v_mfma_f32_16x16x32_bf16 v[112:115], a[168:171], a[124:127], v[112:115]
ds_read_b128 a[168:171], v5 offset:2048
s_waitcnt lgkmcnt(9)
v_mfma_f32_16x16x32_bf16 v[76:79], a[172:175], a[120:123], v[76:79]
v_mfma_f32_16x16x32_bf16 v[116:119], a[172:175], a[124:127], v[116:119]
ds_read_b128 a[172:175], v5 offset:3072
s_waitcnt lgkmcnt(9)
v_mfma_f32_16x16x32_bf16 v[80:83], a[176:179], a[120:123], v[80:83]
v_mfma_f32_16x16x32_bf16 v[120:123], a[176:179], a[124:127], v[120:123]
ds_read_b128 a[176:179], v5 offset:4096
s_waitcnt lgkmcnt(9)
v_mfma_f32_16x16x32_bf16 v[84:87], a[180:183], a[120:123], v[84:87]
v_mfma_f32_16x16x32_bf16 v[124:127], a[180:183], a[124:127], v[124:127]
ds_read_b128 a[180:183], v5 offset:5120
s_waitcnt lgkmcnt(9)
v_mfma_f32_16x16x32_bf16 v[88:91], a[184:187], a[120:123], v[88:91]
v_mfma_f32_16x16x32_bf16 v[128:131], a[184:187], a[124:127], v[128:131]
ds_read_b128 a[184:187], v5 offset:6144
s_waitcnt lgkmcnt(9)
v_mfma_f32_16x16x32_bf16 v[92:95], a[188:191], a[120:123], v[92:95]
v_mfma_f32_16x16x32_bf16 v[132:135], a[188:191], a[124:127], v[132:135]
ds_read_b128 a[188:191], v5 offset:7168
s_waitcnt lgkmcnt(9)
v_mfma_f32_16x16x32_bf16 v[96:99], a[192:195], a[120:123], v[96:99]
v_mfma_f32_16x16x32_bf16 v[136:139], a[192:195], a[124:127], v[136:139]
ds_read_b128 a[192:195], v5 offset:8192
s_waitcnt lgkmcnt(9)
v_mfma_f32_16x16x32_bf16 v[100:103], a[196:199], a[120:123], v[100:103]
v_mfma_f32_16x16x32_bf16 v[140:143], a[196:199], a[124:127], v[140:143]
ds_read_b128 a[196:199], v5 offset:9216
s_waitcnt vmcnt(4) lgkmcnt(9)
v_mfma_f32_16x16x32_bf16 v[64:67], a[160:163], a[128:131], v[64:67]
s_add_u32 s37, s32, 19456
buffer_load_dwordx4 a[152:155], v4, s[16:19], s37 offen sc1
v_mfma_f32_16x16x32_bf16 v[104:107], a[160:163], a[132:135], v[104:107]
ds_read_b128 a[160:163], v5 offset:10240
s_add_u32 s37, s32, 39936
buffer_load_dwordx4 a[156:159], v4, s[16:19], s37 offen sc1
s_waitcnt lgkmcnt(9)
v_mfma_f32_16x16x32_bf16 v[68:71], a[164:167], a[128:131], v[68:71]
v_mfma_f32_16x16x32_bf16 v[108:111], a[164:167], a[132:135], v[108:111]
ds_read_b128 a[164:167], v5 offset:11264
s_waitcnt lgkmcnt(9)
v_mfma_f32_16x16x32_bf16 v[72:75], a[168:171], a[128:131], v[72:75]
v_mfma_f32_16x16x32_bf16 v[112:115], a[168:171], a[132:135], v[112:115]
ds_read_b128 a[168:171], v5 offset:12288
s_waitcnt lgkmcnt(9)
v_mfma_f32_16x16x32_bf16 v[76:79], a[172:175], a[128:131], v[76:79]
v_mfma_f32_16x16x32_bf16 v[116:119], a[172:175], a[132:135], v[116:119]
ds_read_b128 a[172:175], v5 offset:13312
s_waitcnt lgkmcnt(9)
v_mfma_f32_16x16x32_bf16 v[80:83], a[176:179], a[128:131], v[80:83]
v_mfma_f32_16x16x32_bf16 v[120:123], a[176:179], a[132:135], v[120:123]
ds_read_b128 a[176:179], v5 offset:14336
s_waitcnt lgkmcnt(9)
v_mfma_f32_16x16x32_bf16 v[84:87], a[180:183], a[128:131], v[84:87]
v_mfma_f32_16x16x32_bf16 v[124:127], a[180:183], a[132:135], v[124:127]
ds_read_b128 a[180:183], v5 offset:15360
s_waitcnt lgkmcnt(9)
v_mfma_f32_16x16x32_bf16 v[88:91], a[184:187], a[128:131], v[88:91]
v_mfma_f32_16x16x32_bf16 v[128:131], a[184:187], a[132:135], v[128:131]
s_barrier
ds_read_b128 a[184:187], v5 offset:16384
s_waitcnt lgkmcnt(9)
v_mfma_f32_16x16x32_bf16 v[92:95], a[188:191], a[128:131], v[92:95]
v_mfma_f32_16x16x32_bf16 v[132:135], a[188:191], a[132:135], v[132:135]
ds_read_b128 a[188:191], v5 offset:17408
s_waitcnt lgkmcnt(9)
v_mfma_f32_16x16x32_bf16 v[96:99], a[192:195], a[128:131], v[96:99]
v_mfma_f32_16x16x32_bf16 v[136:139], a[192:195], a[132:135], v[136:139]
ds_read_b128 a[192:195], v5 offset:18432
s_waitcnt lgkmcnt(9)
v_mfma_f32_16x16x32_bf16 v[100:103], a[196:199], a[128:131], v[100:103]
v_mfma_f32_16x16x32_bf16 v[140:143], a[196:199], a[132:135], v[140:143]
ds_read_b128 a[196:199], v5 offset:19456
s_waitcnt vmcnt(4) lgkmcnt(9)
v_mfma_f32_16x16x32_bf16 v[64:67], a[160:163], a[136:139], v[64:67]
v_mfma_f32_16x16x32_bf16 v[104:107], a[160:163], a[140:143], v[104:107]
ds_read_b128 a[160:163], v5 offset:20480
s_waitcnt lgkmcnt(9)
v_mfma_f32_16x16x32_bf16 v[68:71], a[164:167], a[136:139], v[68:71]
v_mfma_f32_16x16x32_bf16 v[108:111], a[164:167], a[140:143], v[108:111]
ds_read_b128 a[164:167], v5 offset:21504
s_waitcnt lgkmcnt(9)
v_mfma_f32_16x16x32_bf16 v[72:75], a[168:171], a[136:139], v[72:75]
v_mfma_f32_16x16x32_bf16 v[112:115], a[168:171], a[140:143], v[112:115]
ds_read_b128 a[168:171], v5 offset:22528
s_waitcnt lgkmcnt(9)
v_mfma_f32_16x16x32_bf16 v[76:79], a[172:175], a[136:139], v[76:79]
v_mfma_f32_16x16x32_bf16 v[116:119], a[172:175], a[140:143], v[116:119]
ds_read_b128 a[172:175], v5 offset:23552
s_waitcnt lgkmcnt(9)
v_mfma_f32_16x16x32_bf16 v[80:83], a[176:179], a[136:139], v[80:83]
v_mfma_f32_16x16x32_bf16 v[120:123], a[176:179], a[140:143], v[120:123]
ds_read_b128 a[176:179], v5 offset:24576
s_waitcnt lgkmcnt(9)
v_mfma_f32_16x16x32_bf16 v[84:87], a[180:183], a[136:139], v[84:87]
v_mfma_f32_16x16x32_bf16 v[124:127], a[180:183], a[140:143], v[124:127]
ds_read_b128 a[180:183], v5 offset:25600
s_waitcnt lgkmcnt(9)
v_mfma_f32_16x16x32_bf16 v[88:91], a[184:187], a[136:139], v[88:91]
v_mfma_f32_16x16x32_bf16 v[128:131], a[184:187], a[140:143], v[128:131]
ds_read_b128 a[184:187], v5 offset:26624
s_waitcnt lgkmcnt(9)
v_mfma_f32_16x16x32_bf16 v[92:95], a[188:191], a[136:139], v[92:95]
v_mfma_f32_16x16x32_bf16 v[132:135], a[188:191], a[140:143], v[132:135]
ds_read_b128 a[188:191], v5 offset:27648
s_waitcnt lgkmcnt(9)
v_mfma_f32_16x16x32_bf16 v[96:99], a[192:195], a[136:139], v[96:99]
v_mfma_f32_16x16x32_bf16 v[136:139], a[192:195], a[140:143], v[136:139]
ds_read_b128 a[192:195], v5 offset:28672
s_waitcnt lgkmcnt(9)
v_mfma_f32_16x16x32_bf16 v[100:103], a[196:199], a[136:139], v[100:103]
v_mfma_f32_16x16x32_bf16 v[140:143], a[196:199], a[140:143], v[140:143]
ds_read_b128 a[196:199], v5 offset:29696
s_waitcnt vmcnt(2) lgkmcnt(9)
v_mfma_f32_16x16x32_bf16 v[64:67], a[160:163], a[144:147], v[64:67]
v_mfma_f32_16x16x32_bf16 v[104:107], a[160:163], a[148:151], v[104:107]
ds_read_b128 a[160:163], v5 offset:30720
s_waitcnt lgkmcnt(9)
v_mfma_f32_16x16x32_bf16 v[68:71], a[164:167], a[144:147], v[68:71]
v_mfma_f32_16x16x32_bf16 v[108:111], a[164:167], a[148:151], v[108:111]
ds_read_b128 a[164:167], v5 offset:31744
s_waitcnt lgkmcnt(9)
v_mfma_f32_16x16x32_bf16 v[72:75], a[168:171], a[144:147], v[72:75]
v_mfma_f32_16x16x32_bf16 v[112:115], a[168:171], a[148:151], v[112:115]
s_barrier
ds_read_b128 a[168:171], v5 offset:32768
s_waitcnt lgkmcnt(9)
v_mfma_f32_16x16x32_bf16 v[76:79], a[172:175], a[144:147], v[76:79]
v_mfma_f32_16x16x32_bf16 v[116:119], a[172:175], a[148:151], v[116:119]
ds_read_b128 a[172:175], v5 offset:33792
s_waitcnt lgkmcnt(9)
v_mfma_f32_16x16x32_bf16 v[80:83], a[176:179], a[144:147], v[80:83]
v_mfma_f32_16x16x32_bf16 v[120:123], a[176:179], a[148:151], v[120:123]
ds_read_b128 a[176:179], v5 offset:34816
s_waitcnt lgkmcnt(9)
v_mfma_f32_16x16x32_bf16 v[84:87], a[180:183], a[144:147], v[84:87]
v_mfma_f32_16x16x32_bf16 v[124:127], a[180:183], a[148:151], v[124:127]
ds_read_b128 a[180:183], v5 offset:35840
s_waitcnt lgkmcnt(9)
v_mfma_f32_16x16x32_bf16 v[88:91], a[184:187], a[144:147], v[88:91]
v_mfma_f32_16x16x32_bf16 v[128:131], a[184:187], a[148:151], v[128:131]
ds_read_b128 a[184:187], v5 offset:36864
s_waitcnt lgkmcnt(9)
v_mfma_f32_16x16x32_bf16 v[92:95], a[188:191], a[144:147], v[92:95]
v_mfma_f32_16x16x32_bf16 v[132:135], a[188:191], a[148:151], v[132:135]
ds_read_b128 a[188:191], v5 offset:37888
s_waitcnt lgkmcnt(9)
v_mfma_f32_16x16x32_bf16 v[96:99], a[192:195], a[144:147], v[96:99]
v_mfma_f32_16x16x32_bf16 v[136:139], a[192:195], a[148:151], v[136:139]
ds_read_b128 a[192:195], v5 offset:38912
s_waitcnt lgkmcnt(9)
v_mfma_f32_16x16x32_bf16 v[100:103], a[196:199], a[144:147], v[100:103]
v_mfma_f32_16x16x32_bf16 v[140:143], a[196:199], a[148:151], v[140:143]
ds_read_b128 a[196:199], v5 offset:39936
s_waitcnt vmcnt(0) lgkmcnt(9)
v_mfma_f32_16x16x32_bf16 v[64:67], a[160:163], a[152:155], v[64:67]
v_mfma_f32_16x16x32_bf16 v[104:107], a[160:163], a[156:159], v[104:107]
s_waitcnt lgkmcnt(8)
v_mfma_f32_16x16x32_bf16 v[68:71], a[164:167], a[152:155], v[68:71]
v_mfma_f32_16x16x32_bf16 v[108:111], a[164:167], a[156:159], v[108:111]
s_waitcnt lgkmcnt(7)
v_mfma_f32_16x16x32_bf16 v[72:75], a[168:171], a[152:155], v[72:75]
v_mfma_f32_16x16x32_bf16 v[112:115], a[168:171], a[156:159], v[112:115]
s_waitcnt lgkmcnt(6)
v_mfma_f32_16x16x32_bf16 v[76:79], a[172:175], a[152:155], v[76:79]
v_mfma_f32_16x16x32_bf16 v[116:119], a[172:175], a[156:159], v[116:119]
s_waitcnt lgkmcnt(5)
v_mfma_f32_16x16x32_bf16 v[80:83], a[176:179], a[152:155], v[80:83]
v_mfma_f32_16x16x32_bf16 v[120:123], a[176:179], a[156:159], v[120:123]
s_waitcnt lgkmcnt(4)
v_mfma_f32_16x16x32_bf16 v[84:87], a[180:183], a[152:155], v[84:87]
v_mfma_f32_16x16x32_bf16 v[124:127], a[180:183], a[156:159], v[124:127]
s_waitcnt lgkmcnt(3)
v_mfma_f32_16x16x32_bf16 v[88:91], a[184:187], a[152:155], v[88:91]
v_mfma_f32_16x16x32_bf16 v[128:131], a[184:187], a[156:159], v[128:131]
s_waitcnt lgkmcnt(2)
v_mfma_f32_16x16x32_bf16 v[92:95], a[188:191], a[152:155], v[92:95]
v_mfma_f32_16x16x32_bf16 v[132:135], a[188:191], a[156:159], v[132:135]
s_waitcnt lgkmcnt(1)
v_mfma_f32_16x16x32_bf16 v[96:99], a[192:195], a[152:155], v[96:99]
v_mfma_f32_16x16x32_bf16 v[136:139], a[192:195], a[156:159], v[136:139]
s_waitcnt lgkmcnt(0)
v_mfma_f32_16x16x32_bf16 v[100:103], a[196:199], a[152:155], v[100:103]
v_mfma_f32_16x16x32_bf16 v[140:143], a[196:199], a[156:159], v[140:143]
s_barrier
s_and_b32 s33, s10, 1
s_lshl_b32 s33, s33, 2
s_and_b32 s34, s11, 3
s_add_u32 s33, s33, s34
s_mul_i32 s33, s33, 276480
s_add_u32 s33, s33, 10117120
s_lshl_b32 s34, s3, 12
s_add_u32 s33, s33, s34
s_lshl_b32 s51, s12, 7
s_lshl_b32 s15, s13, 2
s_add_u32 s51, s51, s15
s_add_u32 s51, s51, 28515376
s_mul_i32 s14, s48, 20480
s_mul_i32 s15, s13, 5120
s_add_u32 s14, s14, s15
s_add_u32 s14, s14, 25624576
s_nop 4
v_cvt_pk_bf16_f32 v150, v64, v65
v_cvt_pk_bf16_f32 v151, v66, v67
v_cvt_pk_bf16_f32 v152, v68, v69
v_cvt_pk_bf16_f32 v153, v70, v71
s_add_u32 s15, s14, 0
buffer_store_dwordx4 v[150:153], v4, s[24:27], s15 offen sc1
v_cvt_pk_bf16_f32 v154, v72, v73
v_cvt_pk_bf16_f32 v155, v74, v75
v_cvt_pk_bf16_f32 v156, v76, v77
v_cvt_pk_bf16_f32 v157, v78, v79
s_add_u32 s15, s14, 1024
buffer_store_dwordx4 v[154:157], v4, s[24:27], s15 offen sc1
v_cvt_pk_bf16_f32 v158, v80, v81
v_cvt_pk_bf16_f32 v159, v82, v83
v_cvt_pk_bf16_f32 v160, v84, v85
v_cvt_pk_bf16_f32 v161, v86, v87
s_add_u32 s15, s14, 2048
buffer_store_dwordx4 v[158:161], v4, s[24:27], s15 offen sc1
v_cvt_pk_bf16_f32 v162, v88, v89
v_cvt_pk_bf16_f32 v163, v90, v91
v_cvt_pk_bf16_f32 v164, v92, v93
v_cvt_pk_bf16_f32 v165, v94, v95
s_add_u32 s15, s14, 3072
buffer_store_dwordx4 v[162:165], v4, s[24:27], s15 offen sc1
v_cvt_pk_bf16_f32 v166, v96, v97
v_cvt_pk_bf16_f32 v167, v98, v99
v_cvt_pk_bf16_f32 v168, v100, v101
v_cvt_pk_bf16_f32 v169, v102, v103
s_add_u32 s15, s14, 4096
buffer_store_dwordx4 v[166:169], v4, s[24:27], s15 offen sc1
v_cvt_pk_bf16_f32 v170, v104, v105
v_cvt_pk_bf16_f32 v171, v106, v107
v_cvt_pk_bf16_f32 v172, v108, v109
v_cvt_pk_bf16_f32 v173, v110, v111
s_add_u32 s15, s14, 20480
buffer_store_dwordx4 v[170:173], v4, s[24:27], s15 offen sc1
v_cvt_pk_bf16_f32 v174, v112, v113
v_cvt_pk_bf16_f32 v175, v114, v115
v_cvt_pk_bf16_f32 v176, v116, v117
v_cvt_pk_bf16_f32 v177, v118, v119
s_add_u32 s15, s14, 21504
buffer_store_dwordx4 v[174:177], v4, s[24:27], s15 offen sc1
v_cvt_pk_bf16_f32 v178, v120, v121
v_cvt_pk_bf16_f32 v179, v122, v123
v_cvt_pk_bf16_f32 v180, v124, v125
v_cvt_pk_bf16_f32 v181, v126, v127
s_add_u32 s15, s14, 22528
buffer_store_dwordx4 v[178:181], v4, s[24:27], s15 offen sc1
v_cvt_pk_bf16_f32 v150, v128, v129
v_cvt_pk_bf16_f32 v151, v130, v131
v_cvt_pk_bf16_f32 v152, v132, v133
v_cvt_pk_bf16_f32 v153, v134, v135
s_add_u32 s15, s14, 23552
buffer_store_dwordx4 v[150:153], v4, s[24:27], s15 offen sc1
v_cvt_pk_bf16_f32 v154, v136, v137
v_cvt_pk_bf16_f32 v155, v138, v139
v_cvt_pk_bf16_f32 v156, v140, v141
v_cvt_pk_bf16_f32 v157, v142, v143
s_add_u32 s15, s14, 24576
buffer_store_dwordx4 v[154:157], v4, s[24:27], s15 offen sc1
s_add_u32 m0, s34, 0
s_add_u32 s36, s33, 0
buffer_load_dwordx4 v4, s[24:27], s36 offen offset:0  lds
buffer_load_dwordx4 v4, s[24:27], s36 offen offset:1024  lds
buffer_load_dwordx4 v4, s[24:27], s36 offen offset:2048  lds
buffer_load_dwordx4 v4, s[24:27], s36 offen offset:3072  lds
s_add_u32 m0, s34, 16384
s_add_u32 s36, s33, 16384
buffer_load_dwordx4 v4, s[24:27], s36 offen offset:0  lds
buffer_load_dwordx4 v4, s[24:27], s36 offen offset:1024  lds
buffer_load_dwordx4 v4, s[24:27], s36 offen offset:2048  lds
buffer_load_dwordx4 v4, s[24:27], s36 offen offset:3072  lds
s_waitcnt vmcnt(8) lgkmcnt(0)
s_barrier
s_cmp_eq_u32 s3, 0
s_cbranch_scc0 L_pub_p3o
v_mov_b32 v60, s90
v_mov_b32 v61, 0
s_mov_b64 s[94:95], exec
s_mov_b64 exec, 1
buffer_store_dword v60, v61, s[24:27], s51 offen sc1
s_mov_b64 exec, s[94:95]
L_pub_p3o:
s_add_u32 m0, s34, 32768
s_add_u32 s36, s33, 32768
buffer_load_dwordx4 v4, s[24:27], s36 offen offset:0  lds
buffer_load_dwordx4 v4, s[24:27], s36 offen offset:1024  lds
buffer_load_dwordx4 v4, s[24:27], s36 offen offset:2048  lds
buffer_load_dwordx4 v4, s[24:27], s36 offen offset:3072  lds
s_add_u32 m0, s34, 49152
s_add_u32 s36, s33, 49152
buffer_load_dwordx4 v4, s[24:27], s36 offen offset:0  lds
buffer_load_dwordx4 v4, s[24:27], s36 offen offset:1024  lds
buffer_load_dwordx4 v4, s[24:27], s36 offen offset:2048  lds
buffer_load_dwordx4 v4, s[24:27], s36 offen offset:3072  lds
s_add_u32 m0, s34, 65536
s_add_u32 s36, s33, 65536
buffer_load_dwordx4 v4, s[24:27], s36 offen offset:0  lds
buffer_load_dwordx4 v4, s[24:27], s36 offen offset:1024  lds
buffer_load_dwordx4 v4, s[24:27], s36 offen offset:2048  lds
buffer_load_dwordx4 v4, s[24:27], s36 offen offset:3072  lds
s_add_u32 m0, s34, 81920
s_add_u32 s36, s33, 81920
buffer_load_dwordx4 v4, s[24:27], s36 offen offset:0  lds
buffer_load_dwordx4 v4, s[24:27], s36 offen offset:1024  lds
buffer_load_dwordx4 v4, s[24:27], s36 offen offset:2048  lds
buffer_load_dwordx4 v4, s[24:27], s36 offen offset:3072  lds
s_add_u32 m0, s34, 98304
s_add_u32 s36, s33, 98304
buffer_load_dwordx4 v4, s[24:27], s36 offen offset:0  lds
buffer_load_dwordx4 v4, s[24:27], s36 offen offset:1024  lds
buffer_load_dwordx4 v4, s[24:27], s36 offen offset:2048  lds
buffer_load_dwordx4 v4, s[24:27], s36 offen offset:3072  lds
s_add_u32 m0, s34, 114688
s_add_u32 s36, s33, 114688
buffer_load_dwordx4 v4, s[24:27], s36 offen offset:0  lds
buffer_load_dwordx4 v4, s[24:27], s36 offen offset:1024  lds
buffer_load_dwordx4 v4, s[24:27], s36 offen offset:2048  lds
buffer_load_dwordx4 v4, s[24:27], s36 offen offset:3072  lds
s_add_u32 m0, s34, 131072
s_add_u32 s36, s33, 131072
buffer_load_dwordx4 v4, s[24:27], s36 offen offset:0  lds
buffer_load_dwordx4 v4, s[24:27], s36 offen offset:1024  lds
buffer_load_dwordx4 v4, s[24:27], s36 offen offset:2048  lds
buffer_load_dwordx4 v4, s[24:27], s36 offen offset:3072  lds
L_k3_kernel_fin:
L_code_p4:
v_lshrrev_b32 v8, 6, v0
v_and_b32 v1, 63, v0
v_readfirstlane_b32 s3, v8
v_lshrrev_b32 v2, 4, v1
v_and_b32 v3, 15, v1
v_lshlrev_b32 v4, 4, v1
v_mov_b32 v5, v4
v_add_u32 v6, 0x10000, v4
v_add_u32 v7, 0x20000, v4
s_and_b32 s10, s2, 7
s_lshr_b32 s11, s2, 3
s_lshr_b32 s14, s10, 1
s_lshl_b32 s14, s14, 3
s_lshr_b32 s15, s11, 2
s_add_u32 s12, s14, s15
s_and_b32 s14, s10, 1
s_lshl_b32 s14, s14, 2
s_and_b32 s15, s11, 3
s_add_u32 s13, s14, s15
s_lshl_b32 s14, s12, 2
s_add_u32 s48, s14, s3
s_mul_i32 s32, s12, 221184
s_lshl_b32 s14, s3, 10
s_add_u32 s32, s32, s14
s_mul_i32 s33, s13, 276480
s_lshl_b32 s34, s3, 12
s_add_u32 s33, s33, s34
s_add_u32 s16, s6, 18546688
s_addc_u32 s17, s7, 0
s_mov_b32 s18, 7077888
s_mov_b32 s19, 0x20000
s_add_u32 s20, s6, 10117120
s_addc_u32 s21, s7, 0
s_mov_b32 s22, 18403328
s_mov_b32 s23, 0x20000
s_mov_b32 s24, s6
s_mov_b32 s25, s7
s_mov_b32 s26, 28520448
s_mov_b32 s27, 0x20000
s_mov_b32 s28, s8
s_mov_b32 s29, s9
s_mov_b32 s30, 2621440
s_mov_b32 s31, 0x20000
s_lshr_b32 s14, s12, 1
s_lshl_b32 s14, s14, 7
s_add_u32 s14, s14, 28515328
s_cmp_eq_u32 s3, 0
s_cbranch_scc0 L_pd_p4
v_and_b32 v60, 63, v0
v_min_u32 v60, 15, v60
v_add_u32 v60, 0, v60
v_lshlrev_b32 v60, 2, v60
s_mov_b32 s93, 0x40000
L_pl_p4:
buffer_load_dword v56, v60, s[24:27], s14 offen sc1
s_waitcnt vmcnt(0)
v_cmp_eq_u32 vcc, s90, v56
s_sub_u32 s93, s93, 1
s_cmp_eq_u32 s93, 0
s_cbranch_scc1 L_pd_p4
s_cmp_eq_u64 vcc, exec
s_cbranch_scc1 L_pd_p4
s_sleep 2
s_branch L_pl_p4
L_pd_p4:
s_waitcnt vmcnt(0)
s_barrier
s_add_u32 s37, s32, 0
buffer_load_dwordx4 a[0:3], v4, s[16:19], s37 offen sc1
s_add_u32 s37, s32, 4096
buffer_load_dwordx4 a[4:7], v4, s[16:19], s37 offen sc1
s_add_u32 s37, s32, 8192
buffer_load_dwordx4 a[8:11], v4, s[16:19], s37 offen sc1
s_add_u32 s37, s32, 12288
buffer_load_dwordx4 a[12:15], v4, s[16:19], s37 offen sc1
s_add_u32 s37, s32, 16384
buffer_load_dwordx4 a[16:19], v4, s[16:19], s37 offen sc1
s_add_u32 s37, s32, 20480
buffer_load_dwordx4 a[20:23], v4, s[16:19], s37 offen sc1
s_add_u32 s37, s32, 24576
buffer_load_dwordx4 a[24:27], v4, s[16:19], s37 offen sc1
s_add_u32 s37, s32, 28672
buffer_load_dwordx4 a[28:31], v4, s[16:19], s37 offen sc1
ds_read_b128 a[160:163], v5 offset:0
ds_read_b128 a[164:167], v5 offset:1024
ds_read_b128 a[168:171], v5 offset:2048
ds_read_b128 a[172:175], v5 offset:3072
ds_read_b128 a[176:179], v5 offset:4096
ds_read_b128 a[180:183], v5 offset:5120
ds_read_b128 a[184:187], v5 offset:6144
ds_read_b128 a[188:191], v5 offset:7168
ds_read_b128 a[192:195], v5 offset:8192
ds_read_b128 a[196:199], v5 offset:9216
s_waitcnt vmcnt(7) lgkmcnt(9)
v_mfma_f32_16x16x32_bf16 v[64:67], a[160:163], a[0:3], 0
ds_read_b128 a[160:163], v5 offset:10240
s_add_u32 s37, s32, 32768
buffer_load_dwordx4 a[32:35], v4, s[16:19], s37 offen sc1
s_waitcnt lgkmcnt(9)
v_mfma_f32_16x16x32_bf16 v[68:71], a[164:167], a[0:3], 0
ds_read_b128 a[164:167], v5 offset:11264
s_add_u32 s37, s32, 36864
buffer_load_dwordx4 a[36:39], v4, s[16:19], s37 offen sc1
s_waitcnt lgkmcnt(9)
v_mfma_f32_16x16x32_bf16 v[72:75], a[168:171], a[0:3], 0
ds_read_b128 a[168:171], v5 offset:12288
s_waitcnt lgkmcnt(9)
v_mfma_f32_16x16x32_bf16 v[76:79], a[172:175], a[0:3], 0
ds_read_b128 a[172:175], v5 offset:13312
s_waitcnt lgkmcnt(9)
v_mfma_f32_16x16x32_bf16 v[80:83], a[176:179], a[0:3], 0
ds_read_b128 a[176:179], v5 offset:14336
s_waitcnt vmcnt(8) lgkmcnt(9)
v_mfma_f32_16x16x32_bf16 v[64:67], a[180:183], a[4:7], v[64:67]
ds_read_b128 a[180:183], v5 offset:15360
s_add_u32 s37, s32, 40960
buffer_load_dwordx4 a[40:43], v4, s[16:19], s37 offen sc1
s_waitcnt lgkmcnt(9)
v_mfma_f32_16x16x32_bf16 v[68:71], a[184:187], a[4:7], v[68:71]
ds_read_b128 a[184:187], v5 offset:16384
s_waitcnt lgkmcnt(9)
v_mfma_f32_16x16x32_bf16 v[72:75], a[188:191], a[4:7], v[72:75]
ds_read_b128 a[188:191], v5 offset:17408
s_waitcnt lgkmcnt(9)
v_mfma_f32_16x16x32_bf16 v[76:79], a[192:195], a[4:7], v[76:79]
ds_read_b128 a[192:195], v5 offset:18432
s_waitcnt lgkmcnt(9)
v_mfma_f32_16x16x32_bf16 v[80:83], a[196:199], a[4:7], v[80:83]
ds_read_b128 a[196:199], v5 offset:19456
s_waitcnt vmcnt(8) lgkmcnt(9)
v_mfma_f32_16x16x32_bf16 v[64:67], a[160:163], a[8:11], v[64:67]
ds_read_b128 a[160:163], v5 offset:20480
s_add_u32 s37, s32, 45056
buffer_load_dwordx4 a[44:47], v4, s[16:19], s37 offen sc1
s_waitcnt lgkmcnt(9)
v_mfma_f32_16x16x32_bf16 v[68:71], a[164:167], a[8:11], v[68:71]
ds_read_b128 a[164:167], v5 offset:21504
s_waitcnt lgkmcnt(9)
v_mfma_f32_16x16x32_bf16 v[72:75], a[168:171], a[8:11], v[72:75]
ds_read_b128 a[168:171], v5 offset:22528
s_waitcnt lgkmcnt(9)
v_mfma_f32_16x16x32_bf16 v[76:79], a[172:175], a[8:11], v[76:79]
ds_read_b128 a[172:175], v5 offset:23552
s_waitcnt lgkmcnt(9)
v_mfma_f32_16x16x32_bf16 v[80:83], a[176:179], a[8:11], v[80:83]
ds_read_b128 a[176:179], v5 offset:24576
s_waitcnt vmcnt(8) lgkmcnt(9)
v_mfma_f32_16x16x32_bf16 v[64:67], a[180:183], a[12:15], v[64:67]
ds_read_b128 a[180:183], v5 offset:25600
s_add_u32 s37, s32, 49152
buffer_load_dwordx4 a[48:51], v4, s[16:19], s37 offen sc1
s_waitcnt lgkmcnt(9)
v_mfma_f32_16x16x32_bf16 v[68:71], a[184:187], a[12:15], v[68:71]
ds_read_b128 a[184:187], v5 offset:26624
s_waitcnt lgkmcnt(9)
v_mfma_f32_16x16x32_bf16 v[72:75], a[188:191], a[12:15], v[72:75]
ds_read_b128 a[188:191], v5 offset:27648
s_waitcnt lgkmcnt(9)
v_mfma_f32_16x16x32_bf16 v[76:79], a[192:195], a[12:15], v[76:79]
ds_read_b128 a[192:195], v5 offset:28672
s_waitcnt lgkmcnt(9)
v_mfma_f32_16x16x32_bf16 v[80:83], a[196:199], a[12:15], v[80:83]
ds_read_b128 a[196:199], v5 offset:29696
s_barrier
s_waitcnt vmcnt(8) lgkmcnt(9)
v_mfma_f32_16x16x32_bf16 v[64:67], a[160:163], a[16:19], v[64:67]
ds_read_b128 a[160:163], v5 offset:30720
s_add_u32 s37, s32, 53248
buffer_load_dwordx4 a[52:55], v4, s[16:19], s37 offen sc1
s_add_u32 m0, s34, 0
s_add_u32 s36, s33, 147456
s_waitcnt lgkmcnt(9)
v_mfma_f32_16x16x32_bf16 v[68:71], a[164:167], a[16:19], v[68:71]
ds_read_b128 a[164:167], v5 offset:31744
buffer_load_dwordx4 v4, s[20:23], s36 offen offset:0 sc1 lds
buffer_load_dwordx4 v4, s[20:23], s36 offen offset:1024 sc1 lds
s_waitcnt lgkmcnt(9)
v_mfma_f32_16x16x32_bf16 v[72:75], a[168:171], a[16:19], v[72:75]
ds_read_b128 a[168:171], v5 offset:32768
buffer_load_dwordx4 v4, s[20:23], s36 offen offset:2048 sc1 lds
buffer_load_dwordx4 v4, s[20:23], s36 offen offset:3072 sc1 lds
s_waitcnt lgkmcnt(9)
v_mfma_f32_16x16x32_bf16 v[76:79], a[172:175], a[16:19], v[76:79]
ds_read_b128 a[172:175], v5 offset:33792
s_waitcnt lgkmcnt(9)
v_mfma_f32_16x16x32_bf16 v[80:83], a[176:179], a[16:19], v[80:83]
ds_read_b128 a[176:179], v5 offset:34816
s_waitcnt vmcnt(12) lgkmcnt(9)
v_mfma_f32_16x16x32_bf16 v[64:67], a[180:183], a[20:23], v[64:67]
ds_read_b128 a[180:183], v5 offset:35840
s_add_u32 s37, s32, 57344
buffer_load_dwordx4 a[56:59], v4, s[16:19], s37 offen sc1
s_waitcnt lgkmcnt(9)
v_mfma_f32_16x16x32_bf16 v[68:71], a[184:187], a[20:23], v[68:71]
ds_read_b128 a[184:187], v5 offset:36864
s_waitcnt lgkmcnt(9)
v_mfma_f32_16x16x32_bf16 v[72:75], a[188:191], a[20:23], v[72:75]
ds_read_b128 a[188:191], v5 offset:37888
s_waitcnt lgkmcnt(9)
v_mfma_f32_16x16x32_bf16 v[76:79], a[192:195], a[20:23], v[76:79]
ds_read_b128 a[192:195], v5 offset:38912
s_waitcnt lgkmcnt(9)
v_mfma_f32_16x16x32_bf16 v[80:83], a[196:199], a[20:23], v[80:83]
ds_read_b128 a[196:199], v5 offset:39936
s_waitcnt vmcnt(12) lgkmcnt(9)
v_mfma_f32_16x16x32_bf16 v[64:67], a[160:163], a[24:27], v[64:67]
ds_read_b128 a[160:163], v5 offset:40960
s_add_u32 s37, s32, 61440
buffer_load_dwordx4 a[60:63], v4, s[16:19], s37 offen sc1
s_waitcnt lgkmcnt(9)
v_mfma_f32_16x16x32_bf16 v[68:71], a[164:167], a[24:27], v[68:71]
ds_read_b128 a[164:167], v5 offset:41984
s_waitcnt lgkmcnt(9)
v_mfma_f32_16x16x32_bf16 v[72:75], a[168:171], a[24:27], v[72:75]
ds_read_b128 a[168:171], v5 offset:43008
s_waitcnt lgkmcnt(9)
v_mfma_f32_16x16x32_bf16 v[76:79], a[172:175], a[24:27], v[76:79]
ds_read_b128 a[172:175], v5 offset:44032
s_waitcnt lgkmcnt(9)
v_mfma_f32_16x16x32_bf16 v[80:83], a[176:179], a[24:27], v[80:83]
ds_read_b128 a[176:179], v5 offset:45056
s_barrier
s_waitcnt vmcnt(12) lgkmcnt(9)
v_mfma_f32_16x16x32_bf16 v[64:67], a[180:183], a[28:31], v[64:67]
ds_read_b128 a[180:183], v5 offset:46080
s_add_u32 s37, s32, 65536
buffer_load_dwordx4 a[64:67], v4, s[16:19], s37 offen sc1
s_add_u32 m0, s34, 16384
s_add_u32 s36, s33, 163840
s_waitcnt lgkmcnt(9)
v_mfma_f32_16x16x32_bf16 v[68:71], a[184:187], a[28:31], v[68:71]
ds_read_b128 a[184:187], v5 offset:47104
buffer_load_dwordx4 v4, s[20:23], s36 offen offset:0 sc1 lds
buffer_load_dwordx4 v4, s[20:23], s36 offen offset:1024 sc1 lds
s_waitcnt lgkmcnt(9)
v_mfma_f32_16x16x32_bf16 v[72:75], a[188:191], a[28:31], v[72:75]
ds_read_b128 a[188:191], v5 offset:48128
buffer_load_dwordx4 v4, s[20:23], s36 offen offset:2048 sc1 lds
buffer_load_dwordx4 v4, s[20:23], s36 offen offset:3072 sc1 lds
s_waitcnt lgkmcnt(9)
v_mfma_f32_16x16x32_bf16 v[76:79], a[192:195], a[28:31], v[76:79]
ds_read_b128 a[192:195], v5 offset:49152
s_waitcnt lgkmcnt(9)
v_mfma_f32_16x16x32_bf16 v[80:83], a[196:199], a[28:31], v[80:83]
ds_read_b128 a[196:199], v5 offset:50176
s_waitcnt vmcnt(16) lgkmcnt(9)
v_mfma_f32_16x16x32_bf16 v[64:67], a[160:163], a[32:35], v[64:67]
ds_read_b128 a[160:163], v5 offset:51200
s_add_u32 s37, s32, 69632
buffer_load_dwordx4 a[68:71], v4, s[16:19], s37 offen sc1
s_waitcnt lgkmcnt(9)
v_mfma_f32_16x16x32_bf16 v[68:71], a[164:167], a[32:35], v[68:71]
ds_read_b128 a[164:167], v5 offset:52224
s_waitcnt lgkmcnt(9)
v_mfma_f32_16x16x32_bf16 v[72:75], a[168:171], a[32:35], v[72:75]
ds_read_b128 a[168:171], v5 offset:53248
s_waitcnt lgkmcnt(9)
v_mfma_f32_16x16x32_bf16 v[76:79], a[172:175], a[32:35], v[76:79]
ds_read_b128 a[172:175], v5 offset:54272
s_waitcnt lgkmcnt(9)
v_mfma_f32_16x16x32_bf16 v[80:83], a[176:179], a[32:35], v[80:83]
ds_read_b128 a[176:179], v5 offset:55296
s_waitcnt vmcnt(16) lgkmcnt(9)
v_mfma_f32_16x16x32_bf16 v[64:67], a[180:183], a[36:39], v[64:67]
ds_read_b128 a[180:183], v5 offset:56320
s_add_u32 s37, s32, 73728
buffer_load_dwordx4 a[72:75], v4, s[16:19], s37 offen sc1
s_waitcnt lgkmcnt(9)
v_mfma_f32_16x16x32_bf16 v[68:71], a[184:187], a[36:39], v[68:71]
ds_read_b128 a[184:187], v5 offset:57344
s_waitcnt lgkmcnt(9)
v_mfma_f32_16x16x32_bf16 v[72:75], a[188:191], a[36:39], v[72:75]
ds_read_b128 a[188:191], v5 offset:58368
s_waitcnt lgkmcnt(9)
v_mfma_f32_16x16x32_bf16 v[76:79], a[192:195], a[36:39], v[76:79]
ds_read_b128 a[192:195], v5 offset:59392
s_waitcnt lgkmcnt(9)
v_mfma_f32_16x16x32_bf16 v[80:83], a[196:199], a[36:39], v[80:83]
ds_read_b128 a[196:199], v5 offset:60416
s_barrier
s_waitcnt vmcnt(16) lgkmcnt(9)
v_mfma_f32_16x16x32_bf16 v[64:67], a[160:163], a[40:43], v[64:67]
ds_read_b128 a[160:163], v5 offset:61440
s_add_u32 s37, s32, 77824
buffer_load_dwordx4 a[76:79], v4, s[16:19], s37 offen sc1
s_add_u32 m0, s34, 32768
s_add_u32 s36, s33, 180224
s_waitcnt lgkmcnt(9)
v_mfma_f32_16x16x32_bf16 v[68:71], a[164:167], a[40:43], v[68:71]
ds_read_b128 a[164:167], v5 offset:62464
buffer_load_dwordx4 v4, s[20:23], s36 offen offset:0 sc1 lds
buffer_load_dwordx4 v4, s[20:23], s36 offen offset:1024 sc1 lds
s_waitcnt lgkmcnt(9)
v_mfma_f32_16x16x32_bf16 v[72:75], a[168:171], a[40:43], v[72:75]
ds_read_b128 a[168:171], v5 offset:63488
buffer_load_dwordx4 v4, s[20:23], s36 offen offset:2048 sc1 lds
buffer_load_dwordx4 v4, s[20:23], s36 offen offset:3072 sc1 lds
s_waitcnt lgkmcnt(9)
v_mfma_f32_16x16x32_bf16 v[76:79], a[172:175], a[40:43], v[76:79]
ds_read_b128 a[172:175], v5 offset:64512
s_waitcnt lgkmcnt(9)
v_mfma_f32_16x16x32_bf16 v[80:83], a[176:179], a[40:43], v[80:83]
ds_read_b128 a[176:179], v6 offset:0
s_waitcnt vmcnt(20) lgkmcnt(9)
v_mfma_f32_16x16x32_bf16 v[64:67], a[180:183], a[44:47], v[64:67]
ds_read_b128 a[180:183], v6 offset:1024
s_add_u32 s37, s32, 81920
buffer_load_dwordx4 a[80:83], v4, s[16:19], s37 offen sc1
s_waitcnt lgkmcnt(9)
v_mfma_f32_16x16x32_bf16 v[68:71], a[184:187], a[44:47], v[68:71]
ds_read_b128 a[184:187], v6 offset:2048
s_waitcnt lgkmcnt(9)
v_mfma_f32_16x16x32_bf16 v[72:75], a[188:191], a[44:47], v[72:75]
ds_read_b128 a[188:191], v6 offset:3072
s_waitcnt lgkmcnt(9)
v_mfma_f32_16x16x32_bf16 v[76:79], a[192:195], a[44:47], v[76:79]
ds_read_b128 a[192:195], v6 offset:4096
s_waitcnt lgkmcnt(9)
v_mfma_f32_16x16x32_bf16 v[80:83], a[196:199], a[44:47], v[80:83]
ds_read_b128 a[196:199], v6 offset:5120
s_waitcnt vmcnt(20) lgkmcnt(9)
v_mfma_f32_16x16x32_bf16 v[64:67], a[160:163], a[48:51], v[64:67]
ds_read_b128 a[160:163], v6 offset:6144
s_add_u32 s37, s32, 86016
buffer_load_dwordx4 a[84:87], v4, s[16:19], s37 offen sc1
s_waitcnt lgkmcnt(9)
v_mfma_f32_16x16x32_bf16 v[68:71], a[164:167], a[48:51], v[68:71]
ds_read_b128 a[164:167], v6 offset:7168
s_waitcnt lgkmcnt(9)
v_mfma_f32_16x16x32_bf16 v[72:75], a[168:171], a[48:51], v[72:75]
ds_read_b128 a[168:171], v6 offset:8192
s_waitcnt lgkmcnt(9)
v_mfma_f32_16x16x32_bf16 v[76:79], a[172:175], a[48:51], v[76:79]
ds_read_b128 a[172:175], v6 offset:9216
s_waitcnt lgkmcnt(9)
v_mfma_f32_16x16x32_bf16 v[80:83], a[176:179], a[48:51], v[80:83]
ds_read_b128 a[176:179], v6 offset:10240
s_barrier
s_waitcnt vmcnt(20) lgkmcnt(9)
v_mfma_f32_16x16x32_bf16 v[64:67], a[180:183], a[52:55], v[64:67]
ds_read_b128 a[180:183], v6 offset:11264
s_add_u32 s37, s32, 90112
buffer_load_dwordx4 a[88:91], v4, s[16:19], s37 offen sc1
s_add_u32 m0, s34, 49152
s_add_u32 s36, s33, 196608
s_waitcnt lgkmcnt(9)
v_mfma_f32_16x16x32_bf16 v[68:71], a[184:187], a[52:55], v[68:71]
ds_read_b128 a[184:187], v6 offset:12288
buffer_load_dwordx4 v4, s[20:23], s36 offen offset:0 sc1 lds
buffer_load_dwordx4 v4, s[20:23], s36 offen offset:1024 sc1 lds
s_waitcnt lgkmcnt(9)
v_mfma_f32_16x16x32_bf16 v[72:75], a[188:191], a[52:55], v[72:75]
ds_read_b128 a[188:191], v6 offset:13312
buffer_load_dwordx4 v4, s[20:23], s36 offen offset:2048 sc1 lds
buffer_load_dwordx4 v4, s[20:23], s36 offen offset:3072 sc1 lds
s_waitcnt lgkmcnt(9)
v_mfma_f32_16x16x32_bf16 v[76:79], a[192:195], a[52:55], v[76:79]
ds_read_b128 a[192:195], v6 offset:14336
s_waitcnt lgkmcnt(9)
v_mfma_f32_16x16x32_bf16 v[80:83], a[196:199], a[52:55], v[80:83]
ds_read_b128 a[196:199], v6 offset:15360
s_waitcnt vmcnt(20) lgkmcnt(9)
v_mfma_f32_16x16x32_bf16 v[64:67], a[160:163], a[56:59], v[64:67]
ds_read_b128 a[160:163], v6 offset:16384
s_add_u32 s37, s32, 94208
buffer_load_dwordx4 a[92:95], v4, s[16:19], s37 offen sc1
s_waitcnt lgkmcnt(9)
v_mfma_f32_16x16x32_bf16 v[68:71], a[164:167], a[56:59], v[68:71]
ds_read_b128 a[164:167], v6 offset:17408
s_waitcnt lgkmcnt(9)
v_mfma_f32_16x16x32_bf16 v[72:75], a[168:171], a[56:59], v[72:75]
ds_read_b128 a[168:171], v6 offset:18432
s_waitcnt lgkmcnt(9)
v_mfma_f32_16x16x32_bf16 v[76:79], a[172:175], a[56:59], v[76:79]
ds_read_b128 a[172:175], v6 offset:19456
s_waitcnt lgkmcnt(9)
v_mfma_f32_16x16x32_bf16 v[80:83], a[176:179], a[56:59], v[80:83]
ds_read_b128 a[176:179], v6 offset:20480
s_waitcnt vmcnt(20) lgkmcnt(9)
v_mfma_f32_16x16x32_bf16 v[64:67], a[180:183], a[60:63], v[64:67]
ds_read_b128 a[180:183], v6 offset:21504
s_add_u32 s37, s32, 98304
buffer_load_dwordx4 a[96:99], v4, s[16:19], s37 offen sc1
s_waitcnt lgkmcnt(9)
v_mfma_f32_16x16x32_bf16 v[68:71], a[184:187], a[60:63], v[68:71]
ds_read_b128 a[184:187], v6 offset:22528
s_waitcnt lgkmcnt(9)
v_mfma_f32_16x16x32_bf16 v[72:75], a[188:191], a[60:63], v[72:75]
ds_read_b128 a[188:191], v6 offset:23552
s_waitcnt lgkmcnt(9)
v_mfma_f32_16x16x32_bf16 v[76:79], a[192:195], a[60:63], v[76:79]
ds_read_b128 a[192:195], v6 offset:24576
s_waitcnt lgkmcnt(9)
v_mfma_f32_16x16x32_bf16 v[80:83], a[196:199], a[60:63], v[80:83]
ds_read_b128 a[196:199], v6 offset:25600
s_barrier
s_waitcnt vmcnt(20) lgkmcnt(9)
v_mfma_f32_16x16x32_bf16 v[64:67], a[160:163], a[64:67], v[64:67]
ds_read_b128 a[160:163], v6 offset:26624
s_add_u32 s37, s32, 102400
buffer_load_dwordx4 a[100:103], v4, s[16:19], s37 offen sc1
s_add_u32 m0, s34, 65536
s_add_u32 s36, s33, 212992
s_waitcnt lgkmcnt(9)
v_mfma_f32_16x16x32_bf16 v[68:71], a[164:167], a[64:67], v[68:71]
ds_read_b128 a[164:167], v6 offset:27648
buffer_load_dwordx4 v4, s[20:23], s36 offen offset:0 sc1 lds
buffer_load_dwordx4 v4, s[20:23], s36 offen offset:1024 sc1 lds
s_waitcnt lgkmcnt(9)
v_mfma_f32_16x16x32_bf16 v[72:75], a[168:171], a[64:67], v[72:75]
ds_read_b128 a[168:171], v6 offset:28672
buffer_load_dwordx4 v4, s[20:23], s36 offen offset:2048 sc1 lds
buffer_load_dwordx4 v4, s[20:23], s36 offen offset:3072 sc1 lds
s_waitcnt lgkmcnt(9)
v_mfma_f32_16x16x32_bf16 v[76:79], a[172:175], a[64:67], v[76:79]
ds_read_b128 a[172:175], v6 offset:29696
s_waitcnt lgkmcnt(9)
v_mfma_f32_16x16x32_bf16 v[80:83], a[176:179], a[64:67], v[80:83]
ds_read_b128 a[176:179], v6 offset:30720
s_waitcnt vmcnt(20) lgkmcnt(9)
v_mfma_f32_16x16x32_bf16 v[64:67], a[180:183], a[68:71], v[64:67]
ds_read_b128 a[180:183], v6 offset:31744
s_add_u32 s37, s32, 106496
buffer_load_dwordx4 a[104:107], v4, s[16:19], s37 offen sc1
s_waitcnt lgkmcnt(9)
v_mfma_f32_16x16x32_bf16 v[68:71], a[184:187], a[68:71], v[68:71]
ds_read_b128 a[184:187], v6 offset:32768
s_waitcnt lgkmcnt(9)
v_mfma_f32_16x16x32_bf16 v[72:75], a[188:191], a[68:71], v[72:75]
ds_read_b128 a[188:191], v6 offset:33792
s_waitcnt lgkmcnt(9)
v_mfma_f32_16x16x32_bf16 v[76:79], a[192:195], a[68:71], v[76:79]
ds_read_b128 a[192:195], v6 offset:34816
s_waitcnt lgkmcnt(9)
v_mfma_f32_16x16x32_bf16 v[80:83], a[196:199], a[68:71], v[80:83]
ds_read_b128 a[196:199], v6 offset:35840
s_waitcnt vmcnt(20) lgkmcnt(9)
v_mfma_f32_16x16x32_bf16 v[64:67], a[160:163], a[72:75], v[64:67]
ds_read_b128 a[160:163], v6 offset:36864
s_add_u32 s37, s32, 110592
buffer_load_dwordx4 a[108:111], v4, s[16:19], s37 offen sc1
s_waitcnt lgkmcnt(9)
v_mfma_f32_16x16x32_bf16 v[68:71], a[164:167], a[72:75], v[68:71]
ds_read_b128 a[164:167], v6 offset:37888
s_waitcnt lgkmcnt(9)
v_mfma_f32_16x16x32_bf16 v[72:75], a[168:171], a[72:75], v[72:75]
ds_read_b128 a[168:171], v6 offset:38912
s_waitcnt lgkmcnt(9)
v_mfma_f32_16x16x32_bf16 v[76:79], a[172:175], a[72:75], v[76:79]
ds_read_b128 a[172:175], v6 offset:39936
s_waitcnt lgkmcnt(9)
v_mfma_f32_16x16x32_bf16 v[80:83], a[176:179], a[72:75], v[80:83]
ds_read_b128 a[176:179], v6 offset:40960
s_waitcnt vmcnt(20) lgkmcnt(9)
v_mfma_f32_16x16x32_bf16 v[64:67], a[180:183], a[76:79], v[64:67]
ds_read_b128 a[180:183], v6 offset:41984
s_add_u32 s37, s32, 114688
buffer_load_dwordx4 a[0:3], v4, s[16:19], s37 offen sc1
s_waitcnt lgkmcnt(9)
v_mfma_f32_16x16x32_bf16 v[68:71], a[184:187], a[76:79], v[68:71]
ds_read_b128 a[184:187], v6 offset:43008
s_waitcnt lgkmcnt(9)
v_mfma_f32_16x16x32_bf16 v[72:75], a[188:191], a[76:79], v[72:75]
ds_read_b128 a[188:191], v6 offset:44032
s_waitcnt lgkmcnt(9)
v_mfma_f32_16x16x32_bf16 v[76:79], a[192:195], a[76:79], v[76:79]
ds_read_b128 a[192:195], v6 offset:45056
s_waitcnt lgkmcnt(9)
v_mfma_f32_16x16x32_bf16 v[80:83], a[196:199], a[76:79], v[80:83]
ds_read_b128 a[196:199], v6 offset:46080
s_barrier
s_waitcnt vmcnt(16) lgkmcnt(9)
v_mfma_f32_16x16x32_bf16 v[64:67], a[160:163], a[80:83], v[64:67]
ds_read_b128 a[160:163], v6 offset:47104
s_add_u32 s37, s32, 118784
buffer_load_dwordx4 a[4:7], v4, s[16:19], s37 offen sc1
s_add_u32 m0, s34, 81920
s_add_u32 s36, s33, 229376
s_waitcnt lgkmcnt(9)
v_mfma_f32_16x16x32_bf16 v[68:71], a[164:167], a[80:83], v[68:71]
ds_read_b128 a[164:167], v6 offset:48128
buffer_load_dwordx4 v4, s[20:23], s36 offen offset:0 sc1 lds
buffer_load_dwordx4 v4, s[20:23], s36 offen offset:1024 sc1 lds
s_waitcnt lgkmcnt(9)
v_mfma_f32_16x16x32_bf16 v[72:75], a[168:171], a[80:83], v[72:75]
ds_read_b128 a[168:171], v6 offset:49152
buffer_load_dwordx4 v4, s[20:23], s36 offen offset:2048 sc1 lds
buffer_load_dwordx4 v4, s[20:23], s36 offen offset:3072 sc1 lds
s_waitcnt lgkmcnt(9)
v_mfma_f32_16x16x32_bf16 v[76:79], a[172:175], a[80:83], v[76:79]
ds_read_b128 a[172:175], v6 offset:50176
s_waitcnt lgkmcnt(9)
v_mfma_f32_16x16x32_bf16 v[80:83], a[176:179], a[80:83], v[80:83]
ds_read_b128 a[176:179], v6 offset:51200
s_waitcnt vmcnt(20) lgkmcnt(9)
v_mfma_f32_16x16x32_bf16 v[64:67], a[180:183], a[84:87], v[64:67]
ds_read_b128 a[180:183], v6 offset:52224
s_add_u32 s37, s32, 122880
buffer_load_dwordx4 a[8:11], v4, s[16:19], s37 offen sc1
s_waitcnt lgkmcnt(9)
v_mfma_f32_16x16x32_bf16 v[68:71], a[184:187], a[84:87], v[68:71]
ds_read_b128 a[184:187], v6 offset:53248
s_waitcnt lgkmcnt(9)
v_mfma_f32_16x16x32_bf16 v[72:75], a[188:191], a[84:87], v[72:75]
ds_read_b128 a[188:191], v6 offset:54272
s_waitcnt lgkmcnt(9)
v_mfma_f32_16x16x32_bf16 v[76:79], a[192:195], a[84:87], v[76:79]
ds_read_b128 a[192:195], v6 offset:55296
s_waitcnt lgkmcnt(9)
v_mfma_f32_16x16x32_bf16 v[80:83], a[196:199], a[84:87], v[80:83]
ds_read_b128 a[196:199], v6 offset:56320
s_waitcnt vmcnt(20) lgkmcnt(9)
v_mfma_f32_16x16x32_bf16 v[64:67], a[160:163], a[88:91], v[64:67]
ds_read_b128 a[160:163], v6 offset:57344
s_add_u32 s37, s32, 126976
buffer_load_dwordx4 a[12:15], v4, s[16:19], s37 offen sc1
s_waitcnt lgkmcnt(9)
v_mfma_f32_16x16x32_bf16 v[68:71], a[164:167], a[88:91], v[68:71]
ds_read_b128 a[164:167], v6 offset:58368
s_waitcnt lgkmcnt(9)
v_mfma_f32_16x16x32_bf16 v[72:75], a[168:171], a[88:91], v[72:75]
ds_read_b128 a[168:171], v6 offset:59392
s_waitcnt lgkmcnt(9)
v_mfma_f32_16x16x32_bf16 v[76:79], a[172:175], a[88:91], v[76:79]
ds_read_b128 a[172:175], v6 offset:60416
s_waitcnt lgkmcnt(9)
v_mfma_f32_16x16x32_bf16 v[80:83], a[176:179], a[88:91], v[80:83]
ds_read_b128 a[176:179], v6 offset:61440
s_barrier
s_waitcnt vmcnt(16) lgkmcnt(9)
v_mfma_f32_16x16x32_bf16 v[64:67], a[180:183], a[92:95], v[64:67]
ds_read_b128 a[180:183], v6 offset:62464
s_add_u32 s37, s32, 131072
buffer_load_dwordx4 a[16:19], v4, s[16:19], s37 offen sc1
s_add_u32 m0, s34, 98304
s_add_u32 s36, s33, 245760
s_waitcnt lgkmcnt(9)
v_mfma_f32_16x16x32_bf16 v[68:71], a[184:187], a[92:95], v[68:71]
ds_read_b128 a[184:187], v6 offset:63488
buffer_load_dwordx4 v4, s[20:23], s36 offen offset:0 sc1 lds
buffer_load_dwordx4 v4, s[20:23], s36 offen offset:1024 sc1 lds
s_waitcnt lgkmcnt(9)
v_mfma_f32_16x16x32_bf16 v[72:75], a[188:191], a[92:95], v[72:75]
ds_read_b128 a[188:191], v6 offset:64512
buffer_load_dwordx4 v4, s[20:23], s36 offen offset:2048 sc1 lds
buffer_load_dwordx4 v4, s[20:23], s36 offen offset:3072 sc1 lds
s_waitcnt lgkmcnt(9)
v_mfma_f32_16x16x32_bf16 v[76:79], a[192:195], a[92:95], v[76:79]
ds_read_b128 a[192:195], v7 offset:0
s_waitcnt lgkmcnt(9)
v_mfma_f32_16x16x32_bf16 v[80:83], a[196:199], a[92:95], v[80:83]
ds_read_b128 a[196:199], v7 offset:1024
s_waitcnt vmcnt(20) lgkmcnt(9)
v_mfma_f32_16x16x32_bf16 v[64:67], a[160:163], a[96:99], v[64:67]
ds_read_b128 a[160:163], v7 offset:2048
s_add_u32 s37, s32, 135168
buffer_load_dwordx4 a[20:23], v4, s[16:19], s37 offen sc1
s_waitcnt lgkmcnt(9)
v_mfma_f32_16x16x32_bf16 v[68:71], a[164:167], a[96:99], v[68:71]
ds_read_b128 a[164:167], v7 offset:3072
s_waitcnt lgkmcnt(9)
v_mfma_f32_16x16x32_bf16 v[72:75], a[168:171], a[96:99], v[72:75]
ds_read_b128 a[168:171], v7 offset:4096
s_waitcnt lgkmcnt(9)
v_mfma_f32_16x16x32_bf16 v[76:79], a[172:175], a[96:99], v[76:79]
ds_read_b128 a[172:175], v7 offset:5120
s_waitcnt lgkmcnt(9)
v_mfma_f32_16x16x32_bf16 v[80:83], a[176:179], a[96:99], v[80:83]
ds_read_b128 a[176:179], v7 offset:6144
s_waitcnt vmcnt(20) lgkmcnt(9)
v_mfma_f32_16x16x32_bf16 v[64:67], a[180:183], a[100:103], v[64:67]
ds_read_b128 a[180:183], v7 offset:7168
s_add_u32 s37, s32, 139264
buffer_load_dwordx4 a[24:27], v4, s[16:19], s37 offen sc1
s_waitcnt lgkmcnt(9)
v_mfma_f32_16x16x32_bf16 v[68:71], a[184:187], a[100:103], v[68:71]
ds_read_b128 a[184:187], v7 offset:8192
s_waitcnt lgkmcnt(9)
v_mfma_f32_16x16x32_bf16 v[72:75], a[188:191], a[100:103], v[72:75]
ds_read_b128 a[188:191], v7 offset:9216
s_waitcnt lgkmcnt(9)
v_mfma_f32_16x16x32_bf16 v[76:79], a[192:195], a[100:103], v[76:79]
ds_read_b128 a[192:195], v7 offset:10240
s_waitcnt lgkmcnt(9)
v_mfma_f32_16x16x32_bf16 v[80:83], a[196:199], a[100:103], v[80:83]
ds_read_b128 a[196:199], v7 offset:11264
s_barrier
s_waitcnt vmcnt(16) lgkmcnt(9)
v_mfma_f32_16x16x32_bf16 v[64:67], a[160:163], a[104:107], v[64:67]
ds_read_b128 a[160:163], v7 offset:12288
s_add_u32 s37, s32, 143360
buffer_load_dwordx4 a[28:31], v4, s[16:19], s37 offen sc1
s_add_u32 m0, s34, 114688
s_add_u32 s36, s33, 262144
s_waitcnt lgkmcnt(9)
v_mfma_f32_16x16x32_bf16 v[68:71], a[164:167], a[104:107], v[68:71]
ds_read_b128 a[164:167], v7 offset:13312
buffer_load_dwordx4 v4, s[20:23], s36 offen offset:0 sc1 lds
buffer_load_dwordx4 v4, s[20:23], s36 offen offset:1024 sc1 lds
s_waitcnt lgkmcnt(9)
v_mfma_f32_16x16x32_bf16 v[72:75], a[168:171], a[104:107], v[72:75]
ds_read_b128 a[168:171], v7 offset:14336
buffer_load_dwordx4 v4, s[20:23], s36 offen offset:2048 sc1 lds
buffer_load_dwordx4 v4, s[20:23], s36 offen offset:3072 sc1 lds
s_waitcnt lgkmcnt(9)
v_mfma_f32_16x16x32_bf16 v[76:79], a[172:175], a[104:107], v[76:79]
ds_read_b128 a[172:175], v7 offset:15360
s_waitcnt lgkmcnt(9)
v_mfma_f32_16x16x32_bf16 v[80:83], a[176:179], a[104:107], v[80:83]
s_barrier
ds_read_b128 a[176:179], v5 offset:0
s_waitcnt vmcnt(20) lgkmcnt(9)
v_mfma_f32_16x16x32_bf16 v[64:67], a[180:183], a[108:111], v[64:67]
ds_read_b128 a[180:183], v5 offset:1024
s_add_u32 s37, s32, 147456
buffer_load_dwordx4 a[32:35], v4, s[16:19], s37 offen sc1
s_waitcnt lgkmcnt(9)
v_mfma_f32_16x16x32_bf16 v[68:71], a[184:187], a[108:111], v[68:71]
ds_read_b128 a[184:187], v5 offset:2048
s_waitcnt lgkmcnt(9)
v_mfma_f32_16x16x32_bf16 v[72:75], a[188:191], a[108:111], v[72:75]
ds_read_b128 a[188:191], v5 offset:3072
s_waitcnt lgkmcnt(9)
v_mfma_f32_16x16x32_bf16 v[76:79], a[192:195], a[108:111], v[76:79]
ds_read_b128 a[192:195], v5 offset:4096
s_waitcnt lgkmcnt(9)
v_mfma_f32_16x16x32_bf16 v[80:83], a[196:199], a[108:111], v[80:83]
ds_read_b128 a[196:199], v5 offset:5120
s_waitcnt vmcnt(20) lgkmcnt(9)
v_mfma_f32_16x16x32_bf16 v[64:67], a[160:163], a[0:3], v[64:67]
ds_read_b128 a[160:163], v5 offset:6144
s_add_u32 s37, s32, 151552
buffer_load_dwordx4 a[36:39], v4, s[16:19], s37 offen sc1
s_waitcnt lgkmcnt(9)
v_mfma_f32_16x16x32_bf16 v[68:71], a[164:167], a[0:3], v[68:71]
ds_read_b128 a[164:167], v5 offset:7168
s_waitcnt lgkmcnt(9)
v_mfma_f32_16x16x32_bf16 v[72:75], a[168:171], a[0:3], v[72:75]
ds_read_b128 a[168:171], v5 offset:8192
s_waitcnt lgkmcnt(9)
v_mfma_f32_16x16x32_bf16 v[76:79], a[172:175], a[0:3], v[76:79]
ds_read_b128 a[172:175], v5 offset:9216
s_waitcnt lgkmcnt(9)
v_mfma_f32_16x16x32_bf16 v[80:83], a[176:179], a[0:3], v[80:83]
ds_read_b128 a[176:179], v5 offset:10240
s_waitcnt vmcnt(20) lgkmcnt(9)
v_mfma_f32_16x16x32_bf16 v[64:67], a[180:183], a[4:7], v[64:67]
ds_read_b128 a[180:183], v5 offset:11264
s_add_u32 s37, s32, 155648
buffer_load_dwordx4 a[40:43], v4, s[16:19], s37 offen sc1
s_waitcnt lgkmcnt(9)
v_mfma_f32_16x16x32_bf16 v[68:71], a[184:187], a[4:7], v[68:71]
ds_read_b128 a[184:187], v5 offset:12288
s_waitcnt lgkmcnt(9)
v_mfma_f32_16x16x32_bf16 v[72:75], a[188:191], a[4:7], v[72:75]
ds_read_b128 a[188:191], v5 offset:13312
s_waitcnt lgkmcnt(9)
v_mfma_f32_16x16x32_bf16 v[76:79], a[192:195], a[4:7], v[76:79]
ds_read_b128 a[192:195], v5 offset:14336
s_waitcnt lgkmcnt(9)
v_mfma_f32_16x16x32_bf16 v[80:83], a[196:199], a[4:7], v[80:83]
ds_read_b128 a[196:199], v5 offset:15360
s_waitcnt vmcnt(16) lgkmcnt(9)
v_mfma_f32_16x16x32_bf16 v[64:67], a[160:163], a[8:11], v[64:67]
s_barrier
ds_read_b128 a[160:163], v5 offset:16384
s_add_u32 s37, s32, 159744
buffer_load_dwordx4 a[44:47], v4, s[16:19], s37 offen sc1
s_waitcnt lgkmcnt(9)
v_mfma_f32_16x16x32_bf16 v[68:71], a[164:167], a[8:11], v[68:71]
ds_read_b128 a[164:167], v5 offset:17408
s_waitcnt lgkmcnt(9)
v_mfma_f32_16x16x32_bf16 v[72:75], a[168:171], a[8:11], v[72:75]
ds_read_b128 a[168:171], v5 offset:18432
s_waitcnt lgkmcnt(9)
v_mfma_f32_16x16x32_bf16 v[76:79], a[172:175], a[8:11], v[76:79]
ds_read_b128 a[172:175], v5 offset:19456
s_waitcnt lgkmcnt(9)
v_mfma_f32_16x16x32_bf16 v[80:83], a[176:179], a[8:11], v[80:83]
ds_read_b128 a[176:179], v5 offset:20480
s_waitcnt vmcnt(16) lgkmcnt(9)
v_mfma_f32_16x16x32_bf16 v[64:67], a[180:183], a[12:15], v[64:67]
ds_read_b128 a[180:183], v5 offset:21504
s_add_u32 s37, s32, 163840
buffer_load_dwordx4 a[48:51], v4, s[16:19], s37 offen sc1
s_waitcnt lgkmcnt(9)
v_mfma_f32_16x16x32_bf16 v[68:71], a[184:187], a[12:15], v[68:71]
ds_read_b128 a[184:187], v5 offset:22528
s_waitcnt lgkmcnt(9)
v_mfma_f32_16x16x32_bf16 v[72:75], a[188:191], a[12:15], v[72:75]
ds_read_b128 a[188:191], v5 offset:23552
s_waitcnt lgkmcnt(9)
v_mfma_f32_16x16x32_bf16 v[76:79], a[192:195], a[12:15], v[76:79]
ds_read_b128 a[192:195], v5 offset:24576
s_waitcnt lgkmcnt(9)
v_mfma_f32_16x16x32_bf16 v[80:83], a[196:199], a[12:15], v[80:83]
ds_read_b128 a[196:199], v5 offset:25600
s_waitcnt vmcnt(16) lgkmcnt(9)
v_mfma_f32_16x16x32_bf16 v[64:67], a[160:163], a[16:19], v[64:67]
ds_read_b128 a[160:163], v5 offset:26624
s_add_u32 s37, s32, 167936
buffer_load_dwordx4 a[52:55], v4, s[16:19], s37 offen sc1
s_waitcnt lgkmcnt(9)
v_mfma_f32_16x16x32_bf16 v[68:71], a[164:167], a[16:19], v[68:71]
ds_read_b128 a[164:167], v5 offset:27648
s_waitcnt lgkmcnt(9)
v_mfma_f32_16x16x32_bf16 v[72:75], a[168:171], a[16:19], v[72:75]
ds_read_b128 a[168:171], v5 offset:28672
s_waitcnt lgkmcnt(9)
v_mfma_f32_16x16x32_bf16 v[76:79], a[172:175], a[16:19], v[76:79]
ds_read_b128 a[172:175], v5 offset:29696
s_waitcnt lgkmcnt(9)
v_mfma_f32_16x16x32_bf16 v[80:83], a[176:179], a[16:19], v[80:83]
ds_read_b128 a[176:179], v5 offset:30720
s_waitcnt vmcnt(12) lgkmcnt(9)
v_mfma_f32_16x16x32_bf16 v[64:67], a[180:183], a[20:23], v[64:67]
ds_read_b128 a[180:183], v5 offset:31744
s_add_u32 s37, s32, 172032
buffer_load_dwordx4 a[56:59], v4, s[16:19], s37 offen sc1
s_waitcnt lgkmcnt(9)
v_mfma_f32_16x16x32_bf16 v[68:71], a[184:187], a[20:23], v[68:71]
s_barrier
ds_read_b128 a[184:187], v5 offset:32768
s_waitcnt lgkmcnt(9)
v_mfma_f32_16x16x32_bf16 v[72:75], a[188:191], a[20:23], v[72:75]
ds_read_b128 a[188:191], v5 offset:33792
s_waitcnt lgkmcnt(9)
v_mfma_f32_16x16x32_bf16 v[76:79], a[192:195], a[20:23], v[76:79]
ds_read_b128 a[192:195], v5 offset:34816
s_waitcnt lgkmcnt(9)
v_mfma_f32_16x16x32_bf16 v[80:83], a[196:199], a[20:23], v[80:83]
ds_read_b128 a[196:199], v5 offset:35840
s_waitcnt vmcnt(12) lgkmcnt(9)
v_mfma_f32_16x16x32_bf16 v[64:67], a[160:163], a[24:27], v[64:67]
ds_read_b128 a[160:163], v5 offset:36864
s_add_u32 s37, s32, 176128
buffer_load_dwordx4 a[60:63], v4, s[16:19], s37 offen sc1
s_waitcnt lgkmcnt(9)
v_mfma_f32_16x16x32_bf16 v[68:71], a[164:167], a[24:27], v[68:71]
ds_read_b128 a[164:167], v5 offset:37888
s_waitcnt lgkmcnt(9)
v_mfma_f32_16x16x32_bf16 v[72:75], a[168:171], a[24:27], v[72:75]
ds_read_b128 a[168:171], v5 offset:38912
s_waitcnt lgkmcnt(9)
v_mfma_f32_16x16x32_bf16 v[76:79], a[172:175], a[24:27], v[76:79]
ds_read_b128 a[172:175], v5 offset:39936
s_waitcnt lgkmcnt(9)
v_mfma_f32_16x16x32_bf16 v[80:83], a[176:179], a[24:27], v[80:83]
ds_read_b128 a[176:179], v5 offset:40960
s_waitcnt vmcnt(12) lgkmcnt(9)
v_mfma_f32_16x16x32_bf16 v[64:67], a[180:183], a[28:31], v[64:67]
ds_read_b128 a[180:183], v5 offset:41984
s_add_u32 s37, s32, 180224
buffer_load_dwordx4 a[64:67], v4, s[16:19], s37 offen sc1
s_waitcnt lgkmcnt(9)
v_mfma_f32_16x16x32_bf16 v[68:71], a[184:187], a[28:31], v[68:71]
ds_read_b128 a[184:187], v5 offset:43008
s_waitcnt lgkmcnt(9)
v_mfma_f32_16x16x32_bf16 v[72:75], a[188:191], a[28:31], v[72:75]
ds_read_b128 a[188:191], v5 offset:44032
s_waitcnt lgkmcnt(9)
v_mfma_f32_16x16x32_bf16 v[76:79], a[192:195], a[28:31], v[76:79]
ds_read_b128 a[192:195], v5 offset:45056
s_waitcnt lgkmcnt(9)
v_mfma_f32_16x16x32_bf16 v[80:83], a[196:199], a[28:31], v[80:83]
ds_read_b128 a[196:199], v5 offset:46080
s_waitcnt vmcnt(8) lgkmcnt(9)
v_mfma_f32_16x16x32_bf16 v[64:67], a[160:163], a[32:35], v[64:67]
ds_read_b128 a[160:163], v5 offset:47104
s_add_u32 s37, s32, 184320
buffer_load_dwordx4 a[68:71], v4, s[16:19], s37 offen sc1
s_waitcnt lgkmcnt(9)
v_mfma_f32_16x16x32_bf16 v[68:71], a[164:167], a[32:35], v[68:71]
ds_read_b128 a[164:167], v5 offset:48128
s_waitcnt lgkmcnt(9)
v_mfma_f32_16x16x32_bf16 v[72:75], a[168:171], a[32:35], v[72:75]
s_barrier
ds_read_b128 a[168:171], v5 offset:49152
s_waitcnt lgkmcnt(9)
v_mfma_f32_16x16x32_bf16 v[76:79], a[172:175], a[32:35], v[76:79]
ds_read_b128 a[172:175], v5 offset:50176
s_waitcnt lgkmcnt(9)
v_mfma_f32_16x16x32_bf16 v[80:83], a[176:179], a[32:35], v[80:83]
ds_read_b128 a[176:179], v5 offset:51200
s_waitcnt vmcnt(8) lgkmcnt(9)
v_mfma_f32_16x16x32_bf16 v[64:67], a[180:183], a[36:39], v[64:67]
ds_read_b128 a[180:183], v5 offset:52224
s_add_u32 s37, s32, 188416
buffer_load_dwordx4 a[72:75], v4, s[16:19], s37 offen sc1
s_waitcnt lgkmcnt(9)
v_mfma_f32_16x16x32_bf16 v[68:71], a[184:187], a[36:39], v[68:71]
ds_read_b128 a[184:187], v5 offset:53248
s_waitcnt lgkmcnt(9)
v_mfma_f32_16x16x32_bf16 v[72:75], a[188:191], a[36:39], v[72:75]
ds_read_b128 a[188:191], v5 offset:54272
s_waitcnt lgkmcnt(9)
v_mfma_f32_16x16x32_bf16 v[76:79], a[192:195], a[36:39], v[76:79]
ds_read_b128 a[192:195], v5 offset:55296
s_waitcnt lgkmcnt(9)
v_mfma_f32_16x16x32_bf16 v[80:83], a[196:199], a[36:39], v[80:83]
ds_read_b128 a[196:199], v5 offset:56320
s_waitcnt vmcnt(8) lgkmcnt(9)
v_mfma_f32_16x16x32_bf16 v[64:67], a[160:163], a[40:43], v[64:67]
ds_read_b128 a[160:163], v5 offset:57344
s_add_u32 s37, s32, 192512
buffer_load_dwordx4 a[76:79], v4, s[16:19], s37 offen sc1
s_waitcnt lgkmcnt(9)
v_mfma_f32_16x16x32_bf16 v[68:71], a[164:167], a[40:43], v[68:71]
ds_read_b128 a[164:167], v5 offset:58368
s_waitcnt lgkmcnt(9)
v_mfma_f32_16x16x32_bf16 v[72:75], a[168:171], a[40:43], v[72:75]
ds_read_b128 a[168:171], v5 offset:59392
s_waitcnt lgkmcnt(9)
v_mfma_f32_16x16x32_bf16 v[76:79], a[172:175], a[40:43], v[76:79]
ds_read_b128 a[172:175], v5 offset:60416
s_waitcnt lgkmcnt(9)
v_mfma_f32_16x16x32_bf16 v[80:83], a[176:179], a[40:43], v[80:83]
ds_read_b128 a[176:179], v5 offset:61440
s_waitcnt vmcnt(8) lgkmcnt(9)
v_mfma_f32_16x16x32_bf16 v[64:67], a[180:183], a[44:47], v[64:67]
ds_read_b128 a[180:183], v5 offset:62464
s_add_u32 s37, s32, 196608
buffer_load_dwordx4 a[80:83], v4, s[16:19], s37 offen sc1
s_waitcnt lgkmcnt(9)
v_mfma_f32_16x16x32_bf16 v[68:71], a[184:187], a[44:47], v[68:71]
ds_read_b128 a[184:187], v5 offset:63488
s_waitcnt lgkmcnt(9)
v_mfma_f32_16x16x32_bf16 v[72:75], a[188:191], a[44:47], v[72:75]
ds_read_b128 a[188:191], v5 offset:64512
s_waitcnt lgkmcnt(9)
v_mfma_f32_16x16x32_bf16 v[76:79], a[192:195], a[44:47], v[76:79]
s_barrier
ds_read_b128 a[192:195], v6 offset:0
s_waitcnt lgkmcnt(9)
v_mfma_f32_16x16x32_bf16 v[80:83], a[196:199], a[44:47], v[80:83]
ds_read_b128 a[196:199], v6 offset:1024
s_waitcnt vmcnt(8) lgkmcnt(9)
v_mfma_f32_16x16x32_bf16 v[64:67], a[160:163], a[48:51], v[64:67]
ds_read_b128 a[160:163], v6 offset:2048
s_add_u32 s37, s32, 200704
buffer_load_dwordx4 a[84:87], v4, s[16:19], s37 offen sc1
s_waitcnt lgkmcnt(9)
v_mfma_f32_16x16x32_bf16 v[68:71], a[164:167], a[48:51], v[68:71]
ds_read_b128 a[164:167], v6 offset:3072
s_waitcnt lgkmcnt(9)
v_mfma_f32_16x16x32_bf16 v[72:75], a[168:171], a[48:51], v[72:75]
ds_read_b128 a[168:171], v6 offset:4096
s_waitcnt lgkmcnt(9)
v_mfma_f32_16x16x32_bf16 v[76:79], a[172:175], a[48:51], v[76:79]
ds_read_b128 a[172:175], v6 offset:5120
s_waitcnt lgkmcnt(9)
v_mfma_f32_16x16x32_bf16 v[80:83], a[176:179], a[48:51], v[80:83]
ds_read_b128 a[176:179], v6 offset:6144
s_waitcnt vmcnt(8) lgkmcnt(9)
v_mfma_f32_16x16x32_bf16 v[64:67], a[180:183], a[52:55], v[64:67]
ds_read_b128 a[180:183], v6 offset:7168
s_add_u32 s37, s32, 204800
buffer_load_dwordx4 a[88:91], v4, s[16:19], s37 offen sc1
s_waitcnt lgkmcnt(9)
v_mfma_f32_16x16x32_bf16 v[68:71], a[184:187], a[52:55], v[68:71]
ds_read_b128 a[184:187], v6 offset:8192
s_waitcnt lgkmcnt(9)
v_mfma_f32_16x16x32_bf16 v[72:75], a[188:191], a[52:55], v[72:75]
ds_read_b128 a[188:191], v6 offset:9216
s_waitcnt lgkmcnt(9)
v_mfma_f32_16x16x32_bf16 v[76:79], a[192:195], a[52:55], v[76:79]
ds_read_b128 a[192:195], v6 offset:10240
s_waitcnt lgkmcnt(9)
v_mfma_f32_16x16x32_bf16 v[80:83], a[196:199], a[52:55], v[80:83]
ds_read_b128 a[196:199], v6 offset:11264
s_waitcnt vmcnt(8) lgkmcnt(9)
v_mfma_f32_16x16x32_bf16 v[64:67], a[160:163], a[56:59], v[64:67]
ds_read_b128 a[160:163], v6 offset:12288
s_add_u32 s37, s32, 208896
buffer_load_dwordx4 a[92:95], v4, s[16:19], s37 offen sc1
s_waitcnt lgkmcnt(9)
v_mfma_f32_16x16x32_bf16 v[68:71], a[164:167], a[56:59], v[68:71]
ds_read_b128 a[164:167], v6 offset:13312
s_waitcnt lgkmcnt(9)
v_mfma_f32_16x16x32_bf16 v[72:75], a[168:171], a[56:59], v[72:75]
ds_read_b128 a[168:171], v6 offset:14336
s_waitcnt lgkmcnt(9)
v_mfma_f32_16x16x32_bf16 v[76:79], a[172:175], a[56:59], v[76:79]
ds_read_b128 a[172:175], v6 offset:15360
s_waitcnt lgkmcnt(9)
v_mfma_f32_16x16x32_bf16 v[80:83], a[176:179], a[56:59], v[80:83]
s_barrier
ds_read_b128 a[176:179], v6 offset:16384
s_waitcnt vmcnt(8) lgkmcnt(9)
v_mfma_f32_16x16x32_bf16 v[64:67], a[180:183], a[60:63], v[64:67]
ds_read_b128 a[180:183], v6 offset:17408
s_add_u32 s37, s32, 212992
buffer_load_dwordx4 a[96:99], v4, s[16:19], s37 offen sc1
s_waitcnt lgkmcnt(9)
v_mfma_f32_16x16x32_bf16 v[68:71], a[184:187], a[60:63], v[68:71]
ds_read_b128 a[184:187], v6 offset:18432
s_waitcnt lgkmcnt(9)
v_mfma_f32_16x16x32_bf16 v[72:75], a[188:191], a[60:63], v[72:75]
ds_read_b128 a[188:191], v6 offset:19456
s_waitcnt lgkmcnt(9)
v_mfma_f32_16x16x32_bf16 v[76:79], a[192:195], a[60:63], v[76:79]
ds_read_b128 a[192:195], v6 offset:20480
s_waitcnt lgkmcnt(9)
v_mfma_f32_16x16x32_bf16 v[80:83], a[196:199], a[60:63], v[80:83]
ds_read_b128 a[196:199], v6 offset:21504
s_waitcnt vmcnt(8) lgkmcnt(9)
v_mfma_f32_16x16x32_bf16 v[64:67], a[160:163], a[64:67], v[64:67]
ds_read_b128 a[160:163], v6 offset:22528
s_add_u32 s37, s32, 217088
buffer_load_dwordx4 a[100:103], v4, s[16:19], s37 offen sc1
s_waitcnt lgkmcnt(9)
v_mfma_f32_16x16x32_bf16 v[68:71], a[164:167], a[64:67], v[68:71]
ds_read_b128 a[164:167], v6 offset:23552
s_mul_i32 s14, s13, 5
s_mul_i32 s15, s48, 20480
s_add_u32 s38, s14, 0
s_and_b32 s39, s38, 1
s_lshr_b32 s38, s38, 1
s_lshl_b32 s38, s38, 10
s_lshl_b32 s39, s39, 3
s_add_u32 s38, s38, s39
s_add_u32 s38, s38, s15
s_add_u32 s39, s38, 25624576
buffer_load_dwordx2 v[32:33], v4, s[24:27], s39 offen sc1
s_add_u32 s39, s38, 13172736
buffer_load_dwordx2 v[42:43], v4, s[24:27], s39 offen sc1
s_add_u32 s38, s14, 1
s_and_b32 s39, s38, 1
s_lshr_b32 s38, s38, 1
s_lshl_b32 s38, s38, 10
s_lshl_b32 s39, s39, 3
s_add_u32 s38, s38, s39
s_add_u32 s38, s38, s15
s_add_u32 s39, s38, 25624576
buffer_load_dwordx2 v[34:35], v4, s[24:27], s39 offen sc1
s_add_u32 s39, s38, 13172736
buffer_load_dwordx2 v[44:45], v4, s[24:27], s39 offen sc1
s_add_u32 s38, s14, 2
s_and_b32 s39, s38, 1
s_lshr_b32 s38, s38, 1
s_lshl_b32 s38, s38, 10
s_lshl_b32 s39, s39, 3
s_add_u32 s38, s38, s39
s_add_u32 s38, s38, s15
s_add_u32 s39, s38, 25624576
buffer_load_dwordx2 v[36:37], v4, s[24:27], s39 offen sc1
s_add_u32 s39, s38, 13172736
buffer_load_dwordx2 v[46:47], v4, s[24:27], s39 offen sc1
s_add_u32 s38, s14, 3
s_and_b32 s39, s38, 1
s_lshr_b32 s38, s38, 1
s_lshl_b32 s38, s38, 10
s_lshl_b32 s39, s39, 3
s_add_u32 s38, s38, s39
s_add_u32 s38, s38, s15
s_add_u32 s39, s38, 25624576
buffer_load_dwordx2 v[38:39], v4, s[24:27], s39 offen sc1
s_add_u32 s39, s38, 13172736
buffer_load_dwordx2 v[48:49], v4, s[24:27], s39 offen sc1
s_add_u32 s38, s14, 4
s_and_b32 s39, s38, 1
s_lshr_b32 s38, s38, 1
s_lshl_b32 s38, s38, 10
s_lshl_b32 s39, s39, 3
s_add_u32 s38, s38, s39
s_add_u32 s38, s38, s15
s_add_u32 s39, s38, 25624576
buffer_load_dwordx2 v[40:41], v4, s[24:27], s39 offen sc1
s_add_u32 s39, s38, 13172736
buffer_load_dwordx2 v[50:51], v4, s[24:27], s39 offen sc1
v_lshlrev_b32 v8, 2, v3
s_lshl_b32 s38, s48, 6
s_add_u32 s38, s38, 7077888
buffer_load_dword v52, v8, s[24:27], s38 offen sc1
s_waitcnt lgkmcnt(9)
v_mfma_f32_16x16x32_bf16 v[72:75], a[168:171], a[64:67], v[72:75]
ds_read_b128 a[168:171], v6 offset:24576
s_waitcnt lgkmcnt(9)
v_mfma_f32_16x16x32_bf16 v[76:79], a[172:175], a[64:67], v[76:79]
ds_read_b128 a[172:175], v6 offset:25600
s_waitcnt lgkmcnt(9)
v_mfma_f32_16x16x32_bf16 v[80:83], a[176:179], a[64:67], v[80:83]
ds_read_b128 a[176:179], v6 offset:26624
s_waitcnt vmcnt(19) lgkmcnt(9)
v_mfma_f32_16x16x32_bf16 v[64:67], a[180:183], a[68:71], v[64:67]
ds_read_b128 a[180:183], v6 offset:27648
s_waitcnt lgkmcnt(9)
v_mfma_f32_16x16x32_bf16 v[68:71], a[184:187], a[68:71], v[68:71]
ds_read_b128 a[184:187], v6 offset:28672
s_waitcnt lgkmcnt(9)
v_mfma_f32_16x16x32_bf16 v[72:75], a[188:191], a[68:71], v[72:75]
ds_read_b128 a[188:191], v6 offset:29696
s_waitcnt lgkmcnt(9)
v_mfma_f32_16x16x32_bf16 v[76:79], a[192:195], a[68:71], v[76:79]
ds_read_b128 a[192:195], v6 offset:30720
s_waitcnt lgkmcnt(9)
v_mfma_f32_16x16x32_bf16 v[80:83], a[196:199], a[68:71], v[80:83]
ds_read_b128 a[196:199], v6 offset:31744
s_waitcnt vmcnt(18) lgkmcnt(9)
v_mfma_f32_16x16x32_bf16 v[64:67], a[160:163], a[72:75], v[64:67]
s_barrier
ds_read_b128 a[160:163], v6 offset:32768
s_waitcnt lgkmcnt(9)
v_mfma_f32_16x16x32_bf16 v[68:71], a[164:167], a[72:75], v[68:71]
ds_read_b128 a[164:167], v6 offset:33792
s_waitcnt lgkmcnt(9)
v_mfma_f32_16x16x32_bf16 v[72:75], a[168:171], a[72:75], v[72:75]
ds_read_b128 a[168:171], v6 offset:34816
s_waitcnt lgkmcnt(9)
v_mfma_f32_16x16x32_bf16 v[76:79], a[172:175], a[72:75], v[76:79]
ds_read_b128 a[172:175], v6 offset:35840
s_waitcnt lgkmcnt(9)
v_mfma_f32_16x16x32_bf16 v[80:83], a[176:179], a[72:75], v[80:83]
ds_read_b128 a[176:179], v6 offset:36864
s_waitcnt vmcnt(17) lgkmcnt(9)
v_mfma_f32_16x16x32_bf16 v[64:67], a[180:183], a[76:79], v[64:67]
ds_read_b128 a[180:183], v6 offset:37888
s_waitcnt lgkmcnt(9)
v_mfma_f32_16x16x32_bf16 v[68:71], a[184:187], a[76:79], v[68:71]
ds_read_b128 a[184:187], v6 offset:38912
s_waitcnt lgkmcnt(9)
v_mfma_f32_16x16x32_bf16 v[72:75], a[188:191], a[76:79], v[72:75]
ds_read_b128 a[188:191], v6 offset:39936
s_waitcnt lgkmcnt(9)
v_mfma_f32_16x16x32_bf16 v[76:79], a[192:195], a[76:79], v[76:79]
ds_read_b128 a[192:195], v6 offset:40960
s_waitcnt lgkmcnt(9)
v_mfma_f32_16x16x32_bf16 v[80:83], a[196:199], a[76:79], v[80:83]
ds_read_b128 a[196:199], v6 offset:41984
s_waitcnt vmcnt(16) lgkmcnt(9)
v_mfma_f32_16x16x32_bf16 v[64:67], a[160:163], a[80:83], v[64:67]
ds_read_b128 a[160:163], v6 offset:43008
s_waitcnt lgkmcnt(9)
v_mfma_f32_16x16x32_bf16 v[68:71], a[164:167], a[80:83], v[68:71]
ds_read_b128 a[164:167], v6 offset:44032
s_waitcnt lgkmcnt(9)
v_mfma_f32_16x16x32_bf16 v[72:75], a[168:171], a[80:83], v[72:75]
ds_read_b128 a[168:171], v6 offset:45056
s_waitcnt lgkmcnt(9)
v_mfma_f32_16x16x32_bf16 v[76:79], a[172:175], a[80:83], v[76:79]
ds_read_b128 a[172:175], v6 offset:46080
s_waitcnt lgkmcnt(9)
v_mfma_f32_16x16x32_bf16 v[80:83], a[176:179], a[80:83], v[80:83]
ds_read_b128 a[176:179], v6 offset:47104
s_waitcnt vmcnt(15) lgkmcnt(9)
v_mfma_f32_16x16x32_bf16 v[64:67], a[180:183], a[84:87], v[64:67]
ds_read_b128 a[180:183], v6 offset:48128
s_waitcnt lgkmcnt(9)
v_mfma_f32_16x16x32_bf16 v[68:71], a[184:187], a[84:87], v[68:71]
s_barrier
ds_read_b128 a[184:187], v6 offset:49152
s_waitcnt lgkmcnt(9)
v_mfma_f32_16x16x32_bf16 v[72:75], a[188:191], a[84:87], v[72:75]
ds_read_b128 a[188:191], v6 offset:50176
s_waitcnt lgkmcnt(9)
v_mfma_f32_16x16x32_bf16 v[76:79], a[192:195], a[84:87], v[76:79]
ds_read_b128 a[192:195], v6 offset:51200
s_waitcnt lgkmcnt(9)
v_mfma_f32_16x16x32_bf16 v[80:83], a[196:199], a[84:87], v[80:83]
ds_read_b128 a[196:199], v6 offset:52224
s_waitcnt vmcnt(14) lgkmcnt(9)
v_mfma_f32_16x16x32_bf16 v[64:67], a[160:163], a[88:91], v[64:67]
ds_read_b128 a[160:163], v6 offset:53248
s_waitcnt lgkmcnt(9)
v_mfma_f32_16x16x32_bf16 v[68:71], a[164:167], a[88:91], v[68:71]
ds_read_b128 a[164:167], v6 offset:54272
s_waitcnt lgkmcnt(9)
v_mfma_f32_16x16x32_bf16 v[72:75], a[168:171], a[88:91], v[72:75]
ds_read_b128 a[168:171], v6 offset:55296
s_waitcnt lgkmcnt(9)
v_mfma_f32_16x16x32_bf16 v[76:79], a[172:175], a[88:91], v[76:79]
ds_read_b128 a[172:175], v6 offset:56320
s_waitcnt lgkmcnt(9)
v_mfma_f32_16x16x32_bf16 v[80:83], a[176:179], a[88:91], v[80:83]
ds_read_b128 a[176:179], v6 offset:57344
s_waitcnt vmcnt(13) lgkmcnt(9)
v_mfma_f32_16x16x32_bf16 v[64:67], a[180:183], a[92:95], v[64:67]
ds_read_b128 a[180:183], v6 offset:58368
s_waitcnt lgkmcnt(9)
v_mfma_f32_16x16x32_bf16 v[68:71], a[184:187], a[92:95], v[68:71]
ds_read_b128 a[184:187], v6 offset:59392
s_waitcnt lgkmcnt(9)
v_mfma_f32_16x16x32_bf16 v[72:75], a[188:191], a[92:95], v[72:75]
ds_read_b128 a[188:191], v6 offset:60416
s_waitcnt lgkmcnt(9)
v_mfma_f32_16x16x32_bf16 v[76:79], a[192:195], a[92:95], v[76:79]
ds_read_b128 a[192:195], v6 offset:61440
s_waitcnt lgkmcnt(9)
v_mfma_f32_16x16x32_bf16 v[80:83], a[196:199], a[92:95], v[80:83]
ds_read_b128 a[196:199], v6 offset:62464
s_waitcnt vmcnt(12) lgkmcnt(9)
v_mfma_f32_16x16x32_bf16 v[64:67], a[160:163], a[96:99], v[64:67]
s_waitcnt lgkmcnt(8)
v_mfma_f32_16x16x32_bf16 v[68:71], a[164:167], a[96:99], v[68:71]
s_waitcnt lgkmcnt(7)
v_mfma_f32_16x16x32_bf16 v[72:75], a[168:171], a[96:99], v[72:75]
s_waitcnt lgkmcnt(6)
v_mfma_f32_16x16x32_bf16 v[76:79], a[172:175], a[96:99], v[76:79]
s_waitcnt lgkmcnt(5)
v_mfma_f32_16x16x32_bf16 v[80:83], a[176:179], a[96:99], v[80:83]
s_waitcnt vmcnt(11) lgkmcnt(4)
v_mfma_f32_16x16x32_bf16 v[64:67], a[180:183], a[100:103], v[64:67]
s_waitcnt lgkmcnt(3)
v_mfma_f32_16x16x32_bf16 v[68:71], a[184:187], a[100:103], v[68:71]
s_waitcnt lgkmcnt(2)
v_mfma_f32_16x16x32_bf16 v[72:75], a[188:191], a[100:103], v[72:75]
s_waitcnt lgkmcnt(1)
v_mfma_f32_16x16x32_bf16 v[76:79], a[192:195], a[100:103], v[76:79]
s_waitcnt lgkmcnt(0)
v_mfma_f32_16x16x32_bf16 v[80:83], a[196:199], a[100:103], v[80:83]
s_waitcnt vmcnt(0)
s_lshl_b32 s14, s48, 4
v_add_u32 v8, s14, v3
v_mul_u32_u24 v8, 1280, v8
v_lshl_add_u32 v8, v2, 3, v8
s_mul_i32 s14, s13, 160
v_sub_f32 v53, 1.0, v52
v_lshlrev_b32 v100, 16, v42
v_and_b32 v101, 0xffff0000, v42
v_lshlrev_b32 v102, 16, v43
v_and_b32 v103, 0xffff0000, v43
v_lshlrev_b32 v104, 16, v32
v_and_b32 v105, 0xffff0000, v32
v_lshlrev_b32 v106, 16, v33
v_and_b32 v107, 0xffff0000, v33
v_pk_add_f32 v[64:65], v[64:65], v[100:101]
v_pk_add_f32 v[66:67], v[66:67], v[102:103]
v_pk_mul_f32 v[64:65], v[64:65], v[52:53] op_sel:[0,1] op_sel_hi:[1,1]
v_pk_mul_f32 v[66:67], v[66:67], v[52:53] op_sel:[0,1] op_sel_hi:[1,1]
v_pk_fma_f32 v[64:65], v[104:105], v[52:53], v[64:65] op_sel_hi:[1,0,1]
v_pk_fma_f32 v[66:67], v[106:107], v[52:53], v[66:67] op_sel_hi:[1,0,1]
v_cvt_pk_bf16_f32 v120, v64, v65
v_cvt_pk_bf16_f32 v121, v66, v67
buffer_store_dwordx2 v[120:121], v8, s[28:31], s14 offen offset:0
v_lshlrev_b32 v108, 16, v44
v_and_b32 v109, 0xffff0000, v44
v_lshlrev_b32 v110, 16, v45
v_and_b32 v111, 0xffff0000, v45
v_lshlrev_b32 v112, 16, v34
v_and_b32 v113, 0xffff0000, v34
v_lshlrev_b32 v114, 16, v35
v_and_b32 v115, 0xffff0000, v35
v_pk_add_f32 v[68:69], v[68:69], v[108:109]
v_pk_add_f32 v[70:71], v[70:71], v[110:111]
v_pk_mul_f32 v[68:69], v[68:69], v[52:53] op_sel:[0,1] op_sel_hi:[1,1]
v_pk_mul_f32 v[70:71], v[70:71], v[52:53] op_sel:[0,1] op_sel_hi:[1,1]
v_pk_fma_f32 v[68:69], v[112:113], v[52:53], v[68:69] op_sel_hi:[1,0,1]
v_pk_fma_f32 v[70:71], v[114:115], v[52:53], v[70:71] op_sel_hi:[1,0,1]
v_cvt_pk_bf16_f32 v122, v68, v69
v_cvt_pk_bf16_f32 v123, v70, v71
buffer_store_dwordx2 v[122:123], v8, s[28:31], s14 offen offset:32
v_lshlrev_b32 v100, 16, v46
v_and_b32 v101, 0xffff0000, v46
v_lshlrev_b32 v102, 16, v47
v_and_b32 v103, 0xffff0000, v47
v_lshlrev_b32 v104, 16, v36
v_and_b32 v105, 0xffff0000, v36
v_lshlrev_b32 v106, 16, v37
v_and_b32 v107, 0xffff0000, v37
v_pk_add_f32 v[72:73], v[72:73], v[100:101]
v_pk_add_f32 v[74:75], v[74:75], v[102:103]
v_pk_mul_f32 v[72:73], v[72:73], v[52:53] op_sel:[0,1] op_sel_hi:[1,1]
v_pk_mul_f32 v[74:75], v[74:75], v[52:53] op_sel:[0,1] op_sel_hi:[1,1]
v_pk_fma_f32 v[72:73], v[104:105], v[52:53], v[72:73] op_sel_hi:[1,0,1]
v_pk_fma_f32 v[74:75], v[106:107], v[52:53], v[74:75] op_sel_hi:[1,0,1]
v_cvt_pk_bf16_f32 v124, v72, v73
v_cvt_pk_bf16_f32 v125, v74, v75
buffer_store_dwordx2 v[124:125], v8, s[28:31], s14 offen offset:64
v_lshlrev_b32 v108, 16, v48
v_and_b32 v109, 0xffff0000, v48
v_lshlrev_b32 v110, 16, v49
v_and_b32 v111, 0xffff0000, v49
v_lshlrev_b32 v112, 16, v38
v_and_b32 v113, 0xffff0000, v38
v_lshlrev_b32 v114, 16, v39
v_and_b32 v115, 0xffff0000, v39
v_pk_add_f32 v[76:77], v[76:77], v[108:109]
v_pk_add_f32 v[78:79], v[78:79], v[110:111]
v_pk_mul_f32 v[76:77], v[76:77], v[52:53] op_sel:[0,1] op_sel_hi:[1,1]
v_pk_mul_f32 v[78:79], v[78:79], v[52:53] op_sel:[0,1] op_sel_hi:[1,1]
v_pk_fma_f32 v[76:77], v[112:113], v[52:53], v[76:77] op_sel_hi:[1,0,1]
v_pk_fma_f32 v[78:79], v[114:115], v[52:53], v[78:79] op_sel_hi:[1,0,1]
v_cvt_pk_bf16_f32 v126, v76, v77
v_cvt_pk_bf16_f32 v127, v78, v79
buffer_store_dwordx2 v[126:127], v8, s[28:31], s14 offen offset:96
v_lshlrev_b32 v100, 16, v50
v_and_b32 v101, 0xffff0000, v50
v_lshlrev_b32 v102, 16, v51
v_and_b32 v103, 0xffff0000, v51
v_lshlrev_b32 v104, 16, v40
v_and_b32 v105, 0xffff0000, v40
v_lshlrev_b32 v106, 16, v41
v_and_b32 v107, 0xffff0000, v41
v_pk_add_f32 v[80:81], v[80:81], v[100:101]
v_pk_add_f32 v[82:83], v[82:83], v[102:103]
v_pk_mul_f32 v[80:81], v[80:81], v[52:53] op_sel:[0,1] op_sel_hi:[1,1]
v_pk_mul_f32 v[82:83], v[82:83], v[52:53] op_sel:[0,1] op_sel_hi:[1,1]
v_pk_fma_f32 v[80:81], v[104:105], v[52:53], v[80:81] op_sel_hi:[1,0,1]
v_pk_fma_f32 v[82:83], v[106:107], v[52:53], v[82:83] op_sel_hi:[1,0,1]
v_cvt_pk_bf16_f32 v128, v80, v81
v_cvt_pk_bf16_f32 v129, v82, v83
buffer_store_dwordx2 v[128:129], v8, s[28:31], s14 offen offset:128
L_k4_kernel_fin:
L_exit:
L_k4_kernel_end:
s_endpgm

.section .rodata,"a"
.p2align 6
.amdhsa_kernel gated_mix__linear_attn_block__mixer_s_mlp__prompt_kernel
  .amdhsa_next_free_vgpr 512
  .amdhsa_next_free_sgpr 100
  .amdhsa_accum_offset 256
  .amdhsa_group_segment_fixed_size 0
  .amdhsa_kernarg_size 96
  .amdhsa_user_sgpr_count 2
  .amdhsa_user_sgpr_kernarg_segment_ptr 1
  .amdhsa_system_sgpr_workgroup_id_x 1
.end_amdhsa_kernel
.text
L_code_end:
s_endpgm
```
